```python
import torch

def _softmax(x, axis=-1):
    return torch.softmax(x, dim=axis)

def _gelu(x):
    return torch.nn.functional.gelu(x, approximate='tanh')

def _silu(x):
    return torch.nn.functional.silu(x)

def _sigmoid(x):
    return torch.sigmoid(x)

def _layernorm(x, axis=-1, eps=1e-05):
    m = x.mean(dim=axis, keepdim=True)
    v = x.var(dim=axis, keepdim=True, unbiased=False)
    return (x - m) / torch.sqrt(v + eps)

def _scatter_add(tgt, idx, src, axis=0):
    return tgt.clone().index_add_(axis, idx, src)

def _segment_sum(src, seg, n):
    out = torch.zeros((n,) + src.shape[1:], dtype=src.dtype)
    return out.index_add_(0, seg, src)

def _pad(x, pw):
    flat = tuple((v for pair in reversed(pw) for v in pair))
    return torch.nn.functional.pad(x, flat)
kernel_name = 'adaLN_cond__gqa_block_cached__swiglu_ffn__prompt'

def setup_inputs():

    _w = lambda a: (lambda t: t.to(torch.bfloat16) if t.is_floating_point() else t)(torch.as_tensor(a))

    def _A_setup():
        B, Sq, D = (1, 2048, 1024)
        Hq, Hkv, Sk, Dh = (32, 4, 2048, 128)
        assert Hq % Hkv == 0, (Hq, Hkv)
        return {'x': _w((lambda *s: torch.randn(*s, dtype=torch.bfloat16) * 0.05)(B, Sq, D)), 'k_cache': _w((lambda *s: torch.randn(*s, dtype=torch.bfloat16) * 3.2)(B, Hkv, Sk, Dh)), 'v_cache': _w((lambda *s: torch.randn(*s, dtype=torch.bfloat16) * 0.4)(B, Hkv, Sk, Dh)), 'wq': _w((lambda *s: torch.randn(*s, dtype=torch.bfloat16) * 3.2)(D, Hq * Dh) * D ** (-0.5)), 'wo': _w((lambda *s: torch.randn(*s, dtype=torch.bfloat16) * 0.4)(Hq * Dh, D) * (Hq * Dh) ** (-0.5))}
    _A_in = _A_setup()

    def _B_setup():
        B, S, D, F = (1, 2048, 1024, 3584)
        return {'x': _w((lambda *s: torch.randn(*s, dtype=torch.bfloat16) * 0.05)(B, S, D)), 'w_gate': _w((lambda *s: torch.randn(*s, dtype=torch.bfloat16) * 0.05)(D, F)), 'w_up': _w((lambda *s: torch.randn(*s, dtype=torch.bfloat16) * 0.05)(D, F)), 'w_down': _w((lambda *s: torch.randn(*s, dtype=torch.bfloat16) * 0.05)(F, D))}
    _B_in = _B_setup()
    return {'A_x': _A_in['x'], 'A_k_cache': _A_in['k_cache'], 'A_v_cache': _A_in['v_cache'], 'A_wq': _A_in['wq'], 'A_wo': _A_in['wo'], 'B_x': _B_in['x'], 'B_w_gate': _B_in['w_gate'], 'B_w_up': _B_in['w_up'], 'B_w_down': _B_in['w_down'], 'c': _w((lambda *s: torch.randn(*s, dtype=torch.bfloat16) * 0.1)(1, 1024) * 8.0), 'w_mod': _w((lambda *s: torch.randn(*s, dtype=torch.bfloat16) * 0.1)(1024, 6 * 1024) * 1024 ** (-0.5) * 8.0)}

def reference(A_x, A_k_cache, A_v_cache, A_wq, A_wo, B_x, B_w_gate, B_w_up, B_w_down, c, w_mod):

    def _A_ref(x, k_cache, v_cache, wq, wo):
        B, Sq, D = x.shape
        Hq, Dh = (32, 128)
        Hkv = k_cache.shape[1]
        rep = Hq // Hkv
        q = (lambda x, *d: x.permute(*d))((x @ wq).reshape(B, Sq, Hq, Dh), 0, 2, 1, 3)
        k = (lambda x, n, axis: torch.repeat_interleave(x, n, dim=axis))(k_cache, rep, axis=1)
        v = (lambda x, n, axis: torch.repeat_interleave(x, n, dim=axis))(v_cache, rep, axis=1)
        scores = torch.einsum('bhqd,bhkd->bhqk', q, k) * Dh ** (-0.5)
        p = _softmax(scores, axis=-1)
        o = torch.einsum('bhqk,bhkd->bhqd', p, v)
        return (lambda x, *d: x.permute(*d))(o, 0, 2, 1, 3).reshape(B, Sq, Hq * Dh) @ wo

    def _B_ref(x, w_gate, w_up, w_down):
        g = _silu(x @ w_gate)
        u = x @ w_up
        return g * u @ w_down
    x = A_x
    mod = (_silu(c) @ w_mod).reshape(c.shape[0], 6, 1, -1)
    sa, ca, ga, sb, cb, gb = (mod[:, 0].clone(), mod[:, 1].clone(), mod[:, 2].clone(), mod[:, 3].clone(), mod[:, 4].clone(), mod[:, 5].clone())
    h = _layernorm(x, axis=-1) * (1 + ca) + sa
    x = x + ga * _A_ref(h, A_k_cache, A_v_cache, A_wq, A_wo)
    h = _layernorm(x, axis=-1) * (1 + cb) + sb
    x = x + gb * _B_ref(h, B_w_gate, B_w_up, B_w_down)
    return x
```

```asm
; @launch kernel=mod_kernel grid=(192,1,1) block=(512,1,1) lds=1024
; @launch kernel=ln1_kernel grid=(512,1,1) block=(256,1,1) lds=0
; @launch kernel=attn_kernel grid=(256,1,1) block=(512,1,1) lds=163840
; @launch kernel=oproj_kernel grid=(256,1,1) block=(512,1,1) lds=98304
; @launch kernel=ln2_kernel grid=(512,1,1) block=(256,1,1) lds=0
; @launch kernel=gateup_kernel grid=(224,1,1) block=(512,1,1) lds=131072
; @launch kernel=down_kernel grid=(256,1,1) block=(512,1,1) lds=98304
.amdgcn_target "amdgcn-amd-amdhsa--gfx950"
.text
.globl mod_kernel
.p2align 8
.type mod_kernel,@function
mod_kernel:
    s_cmp_ge_u32 s2, 192
    s_cbranch_scc1 mod_kernel_end
    s_load_dwordx2 s[4:5], s[0:1], 72
    s_load_dwordx2 s[6:7], s[0:1], 80
    s_load_dwordx2 s[8:9], s[0:1], 104
    v_and_b32 v1, 63, v0
    v_lshrrev_b32 v2, 6, v0
    v_and_b32 v3, 3, v1
    v_lshrrev_b32 v4, 2, v1
    v_lshl_add_u32 v4, v2, 4, v4
    s_waitcnt lgkmcnt(0)
    s_mov_b32 s12, s4
    s_mov_b32 s13, s5
    s_mov_b32 s14, 0x800
    s_mov_b32 s15, 0x00020000
    s_mov_b32 s16, s6
    s_mov_b32 s17, s7
    s_mov_b32 s18, 0xc00000
    s_mov_b32 s19, 0x00020000
    s_mov_b32 s20, s8
    s_mov_b32 s21, s9
    s_mov_b32 s22, 0x6000
    s_mov_b32 s23, 0x00020000
    v_lshlrev_b32 v5, 1, v4
    s_mov_b32 s24, 12288
    v_mul_lo_u32 v6, v4, s24
    s_lshl_b32 s25, s2, 6
    v_lshl_add_u32 v6, v3, 4, v6
    v_add_u32 v6, s25, v6
    buffer_load_ushort v8, v5, s[12:15], 0 offen offset:0
    buffer_load_ushort v9, v5, s[12:15], 0 offen offset:256
    buffer_load_ushort v10, v5, s[12:15], 0 offen offset:512
    buffer_load_ushort v11, v5, s[12:15], 0 offen offset:768
    buffer_load_ushort v12, v5, s[12:15], 0 offen offset:1024
    buffer_load_ushort v13, v5, s[12:15], 0 offen offset:1280
    buffer_load_ushort v14, v5, s[12:15], 0 offen offset:1536
    buffer_load_ushort v15, v5, s[12:15], 0 offen offset:1792
    s_mov_b32 s26, 0
    s_mov_b32 s27, 1572864
    s_mov_b32 s28, 3145728
    s_mov_b32 s29, 4718592
    s_mov_b32 s30, 6291456
    s_mov_b32 s31, 7864320
    s_mov_b32 s32, 9437184
    s_mov_b32 s33, 11010048
    buffer_load_dwordx4 v[32:35], v6, s[16:19], s26 offen
    buffer_load_dwordx4 v[36:39], v6, s[16:19], s27 offen
    buffer_load_dwordx4 v[40:43], v6, s[16:19], s28 offen
    buffer_load_dwordx4 v[44:47], v6, s[16:19], s29 offen
    buffer_load_dwordx4 v[48:51], v6, s[16:19], s30 offen
    buffer_load_dwordx4 v[52:55], v6, s[16:19], s31 offen
    buffer_load_dwordx4 v[56:59], v6, s[16:19], s32 offen
    buffer_load_dwordx4 v[60:63], v6, s[16:19], s33 offen
    s_waitcnt vmcnt(15)
    v_lshlrev_b32 v8, 16, v8
    v_mul_f32 v16, 0xbfb8aa3b, v8
    v_exp_f32 v16, v16
    s_nop 0
    v_add_f32 v16, 1.0, v16
    v_rcp_f32 v16, v16
    s_nop 0
    v_mul_f32 v8, v8, v16
    s_waitcnt vmcnt(14)
    v_lshlrev_b32 v9, 16, v9
    v_mul_f32 v17, 0xbfb8aa3b, v9
    v_exp_f32 v17, v17
    s_nop 0
    v_add_f32 v17, 1.0, v17
    v_rcp_f32 v17, v17
    s_nop 0
    v_mul_f32 v9, v9, v17
    s_waitcnt vmcnt(13)
    v_lshlrev_b32 v10, 16, v10
    v_mul_f32 v18, 0xbfb8aa3b, v10
    v_exp_f32 v18, v18
    s_nop 0
    v_add_f32 v18, 1.0, v18
    v_rcp_f32 v18, v18
    s_nop 0
    v_mul_f32 v10, v10, v18
    s_waitcnt vmcnt(12)
    v_lshlrev_b32 v11, 16, v11
    v_mul_f32 v19, 0xbfb8aa3b, v11
    v_exp_f32 v19, v19
    s_nop 0
    v_add_f32 v19, 1.0, v19
    v_rcp_f32 v19, v19
    s_nop 0
    v_mul_f32 v11, v11, v19
    s_waitcnt vmcnt(11)
    v_lshlrev_b32 v12, 16, v12
    v_mul_f32 v20, 0xbfb8aa3b, v12
    v_exp_f32 v20, v20
    s_nop 0
    v_add_f32 v20, 1.0, v20
    v_rcp_f32 v20, v20
    s_nop 0
    v_mul_f32 v12, v12, v20
    s_waitcnt vmcnt(10)
    v_lshlrev_b32 v13, 16, v13
    v_mul_f32 v21, 0xbfb8aa3b, v13
    v_exp_f32 v21, v21
    s_nop 0
    v_add_f32 v21, 1.0, v21
    v_rcp_f32 v21, v21
    s_nop 0
    v_mul_f32 v13, v13, v21
    s_waitcnt vmcnt(9)
    v_lshlrev_b32 v14, 16, v14
    v_mul_f32 v22, 0xbfb8aa3b, v14
    v_exp_f32 v22, v22
    s_nop 0
    v_add_f32 v22, 1.0, v22
    v_rcp_f32 v22, v22
    s_nop 0
    v_mul_f32 v14, v14, v22
    s_waitcnt vmcnt(8)
    v_lshlrev_b32 v15, 16, v15
    v_mul_f32 v23, 0xbfb8aa3b, v15
    v_exp_f32 v23, v23
    s_nop 0
    v_add_f32 v23, 1.0, v23
    v_rcp_f32 v23, v23
    s_nop 0
    v_mul_f32 v15, v15, v23
    v_cvt_pk_bf16_f32 v16, v8, v9
    v_lshlrev_b32 v8, 16, v16
    v_and_b32 v9, 0xffff0000, v16
    v_cvt_pk_bf16_f32 v16, v10, v11
    v_lshlrev_b32 v10, 16, v16
    v_and_b32 v11, 0xffff0000, v16
    v_cvt_pk_bf16_f32 v16, v12, v13
    v_lshlrev_b32 v12, 16, v16
    v_and_b32 v13, 0xffff0000, v16
    v_cvt_pk_bf16_f32 v16, v14, v15
    v_lshlrev_b32 v14, 16, v16
    v_and_b32 v15, 0xffff0000, v16
    v_mov_b32 v64, 0
    v_mov_b32 v65, 0
    v_mov_b32 v66, 0
    v_mov_b32 v67, 0
    v_mov_b32 v68, 0
    v_mov_b32 v69, 0
    v_mov_b32 v70, 0
    v_mov_b32 v71, 0
    s_waitcnt vmcnt(7)
    v_lshlrev_b32 v16, 16, v32
    v_and_b32 v17, 0xffff0000, v32
    v_fmac_f32 v64, v8, v16
    v_fmac_f32 v65, v8, v17
    v_lshlrev_b32 v16, 16, v33
    v_and_b32 v17, 0xffff0000, v33
    v_fmac_f32 v66, v8, v16
    v_fmac_f32 v67, v8, v17
    v_lshlrev_b32 v16, 16, v34
    v_and_b32 v17, 0xffff0000, v34
    v_fmac_f32 v68, v8, v16
    v_fmac_f32 v69, v8, v17
    v_lshlrev_b32 v16, 16, v35
    v_and_b32 v17, 0xffff0000, v35
    v_fmac_f32 v70, v8, v16
    v_fmac_f32 v71, v8, v17
    s_waitcnt vmcnt(6)
    v_lshlrev_b32 v16, 16, v36
    v_and_b32 v17, 0xffff0000, v36
    v_fmac_f32 v64, v9, v16
    v_fmac_f32 v65, v9, v17
    v_lshlrev_b32 v16, 16, v37
    v_and_b32 v17, 0xffff0000, v37
    v_fmac_f32 v66, v9, v16
    v_fmac_f32 v67, v9, v17
    v_lshlrev_b32 v16, 16, v38
    v_and_b32 v17, 0xffff0000, v38
    v_fmac_f32 v68, v9, v16
    v_fmac_f32 v69, v9, v17
    v_lshlrev_b32 v16, 16, v39
    v_and_b32 v17, 0xffff0000, v39
    v_fmac_f32 v70, v9, v16
    v_fmac_f32 v71, v9, v17
    s_waitcnt vmcnt(5)
    v_lshlrev_b32 v16, 16, v40
    v_and_b32 v17, 0xffff0000, v40
    v_fmac_f32 v64, v10, v16
    v_fmac_f32 v65, v10, v17
    v_lshlrev_b32 v16, 16, v41
    v_and_b32 v17, 0xffff0000, v41
    v_fmac_f32 v66, v10, v16
    v_fmac_f32 v67, v10, v17
    v_lshlrev_b32 v16, 16, v42
    v_and_b32 v17, 0xffff0000, v42
    v_fmac_f32 v68, v10, v16
    v_fmac_f32 v69, v10, v17
    v_lshlrev_b32 v16, 16, v43
    v_and_b32 v17, 0xffff0000, v43
    v_fmac_f32 v70, v10, v16
    v_fmac_f32 v71, v10, v17
    s_waitcnt vmcnt(4)
    v_lshlrev_b32 v16, 16, v44
    v_and_b32 v17, 0xffff0000, v44
    v_fmac_f32 v64, v11, v16
    v_fmac_f32 v65, v11, v17
    v_lshlrev_b32 v16, 16, v45
    v_and_b32 v17, 0xffff0000, v45
    v_fmac_f32 v66, v11, v16
    v_fmac_f32 v67, v11, v17
    v_lshlrev_b32 v16, 16, v46
    v_and_b32 v17, 0xffff0000, v46
    v_fmac_f32 v68, v11, v16
    v_fmac_f32 v69, v11, v17
    v_lshlrev_b32 v16, 16, v47
    v_and_b32 v17, 0xffff0000, v47
    v_fmac_f32 v70, v11, v16
    v_fmac_f32 v71, v11, v17
    s_waitcnt vmcnt(3)
    v_lshlrev_b32 v16, 16, v48
    v_and_b32 v17, 0xffff0000, v48
    v_fmac_f32 v64, v12, v16
    v_fmac_f32 v65, v12, v17
    v_lshlrev_b32 v16, 16, v49
    v_and_b32 v17, 0xffff0000, v49
    v_fmac_f32 v66, v12, v16
    v_fmac_f32 v67, v12, v17
    v_lshlrev_b32 v16, 16, v50
    v_and_b32 v17, 0xffff0000, v50
    v_fmac_f32 v68, v12, v16
    v_fmac_f32 v69, v12, v17
    v_lshlrev_b32 v16, 16, v51
    v_and_b32 v17, 0xffff0000, v51
    v_fmac_f32 v70, v12, v16
    v_fmac_f32 v71, v12, v17
    s_waitcnt vmcnt(2)
    v_lshlrev_b32 v16, 16, v52
    v_and_b32 v17, 0xffff0000, v52
    v_fmac_f32 v64, v13, v16
    v_fmac_f32 v65, v13, v17
    v_lshlrev_b32 v16, 16, v53
    v_and_b32 v17, 0xffff0000, v53
    v_fmac_f32 v66, v13, v16
    v_fmac_f32 v67, v13, v17
    v_lshlrev_b32 v16, 16, v54
    v_and_b32 v17, 0xffff0000, v54
    v_fmac_f32 v68, v13, v16
    v_fmac_f32 v69, v13, v17
    v_lshlrev_b32 v16, 16, v55
    v_and_b32 v17, 0xffff0000, v55
    v_fmac_f32 v70, v13, v16
    v_fmac_f32 v71, v13, v17
    s_waitcnt vmcnt(1)
    v_lshlrev_b32 v16, 16, v56
    v_and_b32 v17, 0xffff0000, v56
    v_fmac_f32 v64, v14, v16
    v_fmac_f32 v65, v14, v17
    v_lshlrev_b32 v16, 16, v57
    v_and_b32 v17, 0xffff0000, v57
    v_fmac_f32 v66, v14, v16
    v_fmac_f32 v67, v14, v17
    v_lshlrev_b32 v16, 16, v58
    v_and_b32 v17, 0xffff0000, v58
    v_fmac_f32 v68, v14, v16
    v_fmac_f32 v69, v14, v17
    v_lshlrev_b32 v16, 16, v59
    v_and_b32 v17, 0xffff0000, v59
    v_fmac_f32 v70, v14, v16
    v_fmac_f32 v71, v14, v17
    s_waitcnt vmcnt(0)
    v_lshlrev_b32 v16, 16, v60
    v_and_b32 v17, 0xffff0000, v60
    v_fmac_f32 v64, v15, v16
    v_fmac_f32 v65, v15, v17
    v_lshlrev_b32 v16, 16, v61
    v_and_b32 v17, 0xffff0000, v61
    v_fmac_f32 v66, v15, v16
    v_fmac_f32 v67, v15, v17
    v_lshlrev_b32 v16, 16, v62
    v_and_b32 v17, 0xffff0000, v62
    v_fmac_f32 v68, v15, v16
    v_fmac_f32 v69, v15, v17
    v_lshlrev_b32 v16, 16, v63
    v_and_b32 v17, 0xffff0000, v63
    v_fmac_f32 v70, v15, v16
    v_fmac_f32 v71, v15, v17
    v_add_f32_dpp v72, v64, v64 row_ror:4 row_mask:0xf bank_mask:0xf
    v_add_f32_dpp v73, v65, v65 row_ror:4 row_mask:0xf bank_mask:0xf
    v_add_f32_dpp v74, v66, v66 row_ror:4 row_mask:0xf bank_mask:0xf
    v_add_f32_dpp v75, v67, v67 row_ror:4 row_mask:0xf bank_mask:0xf
    v_add_f32_dpp v76, v68, v68 row_ror:4 row_mask:0xf bank_mask:0xf
    v_add_f32_dpp v77, v69, v69 row_ror:4 row_mask:0xf bank_mask:0xf
    v_add_f32_dpp v78, v70, v70 row_ror:4 row_mask:0xf bank_mask:0xf
    v_add_f32_dpp v79, v71, v71 row_ror:4 row_mask:0xf bank_mask:0xf
    v_add_f32_dpp v64, v72, v72 row_ror:8 row_mask:0xf bank_mask:0xf
    v_add_f32_dpp v65, v73, v73 row_ror:8 row_mask:0xf bank_mask:0xf
    v_add_f32_dpp v66, v74, v74 row_ror:8 row_mask:0xf bank_mask:0xf
    v_add_f32_dpp v67, v75, v75 row_ror:8 row_mask:0xf bank_mask:0xf
    v_add_f32_dpp v68, v76, v76 row_ror:8 row_mask:0xf bank_mask:0xf
    v_add_f32_dpp v69, v77, v77 row_ror:8 row_mask:0xf bank_mask:0xf
    v_add_f32_dpp v70, v78, v78 row_ror:8 row_mask:0xf bank_mask:0xf
    v_add_f32_dpp v71, v79, v79 row_ror:8 row_mask:0xf bank_mask:0xf
    ds_swizzle_b32 v72, v64 offset:0x401F
    ds_swizzle_b32 v73, v65 offset:0x401F
    ds_swizzle_b32 v74, v66 offset:0x401F
    ds_swizzle_b32 v75, v67 offset:0x401F
    ds_swizzle_b32 v76, v68 offset:0x401F
    ds_swizzle_b32 v77, v69 offset:0x401F
    ds_swizzle_b32 v78, v70 offset:0x401F
    ds_swizzle_b32 v79, v71 offset:0x401F
    s_waitcnt lgkmcnt(7)
    v_add_f32 v64, v64, v72
    s_waitcnt lgkmcnt(6)
    v_add_f32 v65, v65, v73
    s_waitcnt lgkmcnt(5)
    v_add_f32 v66, v66, v74
    s_waitcnt lgkmcnt(4)
    v_add_f32 v67, v67, v75
    s_waitcnt lgkmcnt(3)
    v_add_f32 v68, v68, v76
    s_waitcnt lgkmcnt(2)
    v_add_f32 v69, v69, v77
    s_waitcnt lgkmcnt(1)
    v_add_f32 v70, v70, v78
    s_waitcnt lgkmcnt(0)
    v_add_f32 v71, v71, v79
    v_mov_b32 v72, v64
    v_mov_b32 v73, v65
    v_mov_b32 v74, v66
    v_mov_b32 v75, v67
    v_mov_b32 v76, v68
    v_mov_b32 v77, v69
    v_mov_b32 v78, v70
    v_mov_b32 v79, v71
    v_permlane32_swap_b32 v64, v72
    v_permlane32_swap_b32 v65, v73
    v_permlane32_swap_b32 v66, v74
    v_permlane32_swap_b32 v67, v75
    v_permlane32_swap_b32 v68, v76
    v_permlane32_swap_b32 v69, v77
    v_permlane32_swap_b32 v70, v78
    v_permlane32_swap_b32 v71, v79
    v_add_f32 v64, v64, v72
    v_add_f32 v65, v65, v73
    v_add_f32 v66, v66, v74
    v_add_f32 v67, v67, v75
    v_add_f32 v68, v68, v76
    v_add_f32 v69, v69, v77
    v_add_f32 v70, v70, v78
    v_add_f32 v71, v71, v79
    v_lshlrev_b32 v7, 7, v2
    v_lshl_add_u32 v7, v3, 5, v7
    ds_write_b128 v7, v[64:67]
    ds_write_b128 v7, v[68:71] offset:16
    s_waitcnt lgkmcnt(0)
    s_barrier
    v_and_b32 v7, 31, v0
    v_lshlrev_b32 v7, 2, v7
    ds_read_b32 v72, v7 offset:0
    ds_read_b32 v73, v7 offset:128
    ds_read_b32 v74, v7 offset:256
    ds_read_b32 v75, v7 offset:384
    ds_read_b32 v76, v7 offset:512
    ds_read_b32 v77, v7 offset:640
    ds_read_b32 v78, v7 offset:768
    ds_read_b32 v79, v7 offset:896
    s_waitcnt lgkmcnt(6)
    v_add_f32 v72, v72, v73
    s_waitcnt lgkmcnt(5)
    v_add_f32 v72, v72, v74
    s_waitcnt lgkmcnt(4)
    v_add_f32 v72, v72, v75
    s_waitcnt lgkmcnt(3)
    v_add_f32 v72, v72, v76
    s_waitcnt lgkmcnt(2)
    v_add_f32 v72, v72, v77
    s_waitcnt lgkmcnt(1)
    v_add_f32 v72, v72, v78
    s_waitcnt lgkmcnt(0)
    v_add_f32 v72, v72, v79
    v_cvt_pk_bf16_f32 v74, v72, v72
    v_lshlrev_b32 v72, 16, v74
    v_and_b32 v73, 0xffff0000, v74
    s_lshl_b32 s25, s2, 7
    v_add_u32 v7, s25, v7
    buffer_store_dword v72, v7, s[20:23], 0 offen
mod_kernel_end:
    s_endpgm
.section .rodata,"a"
.p2align 6
.amdhsa_kernel mod_kernel
  .amdhsa_next_free_vgpr 80
  .amdhsa_next_free_sgpr 40
  .amdhsa_accum_offset 80
  .amdhsa_group_segment_fixed_size 0
  .amdhsa_kernarg_size 112
  .amdhsa_user_sgpr_count 2
  .amdhsa_user_sgpr_kernarg_segment_ptr 1
  .amdhsa_system_sgpr_workgroup_id_x 1
.end_amdhsa_kernel

.text
.globl ln1_kernel
.p2align 8
.type ln1_kernel,@function
ln1_kernel:
    s_cmp_ge_u32 s2, 512
    s_cbranch_scc1 ln1_kernel_end
    s_load_dwordx2 s[4:5], s[0:1], 0
    s_load_dwordx2 s[8:9], s[0:1], 104
    v_and_b32 v1, 63, v0
    v_lshrrev_b32 v2, 6, v0
    s_lshl_b32 s3, s2, 2
    v_add_u32 v2, s3, v2
    v_lshlrev_b32 v2, 11, v2
    v_lshl_add_u32 v2, v1, 4, v2
    v_lshlrev_b32 v3, 5, v1
    s_waitcnt lgkmcnt(0)
    s_mov_b32 s12, s4
    s_mov_b32 s13, s5
    s_mov_b32 s14, 0x400000
    s_mov_b32 s15, 0x00020000
    s_add_u32 s16, s8, 0x100000
    s_addc_u32 s17, s9, 0
    s_mov_b32 s18, 0x400000
    s_mov_b32 s19, 0x00020000
    s_mov_b32 s20, s8
    s_mov_b32 s21, s9
    s_mov_b32 s22, 0x6000
    s_mov_b32 s23, 0x00020000
    buffer_load_dwordx4 v[8:11], v2, s[12:15], 0 offen
    buffer_load_dwordx4 v[12:15], v2, s[12:15], 0 offen offset:1024
    s_mov_b32 s24, 4096
    s_mov_b32 s25, 0
    buffer_load_dwordx4 v[32:35], v3, s[20:23], s24 offen
    buffer_load_dwordx4 v[36:39], v3, s[20:23], s24 offen offset:16
    buffer_load_dwordx4 v[40:43], v3, s[20:23], s24 offen offset:2048
    buffer_load_dwordx4 v[44:47], v3, s[20:23], s24 offen offset:2064
    buffer_load_dwordx4 v[48:51], v3, s[20:23], s25 offen
    buffer_load_dwordx4 v[52:55], v3, s[20:23], s25 offen offset:16
    buffer_load_dwordx4 v[56:59], v3, s[20:23], s25 offen offset:2048
    buffer_load_dwordx4 v[60:63], v3, s[20:23], s25 offen offset:2064
    s_waitcnt vmcnt(9)
    v_lshlrev_b32 v16, 16, v8
    v_and_b32 v17, 0xffff0000, v8
    v_lshlrev_b32 v18, 16, v9
    v_and_b32 v19, 0xffff0000, v9
    v_lshlrev_b32 v20, 16, v10
    v_and_b32 v21, 0xffff0000, v10
    v_lshlrev_b32 v22, 16, v11
    v_and_b32 v23, 0xffff0000, v11
    s_waitcnt vmcnt(8)
    v_lshlrev_b32 v24, 16, v12
    v_and_b32 v25, 0xffff0000, v12
    v_lshlrev_b32 v26, 16, v13
    v_and_b32 v27, 0xffff0000, v13
    v_lshlrev_b32 v28, 16, v14
    v_and_b32 v29, 0xffff0000, v14
    v_lshlrev_b32 v30, 16, v15
    v_and_b32 v31, 0xffff0000, v15
    v_add_f32 v4, v16, v17
    v_add_f32 v4, v4, v18
    v_add_f32 v4, v4, v19
    v_add_f32 v4, v4, v20
    v_add_f32 v4, v4, v21
    v_add_f32 v4, v4, v22
    v_add_f32 v4, v4, v23
    v_add_f32 v4, v4, v24
    v_add_f32 v4, v4, v25
    v_add_f32 v4, v4, v26
    v_add_f32 v4, v4, v27
    v_add_f32 v4, v4, v28
    v_add_f32 v4, v4, v29
    v_add_f32 v4, v4, v30
    v_add_f32 v4, v4, v31
    s_nop 1
    v_add_f32_dpp v5, v4, v4 quad_perm:[1,0,3,2] row_mask:0xf bank_mask:0xf
    s_nop 1
    v_add_f32_dpp v4, v5, v5 quad_perm:[2,3,0,1] row_mask:0xf bank_mask:0xf
    s_nop 1
    v_add_f32_dpp v5, v4, v4 row_half_mirror row_mask:0xf bank_mask:0xf
    s_nop 1
    v_add_f32_dpp v4, v5, v5 row_mirror row_mask:0xf bank_mask:0xf
    ds_swizzle_b32 v5, v4 offset:0x401F
    s_waitcnt lgkmcnt(0)
    v_add_f32 v4, v4, v5
    v_mov_b32 v5, v4
    s_nop 1
    v_permlane32_swap_b32 v4, v5
    v_add_f32 v4, v4, v5
    v_mul_f32 v4, 0x3a800000, v4
    v_sub_f32 v6, v16, v4
    v_mul_f32 v7, v6, v6
    v_sub_f32 v6, v17, v4
    v_fmac_f32 v7, v6, v6
    v_sub_f32 v6, v18, v4
    v_fmac_f32 v7, v6, v6
    v_sub_f32 v6, v19, v4
    v_fmac_f32 v7, v6, v6
    v_sub_f32 v6, v20, v4
    v_fmac_f32 v7, v6, v6
    v_sub_f32 v6, v21, v4
    v_fmac_f32 v7, v6, v6
    v_sub_f32 v6, v22, v4
    v_fmac_f32 v7, v6, v6
    v_sub_f32 v6, v23, v4
    v_fmac_f32 v7, v6, v6
    v_sub_f32 v6, v24, v4
    v_fmac_f32 v7, v6, v6
    v_sub_f32 v6, v25, v4
    v_fmac_f32 v7, v6, v6
    v_sub_f32 v6, v26, v4
    v_fmac_f32 v7, v6, v6
    v_sub_f32 v6, v27, v4
    v_fmac_f32 v7, v6, v6
    v_sub_f32 v6, v28, v4
    v_fmac_f32 v7, v6, v6
    v_sub_f32 v6, v29, v4
    v_fmac_f32 v7, v6, v6
    v_sub_f32 v6, v30, v4
    v_fmac_f32 v7, v6, v6
    v_sub_f32 v6, v31, v4
    v_fmac_f32 v7, v6, v6
    s_nop 1
    v_add_f32_dpp v5, v7, v7 quad_perm:[1,0,3,2] row_mask:0xf bank_mask:0xf
    s_nop 1
    v_add_f32_dpp v7, v5, v5 quad_perm:[2,3,0,1] row_mask:0xf bank_mask:0xf
    s_nop 1
    v_add_f32_dpp v5, v7, v7 row_half_mirror row_mask:0xf bank_mask:0xf
    s_nop 1
    v_add_f32_dpp v7, v5, v5 row_mirror row_mask:0xf bank_mask:0xf
    ds_swizzle_b32 v5, v7 offset:0x401F
    s_waitcnt lgkmcnt(0)
    v_add_f32 v7, v7, v5
    v_mov_b32 v5, v7
    s_nop 1
    v_permlane32_swap_b32 v7, v5
    v_add_f32 v7, v7, v5
    v_mul_f32 v7, 0x3a800000, v7
    v_cvt_pk_bf16_f32 v5, v4, v7
    v_lshlrev_b32 v4, 16, v5
    v_and_b32 v7, 0xffff0000, v5
    v_add_f32 v7, 0x3727c5ac, v7
    v_cvt_pk_bf16_f32 v5, v7, v7
    v_lshlrev_b32 v7, 16, v5
    v_and_b32 v6, 0xffff0000, v5
    v_sqrt_f32 v7, v7
    s_nop 0
    v_cvt_pk_bf16_f32 v5, v7, v7
    v_lshlrev_b32 v7, 16, v5
    v_and_b32 v6, 0xffff0000, v5
    v_rcp_f32 v7, v7
    v_sub_f32 v16, v16, v4
    v_sub_f32 v17, v17, v4
    v_cvt_pk_bf16_f32 v5, v16, v17
    v_lshlrev_b32 v16, 16, v5
    v_and_b32 v17, 0xffff0000, v5
    v_mul_f32 v16, v16, v7
    v_mul_f32 v17, v17, v7
    v_cvt_pk_bf16_f32 v5, v16, v17
    v_lshlrev_b32 v16, 16, v5
    v_and_b32 v17, 0xffff0000, v5
    s_waitcnt vmcnt(7)
    v_add_f32 v32, 1.0, v32
    v_add_f32 v33, 1.0, v33
    v_cvt_pk_bf16_f32 v5, v32, v33
    v_lshlrev_b32 v32, 16, v5
    v_and_b32 v33, 0xffff0000, v5
    v_mul_f32 v16, v16, v32
    v_mul_f32 v17, v17, v33
    v_cvt_pk_bf16_f32 v5, v16, v17
    v_lshlrev_b32 v16, 16, v5
    v_and_b32 v17, 0xffff0000, v5
    s_waitcnt vmcnt(3)
    v_add_f32 v16, v16, v48
    v_add_f32 v17, v17, v49
    v_cvt_pk_bf16_f32 v8, v16, v17
    v_sub_f32 v18, v18, v4
    v_sub_f32 v19, v19, v4
    v_cvt_pk_bf16_f32 v5, v18, v19
    v_lshlrev_b32 v18, 16, v5
    v_and_b32 v19, 0xffff0000, v5
    v_mul_f32 v18, v18, v7
    v_mul_f32 v19, v19, v7
    v_cvt_pk_bf16_f32 v5, v18, v19
    v_lshlrev_b32 v18, 16, v5
    v_and_b32 v19, 0xffff0000, v5
    v_add_f32 v34, 1.0, v34
    v_add_f32 v35, 1.0, v35
    v_cvt_pk_bf16_f32 v5, v34, v35
    v_lshlrev_b32 v34, 16, v5
    v_and_b32 v35, 0xffff0000, v5
    v_mul_f32 v18, v18, v34
    v_mul_f32 v19, v19, v35
    v_cvt_pk_bf16_f32 v5, v18, v19
    v_lshlrev_b32 v18, 16, v5
    v_and_b32 v19, 0xffff0000, v5
    v_add_f32 v18, v18, v50
    v_add_f32 v19, v19, v51
    v_cvt_pk_bf16_f32 v9, v18, v19
    v_sub_f32 v20, v20, v4
    v_sub_f32 v21, v21, v4
    v_cvt_pk_bf16_f32 v5, v20, v21
    v_lshlrev_b32 v20, 16, v5
    v_and_b32 v21, 0xffff0000, v5
    v_mul_f32 v20, v20, v7
    v_mul_f32 v21, v21, v7
    v_cvt_pk_bf16_f32 v5, v20, v21
    v_lshlrev_b32 v20, 16, v5
    v_and_b32 v21, 0xffff0000, v5
    v_add_f32 v36, 1.0, v36
    v_add_f32 v37, 1.0, v37
    v_cvt_pk_bf16_f32 v5, v36, v37
    v_lshlrev_b32 v36, 16, v5
    v_and_b32 v37, 0xffff0000, v5
    v_mul_f32 v20, v20, v36
    v_mul_f32 v21, v21, v37
    v_cvt_pk_bf16_f32 v5, v20, v21
    v_lshlrev_b32 v20, 16, v5
    v_and_b32 v21, 0xffff0000, v5
    s_waitcnt vmcnt(2)
    v_add_f32 v20, v20, v52
    v_add_f32 v21, v21, v53
    v_cvt_pk_bf16_f32 v10, v20, v21
    v_sub_f32 v22, v22, v4
    v_sub_f32 v23, v23, v4
    v_cvt_pk_bf16_f32 v5, v22, v23
    v_lshlrev_b32 v22, 16, v5
    v_and_b32 v23, 0xffff0000, v5
    v_mul_f32 v22, v22, v7
    v_mul_f32 v23, v23, v7
    v_cvt_pk_bf16_f32 v5, v22, v23
    v_lshlrev_b32 v22, 16, v5
    v_and_b32 v23, 0xffff0000, v5
    v_add_f32 v38, 1.0, v38
    v_add_f32 v39, 1.0, v39
    v_cvt_pk_bf16_f32 v5, v38, v39
    v_lshlrev_b32 v38, 16, v5
    v_and_b32 v39, 0xffff0000, v5
    v_mul_f32 v22, v22, v38
    v_mul_f32 v23, v23, v39
    v_cvt_pk_bf16_f32 v5, v22, v23
    v_lshlrev_b32 v22, 16, v5
    v_and_b32 v23, 0xffff0000, v5
    v_add_f32 v22, v22, v54
    v_add_f32 v23, v23, v55
    v_cvt_pk_bf16_f32 v11, v22, v23
    v_sub_f32 v24, v24, v4
    v_sub_f32 v25, v25, v4
    v_cvt_pk_bf16_f32 v5, v24, v25
    v_lshlrev_b32 v24, 16, v5
    v_and_b32 v25, 0xffff0000, v5
    v_mul_f32 v24, v24, v7
    v_mul_f32 v25, v25, v7
    v_cvt_pk_bf16_f32 v5, v24, v25
    v_lshlrev_b32 v24, 16, v5
    v_and_b32 v25, 0xffff0000, v5
    v_add_f32 v40, 1.0, v40
    v_add_f32 v41, 1.0, v41
    v_cvt_pk_bf16_f32 v5, v40, v41
    v_lshlrev_b32 v40, 16, v5
    v_and_b32 v41, 0xffff0000, v5
    v_mul_f32 v24, v24, v40
    v_mul_f32 v25, v25, v41
    v_cvt_pk_bf16_f32 v5, v24, v25
    v_lshlrev_b32 v24, 16, v5
    v_and_b32 v25, 0xffff0000, v5
    s_waitcnt vmcnt(1)
    v_add_f32 v24, v24, v56
    v_add_f32 v25, v25, v57
    v_cvt_pk_bf16_f32 v12, v24, v25
    v_sub_f32 v26, v26, v4
    v_sub_f32 v27, v27, v4
    v_cvt_pk_bf16_f32 v5, v26, v27
    v_lshlrev_b32 v26, 16, v5
    v_and_b32 v27, 0xffff0000, v5
    v_mul_f32 v26, v26, v7
    v_mul_f32 v27, v27, v7
    v_cvt_pk_bf16_f32 v5, v26, v27
    v_lshlrev_b32 v26, 16, v5
    v_and_b32 v27, 0xffff0000, v5
    v_add_f32 v42, 1.0, v42
    v_add_f32 v43, 1.0, v43
    v_cvt_pk_bf16_f32 v5, v42, v43
    v_lshlrev_b32 v42, 16, v5
    v_and_b32 v43, 0xffff0000, v5
    v_mul_f32 v26, v26, v42
    v_mul_f32 v27, v27, v43
    v_cvt_pk_bf16_f32 v5, v26, v27
    v_lshlrev_b32 v26, 16, v5
    v_and_b32 v27, 0xffff0000, v5
    v_add_f32 v26, v26, v58
    v_add_f32 v27, v27, v59
    v_cvt_pk_bf16_f32 v13, v26, v27
    v_sub_f32 v28, v28, v4
    v_sub_f32 v29, v29, v4
    v_cvt_pk_bf16_f32 v5, v28, v29
    v_lshlrev_b32 v28, 16, v5
    v_and_b32 v29, 0xffff0000, v5
    v_mul_f32 v28, v28, v7
    v_mul_f32 v29, v29, v7
    v_cvt_pk_bf16_f32 v5, v28, v29
    v_lshlrev_b32 v28, 16, v5
    v_and_b32 v29, 0xffff0000, v5
    v_add_f32 v44, 1.0, v44
    v_add_f32 v45, 1.0, v45
    v_cvt_pk_bf16_f32 v5, v44, v45
    v_lshlrev_b32 v44, 16, v5
    v_and_b32 v45, 0xffff0000, v5
    v_mul_f32 v28, v28, v44
    v_mul_f32 v29, v29, v45
    v_cvt_pk_bf16_f32 v5, v28, v29
    v_lshlrev_b32 v28, 16, v5
    v_and_b32 v29, 0xffff0000, v5
    s_waitcnt vmcnt(0)
    v_add_f32 v28, v28, v60
    v_add_f32 v29, v29, v61
    v_cvt_pk_bf16_f32 v14, v28, v29
    v_sub_f32 v30, v30, v4
    v_sub_f32 v31, v31, v4
    v_cvt_pk_bf16_f32 v5, v30, v31
    v_lshlrev_b32 v30, 16, v5
    v_and_b32 v31, 0xffff0000, v5
    v_mul_f32 v30, v30, v7
    v_mul_f32 v31, v31, v7
    v_cvt_pk_bf16_f32 v5, v30, v31
    v_lshlrev_b32 v30, 16, v5
    v_and_b32 v31, 0xffff0000, v5
    v_add_f32 v46, 1.0, v46
    v_add_f32 v47, 1.0, v47
    v_cvt_pk_bf16_f32 v5, v46, v47
    v_lshlrev_b32 v46, 16, v5
    v_and_b32 v47, 0xffff0000, v5
    v_mul_f32 v30, v30, v46
    v_mul_f32 v31, v31, v47
    v_cvt_pk_bf16_f32 v5, v30, v31
    v_lshlrev_b32 v30, 16, v5
    v_and_b32 v31, 0xffff0000, v5
    v_add_f32 v30, v30, v62
    v_add_f32 v31, v31, v63
    v_cvt_pk_bf16_f32 v15, v30, v31
    buffer_store_dwordx4 v[8:11], v2, s[16:19], 0 offen
    buffer_store_dwordx4 v[12:15], v2, s[16:19], 0 offen offset:1024
ln1_kernel_end:
    s_endpgm
.section .rodata,"a"
.p2align 6
.amdhsa_kernel ln1_kernel
  .amdhsa_next_free_vgpr 64
  .amdhsa_next_free_sgpr 40
  .amdhsa_accum_offset 64
  .amdhsa_group_segment_fixed_size 0
  .amdhsa_kernarg_size 112
  .amdhsa_user_sgpr_count 2
  .amdhsa_user_sgpr_kernarg_segment_ptr 1
  .amdhsa_system_sgpr_workgroup_id_x 1
.end_amdhsa_kernel

.text
.globl attn_kernel
.p2align 8
.type attn_kernel,@function
attn_kernel:
    s_cmp_ge_u32 s2, 256
    s_cbranch_scc1 attn_kernel_end
    s_load_dwordx2 s[4:5], s[0:1], 104
    s_load_dwordx2 s[6:7], s[0:1], 8
    s_load_dwordx2 s[8:9], s[0:1], 16
    s_load_dwordx2 s[10:11], s[0:1], 24
    v_and_b32 v1, 63, v0
    v_lshrrev_b32 v2, 6, v0
    s_nop 0
    v_readfirstlane_b32 s28, v2
    s_and_b32 s36, s2, 7
    s_lshr_b32 s37, s2, 3
    s_lshr_b32 s38, s36, 1
    s_and_b32 s39, s36, 1
    s_lshl_b32 s39, s39, 5
    s_add_u32 s39, s39, s37
    s_lshr_b32 s40, s39, 3
    s_lshl_b32 s41, s38, 3
    s_add_u32 s40, s40, s41
    s_and_b32 s39, s39, 7
    s_lshl_b32 s29, s38, 19
    s_mov_b32 s30, s29
    s_mov_b32 s34, 0x3e0293ee
    s_mov_b32 s35, 0x437af233
    s_waitcnt lgkmcnt(0)
    s_add_u32 s12, s4, 0x500000
    s_addc_u32 s13, s5, 0
    s_mov_b32 s14, 0x1000000
    s_mov_b32 s15, 0x00020000
    s_add_u32 s24, s4, 0x1500000
    s_addc_u32 s25, s5, 0
    s_mov_b32 s26, 0x1000000
    s_mov_b32 s27, 0x00020000
    s_mov_b32 s16, s6
    s_mov_b32 s17, s7
    s_mov_b32 s18, 0x200000
    s_mov_b32 s19, 0x00020000
    s_mov_b32 s20, s8
    s_mov_b32 s21, s9
    s_mov_b32 s22, 0x200000
    s_mov_b32 s23, 0x00020000
    s_lshl_b32 s39, s39, 8
    s_lshl_b32 s41, s28, 5
    s_add_u32 s39, s39, s41
    s_lshl_b32 s40, s40, 8
    v_and_b32 v2, 31, v1
    v_add_u32 v3, s39, v2
    v_lshlrev_b32 v3, 13, v3
    v_add_u32 v3, s40, v3
    v_lshrrev_b32 v4, 5, v1
    v_lshl_add_u32 v28, v4, 4, v3
    v_lshrrev_b32 v5, 4, v1
    s_lshl_b32 s36, s28, 3
    v_add_u32 v5, s36, v5
    v_and_b32 v6, 15, v1
    v_add_u32 v7, 0, v5
    v_and_b32 v8, 15, v7
    v_xor_b32 v8, v8, v6
    v_lshlrev_b32 v7, 8, v5
    v_lshl_add_u32 v22, v8, 4, v7
    v_add_u32 v7, 4, v5
    v_and_b32 v8, 15, v7
    v_xor_b32 v8, v8, v6
    v_lshlrev_b32 v7, 8, v5
    v_lshl_add_u32 v23, v8, 4, v7
    v_and_b32 v8, 3, v5
    v_lshlrev_b32 v8, 2, v8
    v_xor_b32 v8, v8, v6
    v_lshlrev_b32 v7, 8, v5
    v_lshl_add_u32 v24, v8, 4, v7
    s_lshl_b32 s32, s28, 11
    s_add_u32 s33, s32, 98304
    s_add_u32 s32, s32, 32768
    v_and_b32 v6, 15, v1
    v_xor_b32 v6, v6, v4
    v_lshlrev_b32 v6, 4, v6
    v_lshl_add_u32 v6, v2, 8, v6
    v_add_u32 v6, 32768, v6
    v_xor_b32 v10, 0, v6
    v_xor_b32 v11, 32, v6
    v_xor_b32 v12, 64, v6
    v_xor_b32 v13, 96, v6
    v_xor_b32 v14, 128, v6
    v_xor_b32 v15, 160, v6
    v_xor_b32 v16, 192, v6
    v_xor_b32 v17, 224, v6
    v_bfe_u32 v5, v1, 2, 2
    v_and_b32 v6, 3, v1
    v_bfe_u32 v7, v1, 4, 1
    v_lshl_add_u32 v8, v4, 2, v5
    v_lshlrev_b32 v8, 8, v8
    v_and_b32 v9, 1, v6
    v_lshl_add_u32 v8, v9, 3, v8
    v_add_u32 v8, 0x18000, v8
    v_lshrrev_b32 v6, 1, v6
    v_lshl_add_u32 v6, v7, 1, v6
    v_xor_b32 v7, 0, v5
    v_lshl_add_u32 v7, v7, 2, v6
    v_lshl_add_u32 v18, v7, 4, v8
    v_xor_b32 v7, 1, v5
    v_lshl_add_u32 v7, v7, 2, v6
    v_lshl_add_u32 v19, v7, 4, v8
    v_xor_b32 v7, 2, v5
    v_lshl_add_u32 v7, v7, 2, v6
    v_lshl_add_u32 v20, v7, 4, v8
    v_xor_b32 v7, 3, v5
    v_lshl_add_u32 v7, v7, 2, v6
    v_lshl_add_u32 v21, v7, 4, v8
    s_add_u32 s44, s4, 0x100000
    s_addc_u32 s45, s5, 0
    s_mov_b32 s46, 0x400000
    s_mov_b32 s47, 0x00020000
    s_mov_b32 s48, s10
    s_mov_b32 s49, s11
    s_mov_b32 s50, 0x800000
    s_mov_b32 s51, 0x00020000
    s_lshl_b32 s41, s28, 5
    s_sub_u32 s41, s39, s41
    s_lshl_b32 s36, s28, 5
    v_lshrrev_b32 v5, 3, v1
    v_add_u32 v5, s36, v5
    v_and_b32 v6, 7, v1
    v_add_u32 v7, 0, v5
    v_bfe_u32 v8, v7, 1, 3
    v_xor_b32 v8, v8, v6
    v_add_u32 v7, s41, v7
    v_lshlrev_b32 v7, 11, v7
    v_lshl_add_u32 v68, v8, 4, v7
    v_add_u32 v7, 8, v5
    v_bfe_u32 v8, v7, 1, 3
    v_xor_b32 v8, v8, v6
    v_add_u32 v7, s41, v7
    v_lshlrev_b32 v7, 11, v7
    v_lshl_add_u32 v69, v8, 4, v7
    v_subrev_u32 v69, 1024, v69
    v_add_u32 v7, 16, v5
    v_bfe_u32 v8, v7, 1, 3
    v_xor_b32 v8, v8, v6
    v_add_u32 v7, s41, v7
    v_lshlrev_b32 v7, 11, v7
    v_lshl_add_u32 v70, v8, 4, v7
    v_subrev_u32 v70, 2048, v70
    v_add_u32 v7, 24, v5
    v_bfe_u32 v8, v7, 1, 3
    v_xor_b32 v8, v8, v6
    v_add_u32 v7, s41, v7
    v_lshlrev_b32 v7, 11, v7
    v_lshl_add_u32 v71, v8, 4, v7
    v_subrev_u32 v71, 3072, v71
    s_lshl_b32 s36, s28, 3
    v_lshrrev_b32 v5, 4, v1
    v_add_u32 v5, s36, v5
    v_and_b32 v6, 15, v1
    v_and_b32 v8, 3, v5
    v_lshlrev_b32 v8, 2, v8
    v_xor_b32 v8, v8, v6
    v_add_u32 v7, 0, v5
    v_lshlrev_b32 v7, 13, v7
    v_lshl_add_u32 v72, v8, 4, v7
    v_add_u32 v72, s40, v72
    v_add_u32 v7, 4, v5
    v_lshlrev_b32 v7, 13, v7
    v_lshl_add_u32 v73, v8, 4, v7
    v_add_u32 v73, s40, v73
    v_subrev_u32 v73, 1024, v73
    s_lshl_b32 s54, s28, 12
    s_lshl_b32 s55, s28, 11
    s_add_u32 s55, s55, 32768
    s_mov_b32 s52, 0
    s_mov_b32 s53, 0
    s_add_u32 m0, s54, 0
    s_nop 0
    buffer_load_dwordx4 v68, s[44:47], s52 offen offset:0 lds
    buffer_load_dwordx4 v69, s[44:47], s52 offen offset:1024 lds
    buffer_load_dwordx4 v70, s[44:47], s52 offen offset:2048 lds
    buffer_load_dwordx4 v71, s[44:47], s52 offen offset:3072 lds
    s_add_u32 m0, s55, 0
    s_nop 0
    buffer_load_dwordx4 v72, s[48:51], s53 offen offset:0 lds
    buffer_load_dwordx4 v73, s[48:51], s53 offen offset:1024 lds
    s_add_u32 s52, s52, 128
    s_add_u32 s53, s53, 524288
    s_add_u32 m0, s54, 49152
    s_nop 0
    buffer_load_dwordx4 v68, s[44:47], s52 offen offset:0 lds
    buffer_load_dwordx4 v69, s[44:47], s52 offen offset:1024 lds
    buffer_load_dwordx4 v70, s[44:47], s52 offen offset:2048 lds
    buffer_load_dwordx4 v71, s[44:47], s52 offen offset:3072 lds
    s_add_u32 m0, s55, 49152
    s_nop 0
    buffer_load_dwordx4 v72, s[48:51], s53 offen offset:0 lds
    buffer_load_dwordx4 v73, s[48:51], s53 offen offset:1024 lds
    s_add_u32 s52, s52, 128
    s_add_u32 s53, s53, 524288
    s_add_u32 m0, s54, 98304
    s_nop 0
    buffer_load_dwordx4 v68, s[44:47], s52 offen offset:0 lds
    buffer_load_dwordx4 v69, s[44:47], s52 offen offset:1024 lds
    buffer_load_dwordx4 v70, s[44:47], s52 offen offset:2048 lds
    buffer_load_dwordx4 v71, s[44:47], s52 offen offset:3072 lds
    s_add_u32 m0, s55, 98304
    s_nop 0
    buffer_load_dwordx4 v72, s[48:51], s53 offen offset:0 lds
    buffer_load_dwordx4 v73, s[48:51], s53 offen offset:1024 lds
    s_add_u32 s52, s52, 128
    s_add_u32 s53, s53, 524288
    s_lshl_b32 s36, s28, 5
    v_add_u32 v5, s36, v2
    v_bfe_u32 v6, v5, 1, 3
    v_xor_b32 v6, v6, v4
    v_lshlrev_b32 v6, 4, v6
    v_lshl_add_u32 v6, v5, 7, v6
    v_xor_b32 v84, 0, v6
    v_add_u32 v88, 49152, v84
    v_add_u32 v92, 98304, v84
    v_xor_b32 v85, 32, v6
    v_add_u32 v89, 49152, v85
    v_add_u32 v93, 98304, v85
    v_xor_b32 v86, 64, v6
    v_add_u32 v90, 49152, v86
    v_add_u32 v94, 98304, v86
    v_xor_b32 v87, 96, v6
    v_add_u32 v91, 49152, v87
    v_add_u32 v95, 98304, v87
    v_bfe_u32 v5, v1, 2, 2
    v_and_b32 v6, 3, v1
    v_bfe_u32 v7, v1, 4, 1
    v_lshl_add_u32 v8, v4, 3, v5
    v_lshlrev_b32 v8, 8, v8
    v_and_b32 v9, 1, v6
    v_lshl_add_u32 v8, v9, 3, v8
    v_add_u32 v8, 32768, v8
    v_lshrrev_b32 v6, 1, v6
    v_lshl_add_u32 v6, v7, 1, v6
    v_xor_b32 v7, 0, v5
    v_lshl_add_u32 v7, v7, 2, v6
    v_lshl_add_u32 v96, v7, 4, v8
    v_add_u32 v100, 49152, v96
    v_add_u32 v104, 98304, v96
    v_xor_b32 v7, 1, v5
    v_lshl_add_u32 v7, v7, 2, v6
    v_lshl_add_u32 v97, v7, 4, v8
    v_add_u32 v101, 49152, v97
    v_add_u32 v105, 98304, v97
    v_xor_b32 v7, 2, v5
    v_lshl_add_u32 v7, v7, 2, v6
    v_lshl_add_u32 v98, v7, 4, v8
    v_add_u32 v102, 49152, v98
    v_add_u32 v106, 98304, v98
    v_xor_b32 v7, 3, v5
    v_lshl_add_u32 v7, v7, 2, v6
    v_lshl_add_u32 v99, v7, 4, v8
    v_add_u32 v103, 49152, v99
    v_add_u32 v107, 98304, v99
    v_mov_b32 v172, 0
    v_mov_b32 v173, 0
    v_mov_b32 v174, 0
    v_mov_b32 v175, 0
    v_mov_b32 v176, 0
    v_mov_b32 v177, 0
    v_mov_b32 v178, 0
    v_mov_b32 v179, 0
    v_mov_b32 v180, 0
    v_mov_b32 v181, 0
    v_mov_b32 v182, 0
    v_mov_b32 v183, 0
    v_mov_b32 v184, 0
    v_mov_b32 v185, 0
    v_mov_b32 v186, 0
    v_mov_b32 v187, 0
    v_mov_b32 v188, 0
    v_mov_b32 v189, 0
    v_mov_b32 v190, 0
    v_mov_b32 v191, 0
    v_mov_b32 v192, 0
    v_mov_b32 v193, 0
    v_mov_b32 v194, 0
    v_mov_b32 v195, 0
    v_mov_b32 v196, 0
    v_mov_b32 v197, 0
    v_mov_b32 v198, 0
    v_mov_b32 v199, 0
    v_mov_b32 v200, 0
    v_mov_b32 v201, 0
    v_mov_b32 v202, 0
    v_mov_b32 v203, 0
    v_mov_b32 v204, 0
    v_mov_b32 v205, 0
    v_mov_b32 v206, 0
    v_mov_b32 v207, 0
    v_mov_b32 v208, 0
    v_mov_b32 v209, 0
    v_mov_b32 v210, 0
    v_mov_b32 v211, 0
    v_mov_b32 v212, 0
    v_mov_b32 v213, 0
    v_mov_b32 v214, 0
    v_mov_b32 v215, 0
    v_mov_b32 v216, 0
    v_mov_b32 v217, 0
    v_mov_b32 v218, 0
    v_mov_b32 v219, 0
    v_mov_b32 v220, 0
    v_mov_b32 v221, 0
    v_mov_b32 v222, 0
    v_mov_b32 v223, 0
    v_mov_b32 v224, 0
    v_mov_b32 v225, 0
    v_mov_b32 v226, 0
    v_mov_b32 v227, 0
    v_mov_b32 v228, 0
    v_mov_b32 v229, 0
    v_mov_b32 v230, 0
    v_mov_b32 v231, 0
    v_mov_b32 v232, 0
    v_mov_b32 v233, 0
    v_mov_b32 v234, 0
    v_mov_b32 v235, 0
    s_waitcnt vmcnt(12)
    s_barrier
    ds_read_b128 v[108:111], v84
    ds_read_b64_tr_b16 v[116:117], v96 offset:0
    ds_read_b64_tr_b16 v[118:119], v96 offset:1024
    ds_read_b64_tr_b16 v[120:121], v97 offset:0
    ds_read_b64_tr_b16 v[122:123], v97 offset:1024
    ds_read_b64_tr_b16 v[124:125], v98 offset:0
    ds_read_b64_tr_b16 v[126:127], v98 offset:1024
    ds_read_b64_tr_b16 v[128:129], v99 offset:0
    ds_read_b64_tr_b16 v[130:131], v99 offset:1024
    s_mov_b32 s31, 4
attn_kernel_qloop:
    s_waitcnt lgkmcnt(6)
    v_mfma_f32_32x32x16_bf16 v[172:187], v[116:119], v[108:111], v[172:187]
    ds_read_b128 v[112:115], v85
    ds_read_b64_tr_b16 v[132:133], v96 offset:4096
    ds_read_b64_tr_b16 v[134:135], v96 offset:5120
    s_waitcnt lgkmcnt(7)
    v_mfma_f32_32x32x16_bf16 v[188:203], v[120:123], v[108:111], v[188:203]
    ds_read_b64_tr_b16 v[136:137], v97 offset:4096
    ds_read_b64_tr_b16 v[138:139], v97 offset:5120
    ds_read_b64_tr_b16 v[140:141], v98 offset:4096
    s_waitcnt lgkmcnt(8)
    v_mfma_f32_32x32x16_bf16 v[204:219], v[124:127], v[108:111], v[204:219]
    ds_read_b64_tr_b16 v[142:143], v98 offset:5120
    ds_read_b64_tr_b16 v[144:145], v99 offset:4096
    ds_read_b64_tr_b16 v[146:147], v99 offset:5120
    s_waitcnt lgkmcnt(9)
    v_mfma_f32_32x32x16_bf16 v[220:235], v[128:131], v[108:111], v[220:235]
    s_waitcnt lgkmcnt(6)
    v_mfma_f32_32x32x16_bf16 v[172:187], v[132:135], v[112:115], v[172:187]
    ds_read_b128 v[108:111], v86
    ds_read_b64_tr_b16 v[116:117], v96 offset:8192
    ds_read_b64_tr_b16 v[118:119], v96 offset:9216
    s_waitcnt lgkmcnt(7)
    v_mfma_f32_32x32x16_bf16 v[188:203], v[136:139], v[112:115], v[188:203]
    ds_read_b64_tr_b16 v[120:121], v97 offset:8192
    ds_read_b64_tr_b16 v[122:123], v97 offset:9216
    ds_read_b64_tr_b16 v[124:125], v98 offset:8192
    s_waitcnt lgkmcnt(8)
    v_mfma_f32_32x32x16_bf16 v[204:219], v[140:143], v[112:115], v[204:219]
    ds_read_b64_tr_b16 v[126:127], v98 offset:9216
    ds_read_b64_tr_b16 v[128:129], v99 offset:8192
    ds_read_b64_tr_b16 v[130:131], v99 offset:9216
    s_waitcnt lgkmcnt(9)
    v_mfma_f32_32x32x16_bf16 v[220:235], v[144:147], v[112:115], v[220:235]
    s_waitcnt lgkmcnt(6)
    v_mfma_f32_32x32x16_bf16 v[172:187], v[116:119], v[108:111], v[172:187]
    ds_read_b128 v[112:115], v87
    ds_read_b64_tr_b16 v[132:133], v96 offset:12288
    ds_read_b64_tr_b16 v[134:135], v96 offset:13312
    s_waitcnt lgkmcnt(7)
    v_mfma_f32_32x32x16_bf16 v[188:203], v[120:123], v[108:111], v[188:203]
    ds_read_b64_tr_b16 v[136:137], v97 offset:12288
    ds_read_b64_tr_b16 v[138:139], v97 offset:13312
    ds_read_b64_tr_b16 v[140:141], v98 offset:12288
    s_waitcnt lgkmcnt(8)
    v_mfma_f32_32x32x16_bf16 v[204:219], v[124:127], v[108:111], v[204:219]
    ds_read_b64_tr_b16 v[142:143], v98 offset:13312
    ds_read_b64_tr_b16 v[144:145], v99 offset:12288
    ds_read_b64_tr_b16 v[146:147], v99 offset:13312
    s_waitcnt lgkmcnt(9)
    v_mfma_f32_32x32x16_bf16 v[220:235], v[128:131], v[108:111], v[220:235]
    s_waitcnt vmcnt(6) lgkmcnt(0)
    s_barrier
    v_mfma_f32_32x32x16_bf16 v[172:187], v[132:135], v[112:115], v[172:187]
    ds_read_b128 v[108:111], v88
    ds_read_b64_tr_b16 v[116:117], v100 offset:0
    ds_read_b64_tr_b16 v[118:119], v100 offset:1024
    ds_read_b64_tr_b16 v[120:121], v101 offset:0
    ds_read_b64_tr_b16 v[122:123], v101 offset:1024
    v_mfma_f32_32x32x16_bf16 v[188:203], v[136:139], v[112:115], v[188:203]
    ds_read_b64_tr_b16 v[124:125], v102 offset:0
    ds_read_b64_tr_b16 v[126:127], v102 offset:1024
    ds_read_b64_tr_b16 v[128:129], v103 offset:0
    ds_read_b64_tr_b16 v[130:131], v103 offset:1024
    s_add_u32 m0, s54, 0
    v_mfma_f32_32x32x16_bf16 v[204:219], v[140:143], v[112:115], v[204:219]
    buffer_load_dwordx4 v68, s[44:47], s52 offen offset:0 lds
    buffer_load_dwordx4 v69, s[44:47], s52 offen offset:1024 lds
    buffer_load_dwordx4 v70, s[44:47], s52 offen offset:2048 lds
    buffer_load_dwordx4 v71, s[44:47], s52 offen offset:3072 lds
    s_add_u32 m0, s55, 0
    v_mfma_f32_32x32x16_bf16 v[220:235], v[144:147], v[112:115], v[220:235]
    buffer_load_dwordx4 v72, s[48:51], s53 offen offset:0 lds
    buffer_load_dwordx4 v73, s[48:51], s53 offen offset:1024 lds
    s_add_u32 s52, s52, 128
    s_add_u32 s53, s53, 524288
    s_waitcnt lgkmcnt(6)
    v_mfma_f32_32x32x16_bf16 v[172:187], v[116:119], v[108:111], v[172:187]
    ds_read_b128 v[112:115], v89
    ds_read_b64_tr_b16 v[132:133], v100 offset:4096
    ds_read_b64_tr_b16 v[134:135], v100 offset:5120
    s_waitcnt lgkmcnt(7)
    v_mfma_f32_32x32x16_bf16 v[188:203], v[120:123], v[108:111], v[188:203]
    ds_read_b64_tr_b16 v[136:137], v101 offset:4096
    ds_read_b64_tr_b16 v[138:139], v101 offset:5120
    ds_read_b64_tr_b16 v[140:141], v102 offset:4096
    s_waitcnt lgkmcnt(8)
    v_mfma_f32_32x32x16_bf16 v[204:219], v[124:127], v[108:111], v[204:219]
    ds_read_b64_tr_b16 v[142:143], v102 offset:5120
    ds_read_b64_tr_b16 v[144:145], v103 offset:4096
    ds_read_b64_tr_b16 v[146:147], v103 offset:5120
    s_waitcnt lgkmcnt(9)
    v_mfma_f32_32x32x16_bf16 v[220:235], v[128:131], v[108:111], v[220:235]
    s_waitcnt lgkmcnt(6)
    v_mfma_f32_32x32x16_bf16 v[172:187], v[132:135], v[112:115], v[172:187]
    ds_read_b128 v[108:111], v90
    ds_read_b64_tr_b16 v[116:117], v100 offset:8192
    ds_read_b64_tr_b16 v[118:119], v100 offset:9216
    s_waitcnt lgkmcnt(7)
    v_mfma_f32_32x32x16_bf16 v[188:203], v[136:139], v[112:115], v[188:203]
    ds_read_b64_tr_b16 v[120:121], v101 offset:8192
    ds_read_b64_tr_b16 v[122:123], v101 offset:9216
    ds_read_b64_tr_b16 v[124:125], v102 offset:8192
    s_waitcnt lgkmcnt(8)
    v_mfma_f32_32x32x16_bf16 v[204:219], v[140:143], v[112:115], v[204:219]
    ds_read_b64_tr_b16 v[126:127], v102 offset:9216
    ds_read_b64_tr_b16 v[128:129], v103 offset:8192
    ds_read_b64_tr_b16 v[130:131], v103 offset:9216
    s_waitcnt lgkmcnt(9)
    v_mfma_f32_32x32x16_bf16 v[220:235], v[144:147], v[112:115], v[220:235]
    s_waitcnt lgkmcnt(6)
    v_mfma_f32_32x32x16_bf16 v[172:187], v[116:119], v[108:111], v[172:187]
    ds_read_b128 v[112:115], v91
    ds_read_b64_tr_b16 v[132:133], v100 offset:12288
    ds_read_b64_tr_b16 v[134:135], v100 offset:13312
    s_waitcnt lgkmcnt(7)
    v_mfma_f32_32x32x16_bf16 v[188:203], v[120:123], v[108:111], v[188:203]
    ds_read_b64_tr_b16 v[136:137], v101 offset:12288
    ds_read_b64_tr_b16 v[138:139], v101 offset:13312
    ds_read_b64_tr_b16 v[140:141], v102 offset:12288
    s_waitcnt lgkmcnt(8)
    v_mfma_f32_32x32x16_bf16 v[204:219], v[124:127], v[108:111], v[204:219]
    ds_read_b64_tr_b16 v[142:143], v102 offset:13312
    ds_read_b64_tr_b16 v[144:145], v103 offset:12288
    ds_read_b64_tr_b16 v[146:147], v103 offset:13312
    s_waitcnt lgkmcnt(9)
    v_mfma_f32_32x32x16_bf16 v[220:235], v[128:131], v[108:111], v[220:235]
    s_waitcnt vmcnt(6) lgkmcnt(0)
    s_barrier
    v_mfma_f32_32x32x16_bf16 v[172:187], v[132:135], v[112:115], v[172:187]
    ds_read_b128 v[108:111], v92
    ds_read_b64_tr_b16 v[116:117], v104 offset:0
    ds_read_b64_tr_b16 v[118:119], v104 offset:1024
    ds_read_b64_tr_b16 v[120:121], v105 offset:0
    ds_read_b64_tr_b16 v[122:123], v105 offset:1024
    v_mfma_f32_32x32x16_bf16 v[188:203], v[136:139], v[112:115], v[188:203]
    ds_read_b64_tr_b16 v[124:125], v106 offset:0
    ds_read_b64_tr_b16 v[126:127], v106 offset:1024
    ds_read_b64_tr_b16 v[128:129], v107 offset:0
    ds_read_b64_tr_b16 v[130:131], v107 offset:1024
    s_add_u32 m0, s54, 49152
    v_mfma_f32_32x32x16_bf16 v[204:219], v[140:143], v[112:115], v[204:219]
    buffer_load_dwordx4 v68, s[44:47], s52 offen offset:0 lds
    buffer_load_dwordx4 v69, s[44:47], s52 offen offset:1024 lds
    buffer_load_dwordx4 v70, s[44:47], s52 offen offset:2048 lds
    buffer_load_dwordx4 v71, s[44:47], s52 offen offset:3072 lds
    s_add_u32 m0, s55, 49152
    v_mfma_f32_32x32x16_bf16 v[220:235], v[144:147], v[112:115], v[220:235]
    buffer_load_dwordx4 v72, s[48:51], s53 offen offset:0 lds
    buffer_load_dwordx4 v73, s[48:51], s53 offen offset:1024 lds
    s_add_u32 s52, s52, 128
    s_add_u32 s53, s53, 524288
    s_waitcnt lgkmcnt(6)
    v_mfma_f32_32x32x16_bf16 v[172:187], v[116:119], v[108:111], v[172:187]
    ds_read_b128 v[112:115], v93
    ds_read_b64_tr_b16 v[132:133], v104 offset:4096
    ds_read_b64_tr_b16 v[134:135], v104 offset:5120
    s_waitcnt lgkmcnt(7)
    v_mfma_f32_32x32x16_bf16 v[188:203], v[120:123], v[108:111], v[188:203]
    ds_read_b64_tr_b16 v[136:137], v105 offset:4096
    ds_read_b64_tr_b16 v[138:139], v105 offset:5120
    ds_read_b64_tr_b16 v[140:141], v106 offset:4096
    s_waitcnt lgkmcnt(8)
    v_mfma_f32_32x32x16_bf16 v[204:219], v[124:127], v[108:111], v[204:219]
    ds_read_b64_tr_b16 v[142:143], v106 offset:5120
    ds_read_b64_tr_b16 v[144:145], v107 offset:4096
    ds_read_b64_tr_b16 v[146:147], v107 offset:5120
    s_waitcnt lgkmcnt(9)
    v_mfma_f32_32x32x16_bf16 v[220:235], v[128:131], v[108:111], v[220:235]
    s_waitcnt lgkmcnt(6)
    v_mfma_f32_32x32x16_bf16 v[172:187], v[132:135], v[112:115], v[172:187]
    ds_read_b128 v[108:111], v94
    ds_read_b64_tr_b16 v[116:117], v104 offset:8192
    ds_read_b64_tr_b16 v[118:119], v104 offset:9216
    s_waitcnt lgkmcnt(7)
    v_mfma_f32_32x32x16_bf16 v[188:203], v[136:139], v[112:115], v[188:203]
    ds_read_b64_tr_b16 v[120:121], v105 offset:8192
    ds_read_b64_tr_b16 v[122:123], v105 offset:9216
    ds_read_b64_tr_b16 v[124:125], v106 offset:8192
    s_waitcnt lgkmcnt(8)
    v_mfma_f32_32x32x16_bf16 v[204:219], v[140:143], v[112:115], v[204:219]
    ds_read_b64_tr_b16 v[126:127], v106 offset:9216
    ds_read_b64_tr_b16 v[128:129], v107 offset:8192
    ds_read_b64_tr_b16 v[130:131], v107 offset:9216
    s_waitcnt lgkmcnt(9)
    v_mfma_f32_32x32x16_bf16 v[220:235], v[144:147], v[112:115], v[220:235]
    s_waitcnt lgkmcnt(6)
    v_mfma_f32_32x32x16_bf16 v[172:187], v[116:119], v[108:111], v[172:187]
    ds_read_b128 v[112:115], v95
    ds_read_b64_tr_b16 v[132:133], v104 offset:12288
    ds_read_b64_tr_b16 v[134:135], v104 offset:13312
    s_waitcnt lgkmcnt(7)
    v_mfma_f32_32x32x16_bf16 v[188:203], v[120:123], v[108:111], v[188:203]
    ds_read_b64_tr_b16 v[136:137], v105 offset:12288
    ds_read_b64_tr_b16 v[138:139], v105 offset:13312
    ds_read_b64_tr_b16 v[140:141], v106 offset:12288
    s_waitcnt lgkmcnt(8)
    v_mfma_f32_32x32x16_bf16 v[204:219], v[124:127], v[108:111], v[204:219]
    ds_read_b64_tr_b16 v[142:143], v106 offset:13312
    ds_read_b64_tr_b16 v[144:145], v107 offset:12288
    ds_read_b64_tr_b16 v[146:147], v107 offset:13312
    s_waitcnt lgkmcnt(9)
    v_mfma_f32_32x32x16_bf16 v[220:235], v[128:131], v[108:111], v[220:235]
    s_waitcnt vmcnt(6) lgkmcnt(0)
    s_barrier
    v_mfma_f32_32x32x16_bf16 v[172:187], v[132:135], v[112:115], v[172:187]
    ds_read_b128 v[108:111], v84
    ds_read_b64_tr_b16 v[116:117], v96 offset:0
    ds_read_b64_tr_b16 v[118:119], v96 offset:1024
    ds_read_b64_tr_b16 v[120:121], v97 offset:0
    ds_read_b64_tr_b16 v[122:123], v97 offset:1024
    v_mfma_f32_32x32x16_bf16 v[188:203], v[136:139], v[112:115], v[188:203]
    ds_read_b64_tr_b16 v[124:125], v98 offset:0
    ds_read_b64_tr_b16 v[126:127], v98 offset:1024
    ds_read_b64_tr_b16 v[128:129], v99 offset:0
    ds_read_b64_tr_b16 v[130:131], v99 offset:1024
    s_add_u32 m0, s54, 98304
    v_mfma_f32_32x32x16_bf16 v[204:219], v[140:143], v[112:115], v[204:219]
    buffer_load_dwordx4 v68, s[44:47], s52 offen offset:0 lds
    buffer_load_dwordx4 v69, s[44:47], s52 offen offset:1024 lds
    buffer_load_dwordx4 v70, s[44:47], s52 offen offset:2048 lds
    buffer_load_dwordx4 v71, s[44:47], s52 offen offset:3072 lds
    s_add_u32 m0, s55, 98304
    v_mfma_f32_32x32x16_bf16 v[220:235], v[144:147], v[112:115], v[220:235]
    buffer_load_dwordx4 v72, s[48:51], s53 offen offset:0 lds
    buffer_load_dwordx4 v73, s[48:51], s53 offen offset:1024 lds
    s_add_u32 s52, s52, 128
    s_add_u32 s53, s53, 524288
    s_sub_u32 s31, s31, 1
    s_cmp_lg_u32 s31, 0
    s_cbranch_scc1 attn_kernel_qloop
    s_waitcnt lgkmcnt(6)
    v_mfma_f32_32x32x16_bf16 v[172:187], v[116:119], v[108:111], v[172:187]
    ds_read_b128 v[112:115], v85
    ds_read_b64_tr_b16 v[132:133], v96 offset:4096
    ds_read_b64_tr_b16 v[134:135], v96 offset:5120
    s_waitcnt lgkmcnt(7)
    v_mfma_f32_32x32x16_bf16 v[188:203], v[120:123], v[108:111], v[188:203]
    ds_read_b64_tr_b16 v[136:137], v97 offset:4096
    ds_read_b64_tr_b16 v[138:139], v97 offset:5120
    ds_read_b64_tr_b16 v[140:141], v98 offset:4096
    s_waitcnt lgkmcnt(8)
    v_mfma_f32_32x32x16_bf16 v[204:219], v[124:127], v[108:111], v[204:219]
    ds_read_b64_tr_b16 v[142:143], v98 offset:5120
    ds_read_b64_tr_b16 v[144:145], v99 offset:4096
    ds_read_b64_tr_b16 v[146:147], v99 offset:5120
    s_waitcnt lgkmcnt(9)
    v_mfma_f32_32x32x16_bf16 v[220:235], v[128:131], v[108:111], v[220:235]
    s_waitcnt lgkmcnt(6)
    v_mfma_f32_32x32x16_bf16 v[172:187], v[132:135], v[112:115], v[172:187]
    ds_read_b128 v[108:111], v86
    ds_read_b64_tr_b16 v[116:117], v96 offset:8192
    ds_read_b64_tr_b16 v[118:119], v96 offset:9216
    s_waitcnt lgkmcnt(7)
    v_mfma_f32_32x32x16_bf16 v[188:203], v[136:139], v[112:115], v[188:203]
    ds_read_b64_tr_b16 v[120:121], v97 offset:8192
    ds_read_b64_tr_b16 v[122:123], v97 offset:9216
    ds_read_b64_tr_b16 v[124:125], v98 offset:8192
    s_waitcnt lgkmcnt(8)
    v_mfma_f32_32x32x16_bf16 v[204:219], v[140:143], v[112:115], v[204:219]
    ds_read_b64_tr_b16 v[126:127], v98 offset:9216
    ds_read_b64_tr_b16 v[128:129], v99 offset:8192
    ds_read_b64_tr_b16 v[130:131], v99 offset:9216
    s_waitcnt lgkmcnt(9)
    v_mfma_f32_32x32x16_bf16 v[220:235], v[144:147], v[112:115], v[220:235]
    s_waitcnt lgkmcnt(6)
    v_mfma_f32_32x32x16_bf16 v[172:187], v[116:119], v[108:111], v[172:187]
    ds_read_b128 v[112:115], v87
    ds_read_b64_tr_b16 v[132:133], v96 offset:12288
    ds_read_b64_tr_b16 v[134:135], v96 offset:13312
    s_waitcnt lgkmcnt(7)
    v_mfma_f32_32x32x16_bf16 v[188:203], v[120:123], v[108:111], v[188:203]
    ds_read_b64_tr_b16 v[136:137], v97 offset:12288
    ds_read_b64_tr_b16 v[138:139], v97 offset:13312
    ds_read_b64_tr_b16 v[140:141], v98 offset:12288
    s_waitcnt lgkmcnt(8)
    v_mfma_f32_32x32x16_bf16 v[204:219], v[124:127], v[108:111], v[204:219]
    ds_read_b64_tr_b16 v[142:143], v98 offset:13312
    ds_read_b64_tr_b16 v[144:145], v99 offset:12288
    ds_read_b64_tr_b16 v[146:147], v99 offset:13312
    s_waitcnt lgkmcnt(9)
    v_mfma_f32_32x32x16_bf16 v[220:235], v[128:131], v[108:111], v[220:235]
    s_waitcnt vmcnt(6) lgkmcnt(0)
    s_barrier
    v_mfma_f32_32x32x16_bf16 v[172:187], v[132:135], v[112:115], v[172:187]
    ds_read_b128 v[108:111], v88
    ds_read_b64_tr_b16 v[116:117], v100 offset:0
    ds_read_b64_tr_b16 v[118:119], v100 offset:1024
    ds_read_b64_tr_b16 v[120:121], v101 offset:0
    ds_read_b64_tr_b16 v[122:123], v101 offset:1024
    v_mfma_f32_32x32x16_bf16 v[188:203], v[136:139], v[112:115], v[188:203]
    ds_read_b64_tr_b16 v[124:125], v102 offset:0
    ds_read_b64_tr_b16 v[126:127], v102 offset:1024
    ds_read_b64_tr_b16 v[128:129], v103 offset:0
    ds_read_b64_tr_b16 v[130:131], v103 offset:1024
    s_add_u32 m0, s54, 0
    v_mfma_f32_32x32x16_bf16 v[204:219], v[140:143], v[112:115], v[204:219]
    buffer_load_dwordx4 v68, s[44:47], s52 offen offset:0 lds
    buffer_load_dwordx4 v69, s[44:47], s52 offen offset:1024 lds
    buffer_load_dwordx4 v70, s[44:47], s52 offen offset:2048 lds
    buffer_load_dwordx4 v71, s[44:47], s52 offen offset:3072 lds
    s_add_u32 m0, s55, 0
    v_mfma_f32_32x32x16_bf16 v[220:235], v[144:147], v[112:115], v[220:235]
    buffer_load_dwordx4 v72, s[48:51], s53 offen offset:0 lds
    buffer_load_dwordx4 v73, s[48:51], s53 offen offset:1024 lds
    s_add_u32 s52, s52, 128
    s_add_u32 s53, s53, 524288
    s_waitcnt lgkmcnt(6)
    v_mfma_f32_32x32x16_bf16 v[172:187], v[116:119], v[108:111], v[172:187]
    ds_read_b128 v[112:115], v89
    ds_read_b64_tr_b16 v[132:133], v100 offset:4096
    ds_read_b64_tr_b16 v[134:135], v100 offset:5120
    s_waitcnt lgkmcnt(7)
    v_mfma_f32_32x32x16_bf16 v[188:203], v[120:123], v[108:111], v[188:203]
    ds_read_b64_tr_b16 v[136:137], v101 offset:4096
    ds_read_b64_tr_b16 v[138:139], v101 offset:5120
    ds_read_b64_tr_b16 v[140:141], v102 offset:4096
    s_waitcnt lgkmcnt(8)
    v_mfma_f32_32x32x16_bf16 v[204:219], v[124:127], v[108:111], v[204:219]
    ds_read_b64_tr_b16 v[142:143], v102 offset:5120
    ds_read_b64_tr_b16 v[144:145], v103 offset:4096
    ds_read_b64_tr_b16 v[146:147], v103 offset:5120
    s_waitcnt lgkmcnt(9)
    v_mfma_f32_32x32x16_bf16 v[220:235], v[128:131], v[108:111], v[220:235]
    s_waitcnt lgkmcnt(6)
    v_mfma_f32_32x32x16_bf16 v[172:187], v[132:135], v[112:115], v[172:187]
    ds_read_b128 v[108:111], v90
    ds_read_b64_tr_b16 v[116:117], v100 offset:8192
    ds_read_b64_tr_b16 v[118:119], v100 offset:9216
    s_waitcnt lgkmcnt(7)
    v_mfma_f32_32x32x16_bf16 v[188:203], v[136:139], v[112:115], v[188:203]
    ds_read_b64_tr_b16 v[120:121], v101 offset:8192
    ds_read_b64_tr_b16 v[122:123], v101 offset:9216
    ds_read_b64_tr_b16 v[124:125], v102 offset:8192
    s_waitcnt lgkmcnt(8)
    v_mfma_f32_32x32x16_bf16 v[204:219], v[140:143], v[112:115], v[204:219]
    ds_read_b64_tr_b16 v[126:127], v102 offset:9216
    ds_read_b64_tr_b16 v[128:129], v103 offset:8192
    ds_read_b64_tr_b16 v[130:131], v103 offset:9216
    s_waitcnt lgkmcnt(9)
    v_mfma_f32_32x32x16_bf16 v[220:235], v[144:147], v[112:115], v[220:235]
    s_waitcnt lgkmcnt(6)
    v_mfma_f32_32x32x16_bf16 v[172:187], v[116:119], v[108:111], v[172:187]
    ds_read_b128 v[112:115], v91
    ds_read_b64_tr_b16 v[132:133], v100 offset:12288
    ds_read_b64_tr_b16 v[134:135], v100 offset:13312
    s_waitcnt lgkmcnt(7)
    v_mfma_f32_32x32x16_bf16 v[188:203], v[120:123], v[108:111], v[188:203]
    ds_read_b64_tr_b16 v[136:137], v101 offset:12288
    ds_read_b64_tr_b16 v[138:139], v101 offset:13312
    ds_read_b64_tr_b16 v[140:141], v102 offset:12288
    s_waitcnt lgkmcnt(8)
    v_mfma_f32_32x32x16_bf16 v[204:219], v[124:127], v[108:111], v[204:219]
    ds_read_b64_tr_b16 v[142:143], v102 offset:13312
    ds_read_b64_tr_b16 v[144:145], v103 offset:12288
    ds_read_b64_tr_b16 v[146:147], v103 offset:13312
    s_waitcnt lgkmcnt(9)
    v_mfma_f32_32x32x16_bf16 v[220:235], v[128:131], v[108:111], v[220:235]
    s_waitcnt vmcnt(6) lgkmcnt(0)
    s_barrier
    v_mfma_f32_32x32x16_bf16 v[172:187], v[132:135], v[112:115], v[172:187]
    ds_read_b128 v[108:111], v92
    ds_read_b64_tr_b16 v[116:117], v104 offset:0
    ds_read_b64_tr_b16 v[118:119], v104 offset:1024
    ds_read_b64_tr_b16 v[120:121], v105 offset:0
    ds_read_b64_tr_b16 v[122:123], v105 offset:1024
    ds_read_b64_tr_b16 v[124:125], v106 offset:0
    v_mfma_f32_32x32x16_bf16 v[188:203], v[136:139], v[112:115], v[188:203]
    ds_read_b64_tr_b16 v[126:127], v106 offset:1024
    ds_read_b64_tr_b16 v[128:129], v107 offset:0
    ds_read_b64_tr_b16 v[130:131], v107 offset:1024
    s_add_u32 m0, s32, 16384
    s_nop 0
    buffer_load_dwordx4 v22, s[16:19], s29 offen lds
    buffer_load_dwordx4 v23, s[16:19], s29 offen offset:1024 lds
    v_mfma_f32_32x32x16_bf16 v[204:219], v[140:143], v[112:115], v[204:219]
    s_add_u32 s29, s29, 16384
    s_add_u32 m0, s32, 32768
    s_nop 0
    buffer_load_dwordx4 v22, s[16:19], s29 offen lds
    buffer_load_dwordx4 v23, s[16:19], s29 offen offset:1024 lds
    s_add_u32 s29, s29, 16384
    s_add_u32 m0, s32, 49152
    v_mfma_f32_32x32x16_bf16 v[220:235], v[144:147], v[112:115], v[220:235]
    buffer_load_dwordx4 v22, s[16:19], s29 offen lds
    buffer_load_dwordx4 v23, s[16:19], s29 offen offset:1024 lds
    s_add_u32 s29, s29, 16384
    s_waitcnt lgkmcnt(6)
    v_mfma_f32_32x32x16_bf16 v[172:187], v[116:119], v[108:111], v[172:187]
    ds_read_b128 v[112:115], v93
    ds_read_b64_tr_b16 v[132:133], v104 offset:4096
    ds_read_b64_tr_b16 v[134:135], v104 offset:5120
    s_waitcnt lgkmcnt(7)
    v_mfma_f32_32x32x16_bf16 v[188:203], v[120:123], v[108:111], v[188:203]
    ds_read_b64_tr_b16 v[136:137], v105 offset:4096
    ds_read_b64_tr_b16 v[138:139], v105 offset:5120
    ds_read_b64_tr_b16 v[140:141], v106 offset:4096
    s_waitcnt lgkmcnt(8)
    v_mfma_f32_32x32x16_bf16 v[204:219], v[124:127], v[108:111], v[204:219]
    ds_read_b64_tr_b16 v[142:143], v106 offset:5120
    ds_read_b64_tr_b16 v[144:145], v107 offset:4096
    ds_read_b64_tr_b16 v[146:147], v107 offset:5120
    s_waitcnt lgkmcnt(9)
    v_mfma_f32_32x32x16_bf16 v[220:235], v[128:131], v[108:111], v[220:235]
    s_waitcnt lgkmcnt(6)
    v_mfma_f32_32x32x16_bf16 v[172:187], v[132:135], v[112:115], v[172:187]
    ds_read_b128 v[108:111], v94
    ds_read_b64_tr_b16 v[116:117], v104 offset:8192
    ds_read_b64_tr_b16 v[118:119], v104 offset:9216
    s_waitcnt lgkmcnt(7)
    v_mfma_f32_32x32x16_bf16 v[188:203], v[136:139], v[112:115], v[188:203]
    ds_read_b64_tr_b16 v[120:121], v105 offset:8192
    ds_read_b64_tr_b16 v[122:123], v105 offset:9216
    ds_read_b64_tr_b16 v[124:125], v106 offset:8192
    s_waitcnt lgkmcnt(8)
    v_mfma_f32_32x32x16_bf16 v[204:219], v[140:143], v[112:115], v[204:219]
    ds_read_b64_tr_b16 v[126:127], v106 offset:9216
    ds_read_b64_tr_b16 v[128:129], v107 offset:8192
    ds_read_b64_tr_b16 v[130:131], v107 offset:9216
    s_waitcnt lgkmcnt(9)
    v_mfma_f32_32x32x16_bf16 v[220:235], v[144:147], v[112:115], v[220:235]
    s_waitcnt lgkmcnt(6)
    v_mfma_f32_32x32x16_bf16 v[172:187], v[116:119], v[108:111], v[172:187]
    ds_read_b128 v[112:115], v95
    ds_read_b64_tr_b16 v[132:133], v104 offset:12288
    ds_read_b64_tr_b16 v[134:135], v104 offset:13312
    s_waitcnt lgkmcnt(7)
    v_mfma_f32_32x32x16_bf16 v[188:203], v[120:123], v[108:111], v[188:203]
    ds_read_b64_tr_b16 v[136:137], v105 offset:12288
    ds_read_b64_tr_b16 v[138:139], v105 offset:13312
    ds_read_b64_tr_b16 v[140:141], v106 offset:12288
    s_waitcnt lgkmcnt(8)
    v_mfma_f32_32x32x16_bf16 v[204:219], v[124:127], v[108:111], v[204:219]
    ds_read_b64_tr_b16 v[142:143], v106 offset:13312
    ds_read_b64_tr_b16 v[144:145], v107 offset:12288
    ds_read_b64_tr_b16 v[146:147], v107 offset:13312
    s_waitcnt lgkmcnt(9)
    v_mfma_f32_32x32x16_bf16 v[220:235], v[128:131], v[108:111], v[220:235]
    s_waitcnt vmcnt(6) lgkmcnt(0)
    s_barrier
    v_mfma_f32_32x32x16_bf16 v[172:187], v[132:135], v[112:115], v[172:187]
    ds_read_b128 v[108:111], v84
    ds_read_b64_tr_b16 v[116:117], v96 offset:0
    ds_read_b64_tr_b16 v[118:119], v96 offset:1024
    ds_read_b64_tr_b16 v[120:121], v97 offset:0
    ds_read_b64_tr_b16 v[122:123], v97 offset:1024
    v_mfma_f32_32x32x16_bf16 v[188:203], v[136:139], v[112:115], v[188:203]
    ds_read_b64_tr_b16 v[124:125], v98 offset:0
    ds_read_b64_tr_b16 v[126:127], v98 offset:1024
    ds_read_b64_tr_b16 v[128:129], v99 offset:0
    ds_read_b64_tr_b16 v[130:131], v99 offset:1024
    s_add_u32 m0, s33, 0
    v_mfma_f32_32x32x16_bf16 v[204:219], v[140:143], v[112:115], v[204:219]
    buffer_load_dwordx4 v24, s[20:23], s30 offen lds
    buffer_load_dwordx4 v24, s[20:23], s30 offen offset:1024 lds
    s_add_u32 s30, s30, 16384
    s_add_u32 m0, s33, 16384
    s_nop 0
    buffer_load_dwordx4 v24, s[20:23], s30 offen lds
    v_mfma_f32_32x32x16_bf16 v[220:235], v[144:147], v[112:115], v[220:235]
    buffer_load_dwordx4 v24, s[20:23], s30 offen offset:1024 lds
    s_add_u32 s30, s30, 16384
    s_waitcnt lgkmcnt(6)
    v_mfma_f32_32x32x16_bf16 v[172:187], v[116:119], v[108:111], v[172:187]
    ds_read_b128 v[112:115], v85
    ds_read_b64_tr_b16 v[132:133], v96 offset:4096
    ds_read_b64_tr_b16 v[134:135], v96 offset:5120
    s_waitcnt lgkmcnt(7)
    v_mfma_f32_32x32x16_bf16 v[188:203], v[120:123], v[108:111], v[188:203]
    ds_read_b64_tr_b16 v[136:137], v97 offset:4096
    ds_read_b64_tr_b16 v[138:139], v97 offset:5120
    ds_read_b64_tr_b16 v[140:141], v98 offset:4096
    s_waitcnt lgkmcnt(8)
    v_mfma_f32_32x32x16_bf16 v[204:219], v[124:127], v[108:111], v[204:219]
    ds_read_b64_tr_b16 v[142:143], v98 offset:5120
    ds_read_b64_tr_b16 v[144:145], v99 offset:4096
    ds_read_b64_tr_b16 v[146:147], v99 offset:5120
    s_waitcnt lgkmcnt(9)
    v_mfma_f32_32x32x16_bf16 v[220:235], v[128:131], v[108:111], v[220:235]
    s_waitcnt lgkmcnt(6)
    v_mfma_f32_32x32x16_bf16 v[172:187], v[132:135], v[112:115], v[172:187]
    ds_read_b128 v[108:111], v86
    ds_read_b64_tr_b16 v[116:117], v96 offset:8192
    ds_read_b64_tr_b16 v[118:119], v96 offset:9216
    s_waitcnt lgkmcnt(7)
    v_mfma_f32_32x32x16_bf16 v[188:203], v[136:139], v[112:115], v[188:203]
    ds_read_b64_tr_b16 v[120:121], v97 offset:8192
    ds_read_b64_tr_b16 v[122:123], v97 offset:9216
    ds_read_b64_tr_b16 v[124:125], v98 offset:8192
    s_waitcnt lgkmcnt(8)
    v_mfma_f32_32x32x16_bf16 v[204:219], v[140:143], v[112:115], v[204:219]
    ds_read_b64_tr_b16 v[126:127], v98 offset:9216
    ds_read_b64_tr_b16 v[128:129], v99 offset:8192
    ds_read_b64_tr_b16 v[130:131], v99 offset:9216
    s_waitcnt lgkmcnt(9)
    v_mfma_f32_32x32x16_bf16 v[220:235], v[144:147], v[112:115], v[220:235]
    s_waitcnt lgkmcnt(6)
    v_mfma_f32_32x32x16_bf16 v[172:187], v[116:119], v[108:111], v[172:187]
    ds_read_b128 v[112:115], v87
    ds_read_b64_tr_b16 v[132:133], v96 offset:12288
    ds_read_b64_tr_b16 v[134:135], v96 offset:13312
    s_waitcnt lgkmcnt(7)
    v_mfma_f32_32x32x16_bf16 v[188:203], v[120:123], v[108:111], v[188:203]
    ds_read_b64_tr_b16 v[136:137], v97 offset:12288
    ds_read_b64_tr_b16 v[138:139], v97 offset:13312
    ds_read_b64_tr_b16 v[140:141], v98 offset:12288
    s_waitcnt lgkmcnt(8)
    v_mfma_f32_32x32x16_bf16 v[204:219], v[124:127], v[108:111], v[204:219]
    ds_read_b64_tr_b16 v[142:143], v98 offset:13312
    ds_read_b64_tr_b16 v[144:145], v99 offset:12288
    ds_read_b64_tr_b16 v[146:147], v99 offset:13312
    s_waitcnt lgkmcnt(9)
    v_mfma_f32_32x32x16_bf16 v[220:235], v[128:131], v[108:111], v[220:235]
    s_waitcnt lgkmcnt(6)
    v_mfma_f32_32x32x16_bf16 v[172:187], v[132:135], v[112:115], v[172:187]
    s_waitcnt lgkmcnt(4)
    v_mfma_f32_32x32x16_bf16 v[188:203], v[136:139], v[112:115], v[188:203]
    s_waitcnt lgkmcnt(2)
    v_mfma_f32_32x32x16_bf16 v[204:219], v[140:143], v[112:115], v[204:219]
    s_waitcnt lgkmcnt(0)
    v_mfma_f32_32x32x16_bf16 v[220:235], v[144:147], v[112:115], v[220:235]
    s_nop 5
    v_cvt_pk_bf16_f32 v36, v172, v173
    v_cvt_pk_bf16_f32 v37, v174, v175
    v_cvt_pk_bf16_f32 v38, v176, v177
    v_cvt_pk_bf16_f32 v39, v178, v179
    s_nop 0
    v_permlane32_swap_b32 v36, v38
    v_permlane32_swap_b32 v37, v39
    v_cvt_pk_bf16_f32 v40, v180, v181
    v_cvt_pk_bf16_f32 v41, v182, v183
    v_cvt_pk_bf16_f32 v42, v184, v185
    v_cvt_pk_bf16_f32 v43, v186, v187
    s_nop 0
    v_permlane32_swap_b32 v40, v42
    v_permlane32_swap_b32 v41, v43
    v_cvt_pk_bf16_f32 v44, v188, v189
    v_cvt_pk_bf16_f32 v45, v190, v191
    v_cvt_pk_bf16_f32 v46, v192, v193
    v_cvt_pk_bf16_f32 v47, v194, v195
    s_nop 0
    v_permlane32_swap_b32 v44, v46
    v_permlane32_swap_b32 v45, v47
    v_cvt_pk_bf16_f32 v48, v196, v197
    v_cvt_pk_bf16_f32 v49, v198, v199
    v_cvt_pk_bf16_f32 v50, v200, v201
    v_cvt_pk_bf16_f32 v51, v202, v203
    s_nop 0
    v_permlane32_swap_b32 v48, v50
    v_permlane32_swap_b32 v49, v51
    v_cvt_pk_bf16_f32 v52, v204, v205
    v_cvt_pk_bf16_f32 v53, v206, v207
    v_cvt_pk_bf16_f32 v54, v208, v209
    v_cvt_pk_bf16_f32 v55, v210, v211
    s_nop 0
    v_permlane32_swap_b32 v52, v54
    v_permlane32_swap_b32 v53, v55
    v_cvt_pk_bf16_f32 v56, v212, v213
    v_cvt_pk_bf16_f32 v57, v214, v215
    v_cvt_pk_bf16_f32 v58, v216, v217
    v_cvt_pk_bf16_f32 v59, v218, v219
    s_nop 0
    v_permlane32_swap_b32 v56, v58
    v_permlane32_swap_b32 v57, v59
    v_cvt_pk_bf16_f32 v60, v220, v221
    v_cvt_pk_bf16_f32 v61, v222, v223
    v_cvt_pk_bf16_f32 v62, v224, v225
    v_cvt_pk_bf16_f32 v63, v226, v227
    s_nop 0
    v_permlane32_swap_b32 v60, v62
    v_permlane32_swap_b32 v61, v63
    v_cvt_pk_bf16_f32 v64, v228, v229
    v_cvt_pk_bf16_f32 v65, v230, v231
    v_cvt_pk_bf16_f32 v66, v232, v233
    v_cvt_pk_bf16_f32 v67, v234, v235
    s_nop 0
    v_permlane32_swap_b32 v64, v66
    v_permlane32_swap_b32 v65, v67
    v_mov_b32 v172, 0
    v_mov_b32 v173, 0
    v_mov_b32 v174, 0
    v_mov_b32 v175, 0
    v_mov_b32 v176, 0
    v_mov_b32 v177, 0
    v_mov_b32 v178, 0
    v_mov_b32 v179, 0
    v_mov_b32 v180, 0
    v_mov_b32 v181, 0
    v_mov_b32 v182, 0
    v_mov_b32 v183, 0
    v_mov_b32 v184, 0
    v_mov_b32 v185, 0
    v_mov_b32 v186, 0
    v_mov_b32 v187, 0
    v_mov_b32 v188, 0
    v_mov_b32 v189, 0
    v_mov_b32 v190, 0
    v_mov_b32 v191, 0
    v_mov_b32 v192, 0
    v_mov_b32 v193, 0
    v_mov_b32 v194, 0
    v_mov_b32 v195, 0
    v_mov_b32 v196, 0
    v_mov_b32 v197, 0
    v_mov_b32 v198, 0
    v_mov_b32 v199, 0
    v_mov_b32 v200, 0
    v_mov_b32 v201, 0
    v_mov_b32 v202, 0
    v_mov_b32 v203, 0
    v_mov_b32 v204, 0
    v_mov_b32 v205, 0
    v_mov_b32 v206, 0
    v_mov_b32 v207, 0
    v_mov_b32 v208, 0
    v_mov_b32 v209, 0
    v_mov_b32 v210, 0
    v_mov_b32 v211, 0
    v_mov_b32 v212, 0
    v_mov_b32 v213, 0
    v_mov_b32 v214, 0
    v_mov_b32 v215, 0
    v_mov_b32 v216, 0
    v_mov_b32 v217, 0
    v_mov_b32 v218, 0
    v_mov_b32 v219, 0
    v_mov_b32 v220, 0
    v_mov_b32 v221, 0
    v_mov_b32 v222, 0
    v_mov_b32 v223, 0
    v_mov_b32 v224, 0
    v_mov_b32 v225, 0
    v_mov_b32 v226, 0
    v_mov_b32 v227, 0
    v_mov_b32 v228, 0
    v_mov_b32 v229, 0
    v_mov_b32 v230, 0
    v_mov_b32 v231, 0
    v_mov_b32 v232, 0
    v_mov_b32 v233, 0
    v_mov_b32 v234, 0
    v_mov_b32 v235, 0
    v_mov_b32 v25, 0xf149f2ca
    v_mov_b32 v26, 0
    v_mov_b32 v27, 0
    v_mov_b32 v32, 0
    v_mov_b32 v33, 0
    s_mov_b32 s42, s34
    s_mov_b32 s43, s34
    s_waitcnt vmcnt(8)
    s_barrier
    ds_read_b128 v[84:87], v10 offset:16384
    ds_read_b128 v[88:91], v11 offset:16384
    ds_read_b128 v[92:95], v12 offset:16384
    ds_read_b128 v[96:99], v13 offset:16384
    s_waitcnt lgkmcnt(3)
    v_mfma_f32_32x32x16_bf16 v[108:123], v[84:87], v[36:39], 0
    ds_read_b128 v[100:103], v14 offset:16384
    s_waitcnt lgkmcnt(3)
    v_mfma_f32_32x32x16_bf16 v[108:123], v[88:91], v[40:43], v[108:123]
    ds_read_b128 v[104:107], v15 offset:16384
    s_waitcnt lgkmcnt(3)
    v_mfma_f32_32x32x16_bf16 v[108:123], v[92:95], v[44:47], v[108:123]
    ds_read_b128 v[84:87], v16 offset:16384
    s_waitcnt lgkmcnt(3)
    v_mfma_f32_32x32x16_bf16 v[108:123], v[96:99], v[48:51], v[108:123]
    ds_read_b128 v[88:91], v17 offset:16384
    s_waitcnt lgkmcnt(3)
    v_mfma_f32_32x32x16_bf16 v[108:123], v[100:103], v[52:55], v[108:123]
    ds_read_b128 v[92:95], v10 offset:24576
    s_waitcnt lgkmcnt(3)
    v_mfma_f32_32x32x16_bf16 v[108:123], v[104:107], v[56:59], v[108:123]
    ds_read_b128 v[96:99], v11 offset:24576
    s_waitcnt lgkmcnt(3)
    v_mfma_f32_32x32x16_bf16 v[108:123], v[84:87], v[60:63], v[108:123]
    ds_read_b128 v[100:103], v12 offset:24576
    s_waitcnt lgkmcnt(3)
    v_mfma_f32_32x32x16_bf16 v[108:123], v[88:91], v[64:67], v[108:123]
    ds_read_b128 v[104:107], v13 offset:24576
    s_waitcnt lgkmcnt(3)
    v_mfma_f32_32x32x16_bf16 v[124:139], v[92:95], v[36:39], 0
    ds_read_b128 v[84:87], v14 offset:24576
    s_waitcnt lgkmcnt(3)
    v_mfma_f32_32x32x16_bf16 v[124:139], v[96:99], v[40:43], v[124:139]
    ds_read_b128 v[88:91], v15 offset:24576
    s_waitcnt lgkmcnt(3)
    v_mfma_f32_32x32x16_bf16 v[124:139], v[100:103], v[44:47], v[124:139]
    ds_read_b128 v[92:95], v16 offset:24576
    s_waitcnt lgkmcnt(3)
    v_mfma_f32_32x32x16_bf16 v[124:139], v[104:107], v[48:51], v[124:139]
    ds_read_b128 v[96:99], v17 offset:24576
    s_waitcnt lgkmcnt(3)
    v_mfma_f32_32x32x16_bf16 v[124:139], v[84:87], v[52:55], v[124:139]
    s_waitcnt lgkmcnt(2)
    v_mfma_f32_32x32x16_bf16 v[124:139], v[88:91], v[56:59], v[124:139]
    s_waitcnt lgkmcnt(1)
    v_mfma_f32_32x32x16_bf16 v[124:139], v[92:95], v[60:63], v[124:139]
    s_waitcnt lgkmcnt(0)
    v_mfma_f32_32x32x16_bf16 v[124:139], v[96:99], v[64:67], v[124:139]
    s_load_dwordx2 s[60:61], s[0:1], 32
    s_load_dwordx2 s[62:63], s[0:1], 48
    s_load_dwordx2 s[64:65], s[0:1], 56
    s_load_dwordx2 s[66:67], s[0:1], 64
    s_waitcnt lgkmcnt(0)
    s_mov_b32 s72, s60
    s_mov_b32 s73, s61
    s_mov_b32 s74, 0x800000
    s_mov_b32 s75, 0x00020000
    s_mov_b32 s76, s62
    s_mov_b32 s77, s63
    s_mov_b32 s78, 0x700000
    s_mov_b32 s79, 0x00020000
    s_mov_b32 s80, s64
    s_mov_b32 s81, s65
    s_mov_b32 s82, 0x700000
    s_mov_b32 s83, 0x00020000
    s_mov_b32 s84, s66
    s_mov_b32 s85, s67
    s_mov_b32 s86, 0x700000
    s_mov_b32 s87, 0x00020000
    s_mov_b32 s68, 0
    s_lshl_b32 s69, s28, 10
    s_lshl_b32 s36, s2, 13
    s_add_u32 s36, s36, s69
    v_lshlrev_b32 v29, 4, v1
    v_add_u32 v29, s36, v29
    s_mov_b32 s31, 7
attn_kernel_loop:
    s_waitcnt vmcnt(0)
    s_barrier
    ds_read_b128 v[84:87], v10 offset:32768
    ds_read_b128 v[88:91], v11 offset:32768
    ds_read_b128 v[92:95], v12 offset:32768
    ds_read_b128 v[96:99], v13 offset:32768
    s_add_u32 m0, s32, 0
    s_nop 0
    buffer_load_dwordx4 v22, s[16:19], s29 offen lds
    buffer_load_dwordx4 v23, s[16:19], s29 offen offset:1024 lds
    s_add_u32 s29, s29, 16384
    s_add_u32 m0, s33, 32768
    s_nop 0
    buffer_load_dwordx4 v24, s[20:23], s30 offen lds
    buffer_load_dwordx4 v24, s[20:23], s30 offen offset:1024 lds
    s_add_u32 s30, s30, 16384
    s_add_u32 m0, s32, 16384
    s_nop 0
    buffer_load_dwordx4 v22, s[16:19], s29 offen lds
    buffer_load_dwordx4 v23, s[16:19], s29 offen offset:1024 lds
    s_add_u32 s29, s29, 16384
    s_add_u32 m0, s33, 49152
    s_nop 0
    buffer_load_dwordx4 v24, s[20:23], s30 offen lds
    buffer_load_dwordx4 v24, s[20:23], s30 offen offset:1024 lds
    s_add_u32 s30, s30, 16384
    s_mov_b32 m0, s69
    s_nop 0
    buffer_load_dwordx4 v29, s[72:75], s68 offen lds
    buffer_load_dwordx4 v29, s[76:79], s68 offen lds
    v_max3_f32 v2, v108, v109, v110
    v_max3_f32 v3, v111, v112, v113
    v_max3_f32 v2, v2, v114, v115
    v_max3_f32 v3, v3, v116, v117
    v_max3_f32 v2, v2, v118, v119
    v_max3_f32 v3, v3, v120, v121
    s_waitcnt lgkmcnt(3)
    v_mfma_f32_32x32x16_bf16 v[140:155], v[84:87], v[36:39], 0
    ds_read_b128 v[100:103], v14 offset:32768
    v_max3_f32 v2, v2, v122, v123
    v_max3_f32 v3, v3, v124, v125
    v_max3_f32 v2, v2, v126, v127
    v_max3_f32 v3, v3, v128, v129
    v_max3_f32 v2, v2, v130, v131
    s_waitcnt lgkmcnt(3)
    v_mfma_f32_32x32x16_bf16 v[140:155], v[88:91], v[40:43], v[140:155]
    ds_read_b128 v[104:107], v15 offset:32768
    v_max3_f32 v3, v3, v132, v133
    v_max3_f32 v2, v2, v134, v135
    v_max3_f32 v3, v3, v136, v137
    v_max3_f32 v2, v2, v138, v139
    v_max_f32 v2, v2, v3
    s_waitcnt lgkmcnt(3)
    v_mfma_f32_32x32x16_bf16 v[140:155], v[92:95], v[44:47], v[140:155]
    ds_read_b128 v[84:87], v16 offset:32768
    v_mov_b32 v3, v2
    s_nop 1
    v_permlane32_swap_b32 v2, v3
    v_max_f32 v2, v2, v3
    v_sub_f32 v3, v2, v25
    v_cmp_lt_f32 vcc, s35, v3
    s_waitcnt lgkmcnt(3)
    v_mfma_f32_32x32x16_bf16 v[140:155], v[96:99], v[48:51], v[140:155]
    ds_read_b128 v[88:91], v17 offset:32768
    s_cbranch_vccz attn_kernel_nors1
    v_max_f32 v2, v2, v25
    v_sub_f32 v3, v25, v2
    v_mul_f32 v3, s34, v3
    v_exp_f32 v3, v3
    v_mov_b32 v25, v2
    v_mul_f32 v27, s34, v2
    v_mul_f32 v26, v26, v3
    v_mul_f32 v172, v172, v3
    v_mul_f32 v173, v173, v3
    v_mul_f32 v174, v174, v3
    v_mul_f32 v175, v175, v3
    v_mul_f32 v176, v176, v3
    v_mul_f32 v177, v177, v3
    v_mul_f32 v178, v178, v3
    v_mul_f32 v179, v179, v3
    v_mul_f32 v180, v180, v3
    v_mul_f32 v181, v181, v3
    v_mul_f32 v182, v182, v3
    v_mul_f32 v183, v183, v3
    v_mul_f32 v184, v184, v3
    v_mul_f32 v185, v185, v3
    v_mul_f32 v186, v186, v3
    v_mul_f32 v187, v187, v3
    v_mul_f32 v188, v188, v3
    v_mul_f32 v189, v189, v3
    v_mul_f32 v190, v190, v3
    v_mul_f32 v191, v191, v3
    v_mul_f32 v192, v192, v3
    v_mul_f32 v193, v193, v3
    v_mul_f32 v194, v194, v3
    v_mul_f32 v195, v195, v3
    v_mul_f32 v196, v196, v3
    v_mul_f32 v197, v197, v3
    v_mul_f32 v198, v198, v3
    v_mul_f32 v199, v199, v3
    v_mul_f32 v200, v200, v3
    v_mul_f32 v201, v201, v3
    v_mul_f32 v202, v202, v3
    v_mul_f32 v203, v203, v3
    v_mul_f32 v204, v204, v3
    v_mul_f32 v205, v205, v3
    v_mul_f32 v206, v206, v3
    v_mul_f32 v207, v207, v3
    v_mul_f32 v208, v208, v3
    v_mul_f32 v209, v209, v3
    v_mul_f32 v210, v210, v3
    v_mul_f32 v211, v211, v3
    v_mul_f32 v212, v212, v3
    v_mul_f32 v213, v213, v3
    v_mul_f32 v214, v214, v3
    v_mul_f32 v215, v215, v3
    v_mul_f32 v216, v216, v3
    v_mul_f32 v217, v217, v3
    v_mul_f32 v218, v218, v3
    v_mul_f32 v219, v219, v3
    v_mul_f32 v220, v220, v3
    v_mul_f32 v221, v221, v3
    v_mul_f32 v222, v222, v3
    v_mul_f32 v223, v223, v3
    v_mul_f32 v224, v224, v3
    v_mul_f32 v225, v225, v3
    v_mul_f32 v226, v226, v3
    v_mul_f32 v227, v227, v3
    v_mul_f32 v228, v228, v3
    v_mul_f32 v229, v229, v3
    v_mul_f32 v230, v230, v3
    v_mul_f32 v231, v231, v3
    v_mul_f32 v232, v232, v3
    v_mul_f32 v233, v233, v3
    v_mul_f32 v234, v234, v3
    v_mul_f32 v235, v235, v3
attn_kernel_nors1:
    v_fma_f32 v108, v108, s34, -v27
    v_exp_f32 v108, v108
    v_fma_f32 v109, v109, s34, -v27
    v_exp_f32 v109, v109
    s_waitcnt lgkmcnt(3)
    v_mfma_f32_32x32x16_bf16 v[140:155], v[100:103], v[52:55], v[140:155]
    ds_read_b128 v[92:95], v10 offset:40960
    v_fma_f32 v110, v110, s34, -v27
    v_exp_f32 v110, v110
    v_fma_f32 v111, v111, s34, -v27
    v_exp_f32 v111, v111
    v_fma_f32 v112, v112, s34, -v27
    s_waitcnt lgkmcnt(3)
    v_mfma_f32_32x32x16_bf16 v[140:155], v[104:107], v[56:59], v[140:155]
    ds_read_b128 v[96:99], v11 offset:40960
    v_exp_f32 v112, v112
    v_fma_f32 v113, v113, s34, -v27
    v_exp_f32 v113, v113
    v_fma_f32 v114, v114, s34, -v27
    v_exp_f32 v114, v114
    s_waitcnt lgkmcnt(3)
    v_mfma_f32_32x32x16_bf16 v[140:155], v[84:87], v[60:63], v[140:155]
    ds_read_b128 v[100:103], v12 offset:40960
    v_fma_f32 v115, v115, s34, -v27
    v_exp_f32 v115, v115
    v_add_f32 v4, v108, v109
    v_cvt_pk_bf16_f32 v68, v108, v109
    v_add_f32 v5, v110, v111
    s_waitcnt lgkmcnt(3)
    v_mfma_f32_32x32x16_bf16 v[140:155], v[88:91], v[64:67], v[140:155]
    ds_read_b128 v[104:107], v13 offset:40960
    v_cvt_pk_bf16_f32 v69, v110, v111
    v_add_f32 v6, v112, v113
    v_cvt_pk_bf16_f32 v70, v112, v113
    v_add_f32 v7, v114, v115
    v_cvt_pk_bf16_f32 v71, v114, v115
    s_waitcnt lgkmcnt(3)
    v_mfma_f32_32x32x16_bf16 v[156:171], v[92:95], v[36:39], 0
    ds_read_b128 v[84:87], v14 offset:40960
    v_add_f32 v4, v4, v5
    v_add_f32 v6, v6, v7
    v_add_f32 v26, v26, v4
    v_add_f32 v26, v26, v6
    v_fma_f32 v116, v116, s34, -v27
    s_waitcnt lgkmcnt(3)
    v_mfma_f32_32x32x16_bf16 v[156:171], v[96:99], v[40:43], v[156:171]
    ds_read_b128 v[88:91], v15 offset:40960
    v_exp_f32 v116, v116
    v_fma_f32 v117, v117, s34, -v27
    v_exp_f32 v117, v117
    v_fma_f32 v118, v118, s34, -v27
    v_exp_f32 v118, v118
    s_waitcnt lgkmcnt(3)
    v_mfma_f32_32x32x16_bf16 v[156:171], v[100:103], v[44:47], v[156:171]
    ds_read_b128 v[92:95], v16 offset:40960
    v_fma_f32 v119, v119, s34, -v27
    v_exp_f32 v119, v119
    v_fma_f32 v120, v120, s34, -v27
    v_exp_f32 v120, v120
    v_fma_f32 v121, v121, s34, -v27
    s_waitcnt lgkmcnt(3)
    v_mfma_f32_32x32x16_bf16 v[156:171], v[104:107], v[48:51], v[156:171]
    ds_read_b128 v[96:99], v17 offset:40960
    v_exp_f32 v121, v121
    v_fma_f32 v122, v122, s34, -v27
    v_exp_f32 v122, v122
    v_fma_f32 v123, v123, s34, -v27
    v_exp_f32 v123, v123
    s_waitcnt lgkmcnt(3)
    v_mfma_f32_32x32x16_bf16 v[156:171], v[84:87], v[52:55], v[156:171]
    ds_read_b64_tr_b16 v[100:101], v18 offset:0
    ds_read_b64_tr_b16 v[102:103], v18 offset:2048
    v_add_f32 v4, v116, v117
    v_cvt_pk_bf16_f32 v72, v116, v117
    v_add_f32 v5, v118, v119
    v_cvt_pk_bf16_f32 v73, v118, v119
    v_add_f32 v6, v120, v121
    s_waitcnt lgkmcnt(4)
    v_mfma_f32_32x32x16_bf16 v[156:171], v[88:91], v[56:59], v[156:171]
    ds_read_b64_tr_b16 v[104:105], v19 offset:0
    ds_read_b64_tr_b16 v[106:107], v19 offset:2048
    v_cvt_pk_bf16_f32 v74, v120, v121
    v_add_f32 v7, v122, v123
    v_cvt_pk_bf16_f32 v75, v122, v123
    v_add_f32 v4, v4, v5
    v_add_f32 v6, v6, v7
    s_waitcnt lgkmcnt(5)
    v_mfma_f32_32x32x16_bf16 v[156:171], v[92:95], v[60:63], v[156:171]
    ds_read_b64_tr_b16 v[84:85], v20 offset:0
    ds_read_b64_tr_b16 v[86:87], v20 offset:2048
    v_add_f32 v26, v26, v4
    v_add_f32 v26, v26, v6
    v_fma_f32 v124, v124, s34, -v27
    v_exp_f32 v124, v124
    v_fma_f32 v125, v125, s34, -v27
    s_waitcnt lgkmcnt(6)
    v_mfma_f32_32x32x16_bf16 v[156:171], v[96:99], v[64:67], v[156:171]
    ds_read_b64_tr_b16 v[88:89], v21 offset:0
    ds_read_b64_tr_b16 v[90:91], v21 offset:2048
    v_exp_f32 v125, v125
    v_fma_f32 v126, v126, s34, -v27
    v_exp_f32 v126, v126
    v_fma_f32 v127, v127, s34, -v27
    v_exp_f32 v127, v127
    s_waitcnt lgkmcnt(6)
    v_mfma_f32_32x32x16_bf16 v[172:187], v[100:103], v[68:71], v[172:187]
    ds_read_b64_tr_b16 v[92:93], v18 offset:4096
    ds_read_b64_tr_b16 v[94:95], v18 offset:6144
    v_fma_f32 v128, v128, s34, -v27
    v_exp_f32 v128, v128
    v_fma_f32 v129, v129, s34, -v27
    v_exp_f32 v129, v129
    v_fma_f32 v130, v130, s34, -v27
    s_waitcnt lgkmcnt(6)
    v_mfma_f32_32x32x16_bf16 v[188:203], v[104:107], v[68:71], v[188:203]
    ds_read_b64_tr_b16 v[96:97], v19 offset:4096
    ds_read_b64_tr_b16 v[98:99], v19 offset:6144
    v_exp_f32 v130, v130
    v_fma_f32 v131, v131, s34, -v27
    v_exp_f32 v131, v131
    v_add_f32 v4, v124, v125
    v_cvt_pk_bf16_f32 v76, v124, v125
    s_waitcnt lgkmcnt(6)
    v_mfma_f32_32x32x16_bf16 v[204:219], v[84:87], v[68:71], v[204:219]
    ds_read_b64_tr_b16 v[100:101], v20 offset:4096
    ds_read_b64_tr_b16 v[102:103], v20 offset:6144
    v_add_f32 v5, v126, v127
    v_cvt_pk_bf16_f32 v77, v126, v127
    v_add_f32 v6, v128, v129
    v_cvt_pk_bf16_f32 v78, v128, v129
    v_add_f32 v7, v130, v131
    s_waitcnt lgkmcnt(6)
    v_mfma_f32_32x32x16_bf16 v[220:235], v[88:91], v[68:71], v[220:235]
    ds_read_b64_tr_b16 v[104:105], v21 offset:4096
    ds_read_b64_tr_b16 v[106:107], v21 offset:6144
    v_cvt_pk_bf16_f32 v79, v130, v131
    v_add_f32 v4, v4, v5
    v_add_f32 v6, v6, v7
    v_add_f32 v26, v26, v4
    v_add_f32 v26, v26, v6
    s_waitcnt lgkmcnt(6)
    v_mfma_f32_32x32x16_bf16 v[172:187], v[92:95], v[72:75], v[172:187]
    ds_read_b64_tr_b16 v[84:85], v18 offset:8192
    ds_read_b64_tr_b16 v[86:87], v18 offset:10240
    v_fma_f32 v132, v132, s34, -v27
    v_exp_f32 v132, v132
    v_fma_f32 v133, v133, s34, -v27
    v_exp_f32 v133, v133
    v_fma_f32 v134, v134, s34, -v27
    s_waitcnt lgkmcnt(6)
    v_mfma_f32_32x32x16_bf16 v[188:203], v[96:99], v[72:75], v[188:203]
    ds_read_b64_tr_b16 v[88:89], v19 offset:8192
    ds_read_b64_tr_b16 v[90:91], v19 offset:10240
    v_exp_f32 v134, v134
    v_fma_f32 v135, v135, s34, -v27
    v_exp_f32 v135, v135
    v_fma_f32 v136, v136, s34, -v27
    v_exp_f32 v136, v136
    s_waitcnt lgkmcnt(6)
    v_mfma_f32_32x32x16_bf16 v[204:219], v[100:103], v[72:75], v[204:219]
    ds_read_b64_tr_b16 v[92:93], v20 offset:8192
    ds_read_b64_tr_b16 v[94:95], v20 offset:10240
    v_fma_f32 v137, v137, s34, -v27
    v_exp_f32 v137, v137
    v_fma_f32 v138, v138, s34, -v27
    v_exp_f32 v138, v138
    v_fma_f32 v139, v139, s34, -v27
    s_waitcnt lgkmcnt(6)
    v_mfma_f32_32x32x16_bf16 v[220:235], v[104:107], v[72:75], v[220:235]
    ds_read_b64_tr_b16 v[96:97], v21 offset:8192
    ds_read_b64_tr_b16 v[98:99], v21 offset:10240
    v_exp_f32 v139, v139
    v_add_f32 v4, v132, v133
    v_cvt_pk_bf16_f32 v80, v132, v133
    v_add_f32 v5, v134, v135
    v_cvt_pk_bf16_f32 v81, v134, v135
    s_waitcnt lgkmcnt(6)
    v_mfma_f32_32x32x16_bf16 v[172:187], v[84:87], v[76:79], v[172:187]
    ds_read_b64_tr_b16 v[100:101], v18 offset:12288
    ds_read_b64_tr_b16 v[102:103], v18 offset:14336
    v_add_f32 v6, v136, v137
    v_cvt_pk_bf16_f32 v82, v136, v137
    v_add_f32 v7, v138, v139
    v_cvt_pk_bf16_f32 v83, v138, v139
    v_add_f32 v4, v4, v5
    s_waitcnt lgkmcnt(6)
    v_mfma_f32_32x32x16_bf16 v[188:203], v[88:91], v[76:79], v[188:203]
    ds_read_b64_tr_b16 v[104:105], v19 offset:12288
    ds_read_b64_tr_b16 v[106:107], v19 offset:14336
    v_add_f32 v6, v6, v7
    v_add_f32 v26, v26, v4
    v_add_f32 v26, v26, v6
    s_waitcnt lgkmcnt(6)
    v_mfma_f32_32x32x16_bf16 v[204:219], v[92:95], v[76:79], v[204:219]
    ds_read_b64_tr_b16 v[84:85], v20 offset:12288
    ds_read_b64_tr_b16 v[86:87], v20 offset:14336
    s_waitcnt lgkmcnt(6)
    v_mfma_f32_32x32x16_bf16 v[220:235], v[96:99], v[76:79], v[220:235]
    ds_read_b64_tr_b16 v[88:89], v21 offset:12288
    ds_read_b64_tr_b16 v[90:91], v21 offset:14336
    s_waitcnt lgkmcnt(6)
    v_mfma_f32_32x32x16_bf16 v[172:187], v[100:103], v[80:83], v[172:187]
    ds_read_b128 v[92:95], v10 offset:49152
    s_waitcnt lgkmcnt(5)
    v_mfma_f32_32x32x16_bf16 v[188:203], v[104:107], v[80:83], v[188:203]
    ds_read_b128 v[96:99], v11 offset:49152
    s_waitcnt lgkmcnt(4)
    v_mfma_f32_32x32x16_bf16 v[204:219], v[84:87], v[80:83], v[204:219]
    ds_read_b128 v[100:103], v12 offset:49152
    s_waitcnt lgkmcnt(3)
    v_mfma_f32_32x32x16_bf16 v[220:235], v[88:91], v[80:83], v[220:235]
    ds_read_b128 v[104:107], v13 offset:49152
    v_max3_f32 v2, v140, v141, v142
    v_max3_f32 v3, v143, v144, v145
    v_max3_f32 v2, v2, v146, v147
    v_max3_f32 v3, v3, v148, v149
    v_max3_f32 v2, v2, v150, v151
    v_max3_f32 v3, v3, v152, v153
    s_waitcnt lgkmcnt(3)
    v_mfma_f32_32x32x16_bf16 v[108:123], v[92:95], v[36:39], 0
    ds_read_b128 v[84:87], v14 offset:49152
    v_max3_f32 v2, v2, v154, v155
    v_max3_f32 v3, v3, v156, v157
    v_max3_f32 v2, v2, v158, v159
    v_max3_f32 v3, v3, v160, v161
    v_max3_f32 v2, v2, v162, v163
    s_waitcnt lgkmcnt(3)
    v_mfma_f32_32x32x16_bf16 v[108:123], v[96:99], v[40:43], v[108:123]
    ds_read_b128 v[88:91], v15 offset:49152
    v_max3_f32 v3, v3, v164, v165
    v_max3_f32 v2, v2, v166, v167
    v_max3_f32 v3, v3, v168, v169
    v_max3_f32 v2, v2, v170, v171
    v_max_f32 v2, v2, v3
    s_waitcnt lgkmcnt(3)
    v_mfma_f32_32x32x16_bf16 v[108:123], v[100:103], v[44:47], v[108:123]
    ds_read_b128 v[92:95], v16 offset:49152
    v_mov_b32 v3, v2
    s_nop 1
    v_permlane32_swap_b32 v2, v3
    v_max_f32 v2, v2, v3
    v_sub_f32 v3, v2, v25
    v_cmp_lt_f32 vcc, s35, v3
    s_waitcnt lgkmcnt(3)
    v_mfma_f32_32x32x16_bf16 v[108:123], v[104:107], v[48:51], v[108:123]
    ds_read_b128 v[96:99], v17 offset:49152
    s_cbranch_vccz attn_kernel_nors2
    v_max_f32 v2, v2, v25
    v_sub_f32 v3, v25, v2
    v_mul_f32 v3, s34, v3
    v_exp_f32 v3, v3
    v_mov_b32 v25, v2
    v_mul_f32 v27, s34, v2
    v_mul_f32 v26, v26, v3
    v_mul_f32 v172, v172, v3
    v_mul_f32 v173, v173, v3
    v_mul_f32 v174, v174, v3
    v_mul_f32 v175, v175, v3
    v_mul_f32 v176, v176, v3
    v_mul_f32 v177, v177, v3
    v_mul_f32 v178, v178, v3
    v_mul_f32 v179, v179, v3
    v_mul_f32 v180, v180, v3
    v_mul_f32 v181, v181, v3
    v_mul_f32 v182, v182, v3
    v_mul_f32 v183, v183, v3
    v_mul_f32 v184, v184, v3
    v_mul_f32 v185, v185, v3
    v_mul_f32 v186, v186, v3
    v_mul_f32 v187, v187, v3
    v_mul_f32 v188, v188, v3
    v_mul_f32 v189, v189, v3
    v_mul_f32 v190, v190, v3
    v_mul_f32 v191, v191, v3
    v_mul_f32 v192, v192, v3
    v_mul_f32 v193, v193, v3
    v_mul_f32 v194, v194, v3
    v_mul_f32 v195, v195, v3
    v_mul_f32 v196, v196, v3
    v_mul_f32 v197, v197, v3
    v_mul_f32 v198, v198, v3
    v_mul_f32 v199, v199, v3
    v_mul_f32 v200, v200, v3
    v_mul_f32 v201, v201, v3
    v_mul_f32 v202, v202, v3
    v_mul_f32 v203, v203, v3
    v_mul_f32 v204, v204, v3
    v_mul_f32 v205, v205, v3
    v_mul_f32 v206, v206, v3
    v_mul_f32 v207, v207, v3
    v_mul_f32 v208, v208, v3
    v_mul_f32 v209, v209, v3
    v_mul_f32 v210, v210, v3
    v_mul_f32 v211, v211, v3
    v_mul_f32 v212, v212, v3
    v_mul_f32 v213, v213, v3
    v_mul_f32 v214, v214, v3
    v_mul_f32 v215, v215, v3
    v_mul_f32 v216, v216, v3
    v_mul_f32 v217, v217, v3
    v_mul_f32 v218, v218, v3
    v_mul_f32 v219, v219, v3
    v_mul_f32 v220, v220, v3
    v_mul_f32 v221, v221, v3
    v_mul_f32 v222, v222, v3
    v_mul_f32 v223, v223, v3
    v_mul_f32 v224, v224, v3
    v_mul_f32 v225, v225, v3
    v_mul_f32 v226, v226, v3
    v_mul_f32 v227, v227, v3
    v_mul_f32 v228, v228, v3
    v_mul_f32 v229, v229, v3
    v_mul_f32 v230, v230, v3
    v_mul_f32 v231, v231, v3
    v_mul_f32 v232, v232, v3
    v_mul_f32 v233, v233, v3
    v_mul_f32 v234, v234, v3
    v_mul_f32 v235, v235, v3
attn_kernel_nors2:
    v_fma_f32 v140, v140, s34, -v27
    v_exp_f32 v140, v140
    v_fma_f32 v141, v141, s34, -v27
    v_exp_f32 v141, v141
    s_waitcnt lgkmcnt(3)
    v_mfma_f32_32x32x16_bf16 v[108:123], v[84:87], v[52:55], v[108:123]
    ds_read_b128 v[100:103], v10 offset:57344
    v_fma_f32 v142, v142, s34, -v27
    v_exp_f32 v142, v142
    v_fma_f32 v143, v143, s34, -v27
    v_exp_f32 v143, v143
    v_fma_f32 v144, v144, s34, -v27
    s_waitcnt lgkmcnt(3)
    v_mfma_f32_32x32x16_bf16 v[108:123], v[88:91], v[56:59], v[108:123]
    ds_read_b128 v[104:107], v11 offset:57344
    v_exp_f32 v144, v144
    v_fma_f32 v145, v145, s34, -v27
    v_exp_f32 v145, v145
    v_fma_f32 v146, v146, s34, -v27
    v_exp_f32 v146, v146
    s_waitcnt lgkmcnt(3)
    v_mfma_f32_32x32x16_bf16 v[108:123], v[92:95], v[60:63], v[108:123]
    ds_read_b128 v[84:87], v12 offset:57344
    v_fma_f32 v147, v147, s34, -v27
    v_exp_f32 v147, v147
    v_add_f32 v4, v140, v141
    v_cvt_pk_bf16_f32 v68, v140, v141
    v_add_f32 v5, v142, v143
    s_waitcnt lgkmcnt(3)
    v_mfma_f32_32x32x16_bf16 v[108:123], v[96:99], v[64:67], v[108:123]
    ds_read_b128 v[88:91], v13 offset:57344
    v_cvt_pk_bf16_f32 v69, v142, v143
    v_add_f32 v6, v144, v145
    v_cvt_pk_bf16_f32 v70, v144, v145
    v_add_f32 v7, v146, v147
    v_cvt_pk_bf16_f32 v71, v146, v147
    s_waitcnt lgkmcnt(3)
    v_mfma_f32_32x32x16_bf16 v[124:139], v[100:103], v[36:39], 0
    ds_read_b128 v[92:95], v14 offset:57344
    v_add_f32 v4, v4, v5
    v_add_f32 v6, v6, v7
    v_add_f32 v26, v26, v4
    v_add_f32 v26, v26, v6
    v_fma_f32 v148, v148, s34, -v27
    s_waitcnt lgkmcnt(3)
    v_mfma_f32_32x32x16_bf16 v[124:139], v[104:107], v[40:43], v[124:139]
    ds_read_b128 v[96:99], v15 offset:57344
    v_exp_f32 v148, v148
    v_fma_f32 v149, v149, s34, -v27
    v_exp_f32 v149, v149
    v_fma_f32 v150, v150, s34, -v27
    v_exp_f32 v150, v150
    s_waitcnt lgkmcnt(3)
    v_mfma_f32_32x32x16_bf16 v[124:139], v[84:87], v[44:47], v[124:139]
    ds_read_b128 v[100:103], v16 offset:57344
    v_fma_f32 v151, v151, s34, -v27
    v_exp_f32 v151, v151
    v_fma_f32 v152, v152, s34, -v27
    v_exp_f32 v152, v152
    v_fma_f32 v153, v153, s34, -v27
    s_waitcnt lgkmcnt(3)
    v_mfma_f32_32x32x16_bf16 v[124:139], v[88:91], v[48:51], v[124:139]
    ds_read_b128 v[104:107], v17 offset:57344
    v_exp_f32 v153, v153
    v_fma_f32 v154, v154, s34, -v27
    v_exp_f32 v154, v154
    v_fma_f32 v155, v155, s34, -v27
    v_exp_f32 v155, v155
    s_waitcnt lgkmcnt(3)
    v_mfma_f32_32x32x16_bf16 v[124:139], v[92:95], v[52:55], v[124:139]
    ds_read_b64_tr_b16 v[84:85], v18 offset:16384
    ds_read_b64_tr_b16 v[86:87], v18 offset:18432
    v_add_f32 v4, v148, v149
    v_cvt_pk_bf16_f32 v72, v148, v149
    v_add_f32 v5, v150, v151
    v_cvt_pk_bf16_f32 v73, v150, v151
    v_add_f32 v6, v152, v153
    s_waitcnt lgkmcnt(4)
    v_mfma_f32_32x32x16_bf16 v[124:139], v[96:99], v[56:59], v[124:139]
    ds_read_b64_tr_b16 v[88:89], v19 offset:16384
    ds_read_b64_tr_b16 v[90:91], v19 offset:18432
    v_cvt_pk_bf16_f32 v74, v152, v153
    v_add_f32 v7, v154, v155
    v_cvt_pk_bf16_f32 v75, v154, v155
    v_add_f32 v4, v4, v5
    v_add_f32 v6, v6, v7
    s_waitcnt lgkmcnt(5)
    v_mfma_f32_32x32x16_bf16 v[124:139], v[100:103], v[60:63], v[124:139]
    ds_read_b64_tr_b16 v[92:93], v20 offset:16384
    ds_read_b64_tr_b16 v[94:95], v20 offset:18432
    v_add_f32 v26, v26, v4
    v_add_f32 v26, v26, v6
    v_fma_f32 v156, v156, s34, -v27
    v_exp_f32 v156, v156
    v_fma_f32 v157, v157, s34, -v27
    s_waitcnt lgkmcnt(6)
    v_mfma_f32_32x32x16_bf16 v[124:139], v[104:107], v[64:67], v[124:139]
    ds_read_b64_tr_b16 v[96:97], v21 offset:16384
    ds_read_b64_tr_b16 v[98:99], v21 offset:18432
    v_exp_f32 v157, v157
    v_fma_f32 v158, v158, s34, -v27
    v_exp_f32 v158, v158
    v_fma_f32 v159, v159, s34, -v27
    v_exp_f32 v159, v159
    s_waitcnt lgkmcnt(6)
    v_mfma_f32_32x32x16_bf16 v[172:187], v[84:87], v[68:71], v[172:187]
    ds_read_b64_tr_b16 v[100:101], v18 offset:20480
    ds_read_b64_tr_b16 v[102:103], v18 offset:22528
    v_fma_f32 v160, v160, s34, -v27
    v_exp_f32 v160, v160
    v_fma_f32 v161, v161, s34, -v27
    v_exp_f32 v161, v161
    v_fma_f32 v162, v162, s34, -v27
    s_waitcnt lgkmcnt(6)
    v_mfma_f32_32x32x16_bf16 v[188:203], v[88:91], v[68:71], v[188:203]
    ds_read_b64_tr_b16 v[104:105], v19 offset:20480
    ds_read_b64_tr_b16 v[106:107], v19 offset:22528
    v_exp_f32 v162, v162
    v_fma_f32 v163, v163, s34, -v27
    v_exp_f32 v163, v163
    v_add_f32 v4, v156, v157
    v_cvt_pk_bf16_f32 v76, v156, v157
    s_waitcnt lgkmcnt(6)
    v_mfma_f32_32x32x16_bf16 v[204:219], v[92:95], v[68:71], v[204:219]
    ds_read_b64_tr_b16 v[84:85], v20 offset:20480
    ds_read_b64_tr_b16 v[86:87], v20 offset:22528
    v_add_f32 v5, v158, v159
    v_cvt_pk_bf16_f32 v77, v158, v159
    v_add_f32 v6, v160, v161
    v_cvt_pk_bf16_f32 v78, v160, v161
    v_add_f32 v7, v162, v163
    s_waitcnt lgkmcnt(6)
    v_mfma_f32_32x32x16_bf16 v[220:235], v[96:99], v[68:71], v[220:235]
    ds_read_b64_tr_b16 v[88:89], v21 offset:20480
    ds_read_b64_tr_b16 v[90:91], v21 offset:22528
    v_cvt_pk_bf16_f32 v79, v162, v163
    v_add_f32 v4, v4, v5
    v_add_f32 v6, v6, v7
    v_add_f32 v26, v26, v4
    v_add_f32 v26, v26, v6
    s_waitcnt lgkmcnt(6)
    v_mfma_f32_32x32x16_bf16 v[172:187], v[100:103], v[72:75], v[172:187]
    ds_read_b64_tr_b16 v[92:93], v18 offset:24576
    ds_read_b64_tr_b16 v[94:95], v18 offset:26624
    v_fma_f32 v164, v164, s34, -v27
    v_exp_f32 v164, v164
    v_fma_f32 v165, v165, s34, -v27
    v_exp_f32 v165, v165
    v_fma_f32 v166, v166, s34, -v27
    s_waitcnt lgkmcnt(6)
    v_mfma_f32_32x32x16_bf16 v[188:203], v[104:107], v[72:75], v[188:203]
    ds_read_b64_tr_b16 v[96:97], v19 offset:24576
    ds_read_b64_tr_b16 v[98:99], v19 offset:26624
    v_exp_f32 v166, v166
    v_fma_f32 v167, v167, s34, -v27
    v_exp_f32 v167, v167
    v_fma_f32 v168, v168, s34, -v27
    v_exp_f32 v168, v168
    s_waitcnt lgkmcnt(6)
    v_mfma_f32_32x32x16_bf16 v[204:219], v[84:87], v[72:75], v[204:219]
    ds_read_b64_tr_b16 v[100:101], v20 offset:24576
    ds_read_b64_tr_b16 v[102:103], v20 offset:26624
    v_fma_f32 v169, v169, s34, -v27
    v_exp_f32 v169, v169
    v_fma_f32 v170, v170, s34, -v27
    v_exp_f32 v170, v170
    v_fma_f32 v171, v171, s34, -v27
    s_waitcnt lgkmcnt(6)
    v_mfma_f32_32x32x16_bf16 v[220:235], v[88:91], v[72:75], v[220:235]
    ds_read_b64_tr_b16 v[104:105], v21 offset:24576
    ds_read_b64_tr_b16 v[106:107], v21 offset:26624
    v_exp_f32 v171, v171
    v_add_f32 v4, v164, v165
    v_cvt_pk_bf16_f32 v80, v164, v165
    v_add_f32 v5, v166, v167
    v_cvt_pk_bf16_f32 v81, v166, v167
    s_waitcnt lgkmcnt(6)
    v_mfma_f32_32x32x16_bf16 v[172:187], v[92:95], v[76:79], v[172:187]
    ds_read_b64_tr_b16 v[84:85], v18 offset:28672
    ds_read_b64_tr_b16 v[86:87], v18 offset:30720
    v_add_f32 v6, v168, v169
    v_cvt_pk_bf16_f32 v82, v168, v169
    v_add_f32 v7, v170, v171
    v_cvt_pk_bf16_f32 v83, v170, v171
    v_add_f32 v4, v4, v5
    s_waitcnt lgkmcnt(6)
    v_mfma_f32_32x32x16_bf16 v[188:203], v[96:99], v[76:79], v[188:203]
    ds_read_b64_tr_b16 v[88:89], v19 offset:28672
    ds_read_b64_tr_b16 v[90:91], v19 offset:30720
    v_add_f32 v6, v6, v7
    v_add_f32 v26, v26, v4
    v_add_f32 v26, v26, v6
    s_waitcnt lgkmcnt(6)
    v_mfma_f32_32x32x16_bf16 v[204:219], v[100:103], v[76:79], v[204:219]
    ds_read_b64_tr_b16 v[92:93], v20 offset:28672
    ds_read_b64_tr_b16 v[94:95], v20 offset:30720
    s_waitcnt lgkmcnt(6)
    v_mfma_f32_32x32x16_bf16 v[220:235], v[104:107], v[76:79], v[220:235]
    ds_read_b64_tr_b16 v[96:97], v21 offset:28672
    ds_read_b64_tr_b16 v[98:99], v21 offset:30720
    s_waitcnt lgkmcnt(6)
    v_mfma_f32_32x32x16_bf16 v[172:187], v[84:87], v[80:83], v[172:187]
    s_waitcnt lgkmcnt(4)
    v_mfma_f32_32x32x16_bf16 v[188:203], v[88:91], v[80:83], v[188:203]
    s_waitcnt lgkmcnt(2)
    v_mfma_f32_32x32x16_bf16 v[204:219], v[92:95], v[80:83], v[204:219]
    s_waitcnt lgkmcnt(0)
    v_mfma_f32_32x32x16_bf16 v[220:235], v[96:99], v[80:83], v[220:235]
    s_waitcnt vmcnt(0)
    s_barrier
    ds_read_b128 v[84:87], v10 offset:0
    ds_read_b128 v[88:91], v11 offset:0
    ds_read_b128 v[92:95], v12 offset:0
    ds_read_b128 v[96:99], v13 offset:0
    s_add_u32 m0, s32, 32768
    s_nop 0
    buffer_load_dwordx4 v22, s[16:19], s29 offen lds
    buffer_load_dwordx4 v23, s[16:19], s29 offen offset:1024 lds
    s_add_u32 s29, s29, 16384
    s_add_u32 m0, s33, 0
    s_nop 0
    buffer_load_dwordx4 v24, s[20:23], s30 offen lds
    buffer_load_dwordx4 v24, s[20:23], s30 offen offset:1024 lds
    s_add_u32 s30, s30, 16384
    s_add_u32 m0, s32, 49152
    s_nop 0
    buffer_load_dwordx4 v22, s[16:19], s29 offen lds
    buffer_load_dwordx4 v23, s[16:19], s29 offen offset:1024 lds
    s_add_u32 s29, s29, 16384
    s_add_u32 m0, s33, 16384
    s_nop 0
    buffer_load_dwordx4 v24, s[20:23], s30 offen lds
    buffer_load_dwordx4 v24, s[20:23], s30 offen offset:1024 lds
    s_add_u32 s30, s30, 16384
    s_mov_b32 m0, s69
    s_nop 0
    buffer_load_dwordx4 v29, s[80:83], s68 offen lds
    buffer_load_dwordx4 v29, s[84:87], s68 offen lds
    s_add_u32 s68, s68, 2097152
    v_max3_f32 v2, v108, v109, v110
    v_max3_f32 v3, v111, v112, v113
    v_max3_f32 v2, v2, v114, v115
    v_max3_f32 v3, v3, v116, v117
    v_max3_f32 v2, v2, v118, v119
    v_max3_f32 v3, v3, v120, v121
    s_waitcnt lgkmcnt(3)
    v_mfma_f32_32x32x16_bf16 v[140:155], v[84:87], v[36:39], 0
    ds_read_b128 v[100:103], v14 offset:0
    v_max3_f32 v2, v2, v122, v123
    v_max3_f32 v3, v3, v124, v125
    v_max3_f32 v2, v2, v126, v127
    v_max3_f32 v3, v3, v128, v129
    v_max3_f32 v2, v2, v130, v131
    s_waitcnt lgkmcnt(3)
    v_mfma_f32_32x32x16_bf16 v[140:155], v[88:91], v[40:43], v[140:155]
    ds_read_b128 v[104:107], v15 offset:0
    v_max3_f32 v3, v3, v132, v133
    v_max3_f32 v2, v2, v134, v135
    v_max3_f32 v3, v3, v136, v137
    v_max3_f32 v2, v2, v138, v139
    v_max_f32 v2, v2, v3
    s_waitcnt lgkmcnt(3)
    v_mfma_f32_32x32x16_bf16 v[140:155], v[92:95], v[44:47], v[140:155]
    ds_read_b128 v[84:87], v16 offset:0
    v_mov_b32 v3, v2
    s_nop 1
    v_permlane32_swap_b32 v2, v3
    v_max_f32 v2, v2, v3
    v_sub_f32 v3, v2, v25
    v_cmp_lt_f32 vcc, s35, v3
    s_waitcnt lgkmcnt(3)
    v_mfma_f32_32x32x16_bf16 v[140:155], v[96:99], v[48:51], v[140:155]
    ds_read_b128 v[88:91], v17 offset:0
    s_cbranch_vccz attn_kernel_nors3
    v_max_f32 v2, v2, v25
    v_sub_f32 v3, v25, v2
    v_mul_f32 v3, s34, v3
    v_exp_f32 v3, v3
    v_mov_b32 v25, v2
    v_mul_f32 v27, s34, v2
    v_mul_f32 v26, v26, v3
    v_mul_f32 v172, v172, v3
    v_mul_f32 v173, v173, v3
    v_mul_f32 v174, v174, v3
    v_mul_f32 v175, v175, v3
    v_mul_f32 v176, v176, v3
    v_mul_f32 v177, v177, v3
    v_mul_f32 v178, v178, v3
    v_mul_f32 v179, v179, v3
    v_mul_f32 v180, v180, v3
    v_mul_f32 v181, v181, v3
    v_mul_f32 v182, v182, v3
    v_mul_f32 v183, v183, v3
    v_mul_f32 v184, v184, v3
    v_mul_f32 v185, v185, v3
    v_mul_f32 v186, v186, v3
    v_mul_f32 v187, v187, v3
    v_mul_f32 v188, v188, v3
    v_mul_f32 v189, v189, v3
    v_mul_f32 v190, v190, v3
    v_mul_f32 v191, v191, v3
    v_mul_f32 v192, v192, v3
    v_mul_f32 v193, v193, v3
    v_mul_f32 v194, v194, v3
    v_mul_f32 v195, v195, v3
    v_mul_f32 v196, v196, v3
    v_mul_f32 v197, v197, v3
    v_mul_f32 v198, v198, v3
    v_mul_f32 v199, v199, v3
    v_mul_f32 v200, v200, v3
    v_mul_f32 v201, v201, v3
    v_mul_f32 v202, v202, v3
    v_mul_f32 v203, v203, v3
    v_mul_f32 v204, v204, v3
    v_mul_f32 v205, v205, v3
    v_mul_f32 v206, v206, v3
    v_mul_f32 v207, v207, v3
    v_mul_f32 v208, v208, v3
    v_mul_f32 v209, v209, v3
    v_mul_f32 v210, v210, v3
    v_mul_f32 v211, v211, v3
    v_mul_f32 v212, v212, v3
    v_mul_f32 v213, v213, v3
    v_mul_f32 v214, v214, v3
    v_mul_f32 v215, v215, v3
    v_mul_f32 v216, v216, v3
    v_mul_f32 v217, v217, v3
    v_mul_f32 v218, v218, v3
    v_mul_f32 v219, v219, v3
    v_mul_f32 v220, v220, v3
    v_mul_f32 v221, v221, v3
    v_mul_f32 v222, v222, v3
    v_mul_f32 v223, v223, v3
    v_mul_f32 v224, v224, v3
    v_mul_f32 v225, v225, v3
    v_mul_f32 v226, v226, v3
    v_mul_f32 v227, v227, v3
    v_mul_f32 v228, v228, v3
    v_mul_f32 v229, v229, v3
    v_mul_f32 v230, v230, v3
    v_mul_f32 v231, v231, v3
    v_mul_f32 v232, v232, v3
    v_mul_f32 v233, v233, v3
    v_mul_f32 v234, v234, v3
    v_mul_f32 v235, v235, v3
attn_kernel_nors3:
    v_fma_f32 v108, v108, s34, -v27
    v_exp_f32 v108, v108
    v_fma_f32 v109, v109, s34, -v27
    v_exp_f32 v109, v109
    s_waitcnt lgkmcnt(3)
    v_mfma_f32_32x32x16_bf16 v[140:155], v[100:103], v[52:55], v[140:155]
    ds_read_b128 v[92:95], v10 offset:8192
    v_fma_f32 v110, v110, s34, -v27
    v_exp_f32 v110, v110
    v_fma_f32 v111, v111, s34, -v27
    v_exp_f32 v111, v111
    v_fma_f32 v112, v112, s34, -v27
    s_waitcnt lgkmcnt(3)
    v_mfma_f32_32x32x16_bf16 v[140:155], v[104:107], v[56:59], v[140:155]
    ds_read_b128 v[96:99], v11 offset:8192
    v_exp_f32 v112, v112
    v_fma_f32 v113, v113, s34, -v27
    v_exp_f32 v113, v113
    v_fma_f32 v114, v114, s34, -v27
    v_exp_f32 v114, v114
    s_waitcnt lgkmcnt(3)
    v_mfma_f32_32x32x16_bf16 v[140:155], v[84:87], v[60:63], v[140:155]
    ds_read_b128 v[100:103], v12 offset:8192
    v_fma_f32 v115, v115, s34, -v27
    v_exp_f32 v115, v115
    v_add_f32 v4, v108, v109
    v_cvt_pk_bf16_f32 v68, v108, v109
    v_add_f32 v5, v110, v111
    s_waitcnt lgkmcnt(3)
    v_mfma_f32_32x32x16_bf16 v[140:155], v[88:91], v[64:67], v[140:155]
    ds_read_b128 v[104:107], v13 offset:8192
    v_cvt_pk_bf16_f32 v69, v110, v111
    v_add_f32 v6, v112, v113
    v_cvt_pk_bf16_f32 v70, v112, v113
    v_add_f32 v7, v114, v115
    v_cvt_pk_bf16_f32 v71, v114, v115
    s_waitcnt lgkmcnt(3)
    v_mfma_f32_32x32x16_bf16 v[156:171], v[92:95], v[36:39], 0
    ds_read_b128 v[84:87], v14 offset:8192
    v_add_f32 v4, v4, v5
    v_add_f32 v6, v6, v7
    v_add_f32 v26, v26, v4
    v_add_f32 v26, v26, v6
    v_fma_f32 v116, v116, s34, -v27
    s_waitcnt lgkmcnt(3)
    v_mfma_f32_32x32x16_bf16 v[156:171], v[96:99], v[40:43], v[156:171]
    ds_read_b128 v[88:91], v15 offset:8192
    v_exp_f32 v116, v116
    v_fma_f32 v117, v117, s34, -v27
    v_exp_f32 v117, v117
    v_fma_f32 v118, v118, s34, -v27
    v_exp_f32 v118, v118
    s_waitcnt lgkmcnt(3)
    v_mfma_f32_32x32x16_bf16 v[156:171], v[100:103], v[44:47], v[156:171]
    ds_read_b128 v[92:95], v16 offset:8192
    v_fma_f32 v119, v119, s34, -v27
    v_exp_f32 v119, v119
    v_fma_f32 v120, v120, s34, -v27
    v_exp_f32 v120, v120
    v_fma_f32 v121, v121, s34, -v27
    s_waitcnt lgkmcnt(3)
    v_mfma_f32_32x32x16_bf16 v[156:171], v[104:107], v[48:51], v[156:171]
    ds_read_b128 v[96:99], v17 offset:8192
    v_exp_f32 v121, v121
    v_fma_f32 v122, v122, s34, -v27
    v_exp_f32 v122, v122
    v_fma_f32 v123, v123, s34, -v27
    v_exp_f32 v123, v123
    s_waitcnt lgkmcnt(3)
    v_mfma_f32_32x32x16_bf16 v[156:171], v[84:87], v[52:55], v[156:171]
    ds_read_b64_tr_b16 v[100:101], v18 offset:32768
    ds_read_b64_tr_b16 v[102:103], v18 offset:34816
    v_add_f32 v4, v116, v117
    v_cvt_pk_bf16_f32 v72, v116, v117
    v_add_f32 v5, v118, v119
    v_cvt_pk_bf16_f32 v73, v118, v119
    v_add_f32 v6, v120, v121
    s_waitcnt lgkmcnt(4)
    v_mfma_f32_32x32x16_bf16 v[156:171], v[88:91], v[56:59], v[156:171]
    ds_read_b64_tr_b16 v[104:105], v19 offset:32768
    ds_read_b64_tr_b16 v[106:107], v19 offset:34816
    v_cvt_pk_bf16_f32 v74, v120, v121
    v_add_f32 v7, v122, v123
    v_cvt_pk_bf16_f32 v75, v122, v123
    v_add_f32 v4, v4, v5
    v_add_f32 v6, v6, v7
    s_waitcnt lgkmcnt(5)
    v_mfma_f32_32x32x16_bf16 v[156:171], v[92:95], v[60:63], v[156:171]
    ds_read_b64_tr_b16 v[84:85], v20 offset:32768
    ds_read_b64_tr_b16 v[86:87], v20 offset:34816
    v_add_f32 v26, v26, v4
    v_add_f32 v26, v26, v6
    v_fma_f32 v124, v124, s34, -v27
    v_exp_f32 v124, v124
    v_fma_f32 v125, v125, s34, -v27
    s_waitcnt lgkmcnt(6)
    v_mfma_f32_32x32x16_bf16 v[156:171], v[96:99], v[64:67], v[156:171]
    ds_read_b64_tr_b16 v[88:89], v21 offset:32768
    ds_read_b64_tr_b16 v[90:91], v21 offset:34816
    v_exp_f32 v125, v125
    v_fma_f32 v126, v126, s34, -v27
    v_exp_f32 v126, v126
    v_fma_f32 v127, v127, s34, -v27
    v_exp_f32 v127, v127
    s_waitcnt lgkmcnt(6)
    v_mfma_f32_32x32x16_bf16 v[172:187], v[100:103], v[68:71], v[172:187]
    ds_read_b64_tr_b16 v[92:93], v18 offset:36864
    ds_read_b64_tr_b16 v[94:95], v18 offset:38912
    v_fma_f32 v128, v128, s34, -v27
    v_exp_f32 v128, v128
    v_fma_f32 v129, v129, s34, -v27
    v_exp_f32 v129, v129
    v_fma_f32 v130, v130, s34, -v27
    s_waitcnt lgkmcnt(6)
    v_mfma_f32_32x32x16_bf16 v[188:203], v[104:107], v[68:71], v[188:203]
    ds_read_b64_tr_b16 v[96:97], v19 offset:36864
    ds_read_b64_tr_b16 v[98:99], v19 offset:38912
    v_exp_f32 v130, v130
    v_fma_f32 v131, v131, s34, -v27
    v_exp_f32 v131, v131
    v_add_f32 v4, v124, v125
    v_cvt_pk_bf16_f32 v76, v124, v125
    s_waitcnt lgkmcnt(6)
    v_mfma_f32_32x32x16_bf16 v[204:219], v[84:87], v[68:71], v[204:219]
    ds_read_b64_tr_b16 v[100:101], v20 offset:36864
    ds_read_b64_tr_b16 v[102:103], v20 offset:38912
    v_add_f32 v5, v126, v127
    v_cvt_pk_bf16_f32 v77, v126, v127
    v_add_f32 v6, v128, v129
    v_cvt_pk_bf16_f32 v78, v128, v129
    v_add_f32 v7, v130, v131
    s_waitcnt lgkmcnt(6)
    v_mfma_f32_32x32x16_bf16 v[220:235], v[88:91], v[68:71], v[220:235]
    ds_read_b64_tr_b16 v[104:105], v21 offset:36864
    ds_read_b64_tr_b16 v[106:107], v21 offset:38912
    v_cvt_pk_bf16_f32 v79, v130, v131
    v_add_f32 v4, v4, v5
    v_add_f32 v6, v6, v7
    v_add_f32 v26, v26, v4
    v_add_f32 v26, v26, v6
    s_waitcnt lgkmcnt(6)
    v_mfma_f32_32x32x16_bf16 v[172:187], v[92:95], v[72:75], v[172:187]
    ds_read_b64_tr_b16 v[84:85], v18 offset:40960
    ds_read_b64_tr_b16 v[86:87], v18 offset:43008
    v_fma_f32 v132, v132, s34, -v27
    v_exp_f32 v132, v132
    v_fma_f32 v133, v133, s34, -v27
    v_exp_f32 v133, v133
    v_fma_f32 v134, v134, s34, -v27
    s_waitcnt lgkmcnt(6)
    v_mfma_f32_32x32x16_bf16 v[188:203], v[96:99], v[72:75], v[188:203]
    ds_read_b64_tr_b16 v[88:89], v19 offset:40960
    ds_read_b64_tr_b16 v[90:91], v19 offset:43008
    v_exp_f32 v134, v134
    v_fma_f32 v135, v135, s34, -v27
    v_exp_f32 v135, v135
    v_fma_f32 v136, v136, s34, -v27
    v_exp_f32 v136, v136
    s_waitcnt lgkmcnt(6)
    v_mfma_f32_32x32x16_bf16 v[204:219], v[100:103], v[72:75], v[204:219]
    ds_read_b64_tr_b16 v[92:93], v20 offset:40960
    ds_read_b64_tr_b16 v[94:95], v20 offset:43008
    v_fma_f32 v137, v137, s34, -v27
    v_exp_f32 v137, v137
    v_fma_f32 v138, v138, s34, -v27
    v_exp_f32 v138, v138
    v_fma_f32 v139, v139, s34, -v27
    s_waitcnt lgkmcnt(6)
    v_mfma_f32_32x32x16_bf16 v[220:235], v[104:107], v[72:75], v[220:235]
    ds_read_b64_tr_b16 v[96:97], v21 offset:40960
    ds_read_b64_tr_b16 v[98:99], v21 offset:43008
    v_exp_f32 v139, v139
    v_add_f32 v4, v132, v133
    v_cvt_pk_bf16_f32 v80, v132, v133
    v_add_f32 v5, v134, v135
    v_cvt_pk_bf16_f32 v81, v134, v135
    s_waitcnt lgkmcnt(6)
    v_mfma_f32_32x32x16_bf16 v[172:187], v[84:87], v[76:79], v[172:187]
    ds_read_b64_tr_b16 v[100:101], v18 offset:45056
    ds_read_b64_tr_b16 v[102:103], v18 offset:47104
    v_add_f32 v6, v136, v137
    v_cvt_pk_bf16_f32 v82, v136, v137
    v_add_f32 v7, v138, v139
    v_cvt_pk_bf16_f32 v83, v138, v139
    v_add_f32 v4, v4, v5
    s_waitcnt lgkmcnt(6)
    v_mfma_f32_32x32x16_bf16 v[188:203], v[88:91], v[76:79], v[188:203]
    ds_read_b64_tr_b16 v[104:105], v19 offset:45056
    ds_read_b64_tr_b16 v[106:107], v19 offset:47104
    v_add_f32 v6, v6, v7
    v_add_f32 v26, v26, v4
    v_add_f32 v26, v26, v6
    s_waitcnt lgkmcnt(6)
    v_mfma_f32_32x32x16_bf16 v[204:219], v[92:95], v[76:79], v[204:219]
    ds_read_b64_tr_b16 v[84:85], v20 offset:45056
    ds_read_b64_tr_b16 v[86:87], v20 offset:47104
    s_waitcnt lgkmcnt(6)
    v_mfma_f32_32x32x16_bf16 v[220:235], v[96:99], v[76:79], v[220:235]
    ds_read_b64_tr_b16 v[88:89], v21 offset:45056
    ds_read_b64_tr_b16 v[90:91], v21 offset:47104
    s_waitcnt lgkmcnt(6)
    v_mfma_f32_32x32x16_bf16 v[172:187], v[100:103], v[80:83], v[172:187]
    ds_read_b128 v[92:95], v10 offset:16384
    s_waitcnt lgkmcnt(5)
    v_mfma_f32_32x32x16_bf16 v[188:203], v[104:107], v[80:83], v[188:203]
    ds_read_b128 v[96:99], v11 offset:16384
    s_waitcnt lgkmcnt(4)
    v_mfma_f32_32x32x16_bf16 v[204:219], v[84:87], v[80:83], v[204:219]
    ds_read_b128 v[100:103], v12 offset:16384
    s_waitcnt lgkmcnt(3)
    v_mfma_f32_32x32x16_bf16 v[220:235], v[88:91], v[80:83], v[220:235]
    ds_read_b128 v[104:107], v13 offset:16384
    v_max3_f32 v2, v140, v141, v142
    v_max3_f32 v3, v143, v144, v145
    v_max3_f32 v2, v2, v146, v147
    v_max3_f32 v3, v3, v148, v149
    v_max3_f32 v2, v2, v150, v151
    v_max3_f32 v3, v3, v152, v153
    s_waitcnt lgkmcnt(3)
    v_mfma_f32_32x32x16_bf16 v[108:123], v[92:95], v[36:39], 0
    ds_read_b128 v[84:87], v14 offset:16384
    v_max3_f32 v2, v2, v154, v155
    v_max3_f32 v3, v3, v156, v157
    v_max3_f32 v2, v2, v158, v159
    v_max3_f32 v3, v3, v160, v161
    v_max3_f32 v2, v2, v162, v163
    s_waitcnt lgkmcnt(3)
    v_mfma_f32_32x32x16_bf16 v[108:123], v[96:99], v[40:43], v[108:123]
    ds_read_b128 v[88:91], v15 offset:16384
    v_max3_f32 v3, v3, v164, v165
    v_max3_f32 v2, v2, v166, v167
    v_max3_f32 v3, v3, v168, v169
    v_max3_f32 v2, v2, v170, v171
    v_max_f32 v2, v2, v3
    s_waitcnt lgkmcnt(3)
    v_mfma_f32_32x32x16_bf16 v[108:123], v[100:103], v[44:47], v[108:123]
    ds_read_b128 v[92:95], v16 offset:16384
    v_mov_b32 v3, v2
    s_nop 1
    v_permlane32_swap_b32 v2, v3
    v_max_f32 v2, v2, v3
    v_sub_f32 v3, v2, v25
    v_cmp_lt_f32 vcc, s35, v3
    s_waitcnt lgkmcnt(3)
    v_mfma_f32_32x32x16_bf16 v[108:123], v[104:107], v[48:51], v[108:123]
    ds_read_b128 v[96:99], v17 offset:16384
    s_cbranch_vccz attn_kernel_nors4
    v_max_f32 v2, v2, v25
    v_sub_f32 v3, v25, v2
    v_mul_f32 v3, s34, v3
    v_exp_f32 v3, v3
    v_mov_b32 v25, v2
    v_mul_f32 v27, s34, v2
    v_mul_f32 v26, v26, v3
    v_mul_f32 v172, v172, v3
    v_mul_f32 v173, v173, v3
    v_mul_f32 v174, v174, v3
    v_mul_f32 v175, v175, v3
    v_mul_f32 v176, v176, v3
    v_mul_f32 v177, v177, v3
    v_mul_f32 v178, v178, v3
    v_mul_f32 v179, v179, v3
    v_mul_f32 v180, v180, v3
    v_mul_f32 v181, v181, v3
    v_mul_f32 v182, v182, v3
    v_mul_f32 v183, v183, v3
    v_mul_f32 v184, v184, v3
    v_mul_f32 v185, v185, v3
    v_mul_f32 v186, v186, v3
    v_mul_f32 v187, v187, v3
    v_mul_f32 v188, v188, v3
    v_mul_f32 v189, v189, v3
    v_mul_f32 v190, v190, v3
    v_mul_f32 v191, v191, v3
    v_mul_f32 v192, v192, v3
    v_mul_f32 v193, v193, v3
    v_mul_f32 v194, v194, v3
    v_mul_f32 v195, v195, v3
    v_mul_f32 v196, v196, v3
    v_mul_f32 v197, v197, v3
    v_mul_f32 v198, v198, v3
    v_mul_f32 v199, v199, v3
    v_mul_f32 v200, v200, v3
    v_mul_f32 v201, v201, v3
    v_mul_f32 v202, v202, v3
    v_mul_f32 v203, v203, v3
    v_mul_f32 v204, v204, v3
    v_mul_f32 v205, v205, v3
    v_mul_f32 v206, v206, v3
    v_mul_f32 v207, v207, v3
    v_mul_f32 v208, v208, v3
    v_mul_f32 v209, v209, v3
    v_mul_f32 v210, v210, v3
    v_mul_f32 v211, v211, v3
    v_mul_f32 v212, v212, v3
    v_mul_f32 v213, v213, v3
    v_mul_f32 v214, v214, v3
    v_mul_f32 v215, v215, v3
    v_mul_f32 v216, v216, v3
    v_mul_f32 v217, v217, v3
    v_mul_f32 v218, v218, v3
    v_mul_f32 v219, v219, v3
    v_mul_f32 v220, v220, v3
    v_mul_f32 v221, v221, v3
    v_mul_f32 v222, v222, v3
    v_mul_f32 v223, v223, v3
    v_mul_f32 v224, v224, v3
    v_mul_f32 v225, v225, v3
    v_mul_f32 v226, v226, v3
    v_mul_f32 v227, v227, v3
    v_mul_f32 v228, v228, v3
    v_mul_f32 v229, v229, v3
    v_mul_f32 v230, v230, v3
    v_mul_f32 v231, v231, v3
    v_mul_f32 v232, v232, v3
    v_mul_f32 v233, v233, v3
    v_mul_f32 v234, v234, v3
    v_mul_f32 v235, v235, v3
attn_kernel_nors4:
    v_fma_f32 v140, v140, s34, -v27
    v_exp_f32 v140, v140
    v_fma_f32 v141, v141, s34, -v27
    v_exp_f32 v141, v141
    s_waitcnt lgkmcnt(3)
    v_mfma_f32_32x32x16_bf16 v[108:123], v[84:87], v[52:55], v[108:123]
    ds_read_b128 v[100:103], v10 offset:24576
    v_fma_f32 v142, v142, s34, -v27
    v_exp_f32 v142, v142
    v_fma_f32 v143, v143, s34, -v27
    v_exp_f32 v143, v143
    v_fma_f32 v144, v144, s34, -v27
    s_waitcnt lgkmcnt(3)
    v_mfma_f32_32x32x16_bf16 v[108:123], v[88:91], v[56:59], v[108:123]
    ds_read_b128 v[104:107], v11 offset:24576
    v_exp_f32 v144, v144
    v_fma_f32 v145, v145, s34, -v27
    v_exp_f32 v145, v145
    v_fma_f32 v146, v146, s34, -v27
    v_exp_f32 v146, v146
    s_waitcnt lgkmcnt(3)
    v_mfma_f32_32x32x16_bf16 v[108:123], v[92:95], v[60:63], v[108:123]
    ds_read_b128 v[84:87], v12 offset:24576
    v_fma_f32 v147, v147, s34, -v27
    v_exp_f32 v147, v147
    v_add_f32 v4, v140, v141
    v_cvt_pk_bf16_f32 v68, v140, v141
    v_add_f32 v5, v142, v143
    s_waitcnt lgkmcnt(3)
    v_mfma_f32_32x32x16_bf16 v[108:123], v[96:99], v[64:67], v[108:123]
    ds_read_b128 v[88:91], v13 offset:24576
    v_cvt_pk_bf16_f32 v69, v142, v143
    v_add_f32 v6, v144, v145
    v_cvt_pk_bf16_f32 v70, v144, v145
    v_add_f32 v7, v146, v147
    v_cvt_pk_bf16_f32 v71, v146, v147
    s_waitcnt lgkmcnt(3)
    v_mfma_f32_32x32x16_bf16 v[124:139], v[100:103], v[36:39], 0
    ds_read_b128 v[92:95], v14 offset:24576
    v_add_f32 v4, v4, v5
    v_add_f32 v6, v6, v7
    v_add_f32 v26, v26, v4
    v_add_f32 v26, v26, v6
    v_fma_f32 v148, v148, s34, -v27
    s_waitcnt lgkmcnt(3)
    v_mfma_f32_32x32x16_bf16 v[124:139], v[104:107], v[40:43], v[124:139]
    ds_read_b128 v[96:99], v15 offset:24576
    v_exp_f32 v148, v148
    v_fma_f32 v149, v149, s34, -v27
    v_exp_f32 v149, v149
    v_fma_f32 v150, v150, s34, -v27
    v_exp_f32 v150, v150
    s_waitcnt lgkmcnt(3)
    v_mfma_f32_32x32x16_bf16 v[124:139], v[84:87], v[44:47], v[124:139]
    ds_read_b128 v[100:103], v16 offset:24576
    v_fma_f32 v151, v151, s34, -v27
    v_exp_f32 v151, v151
    v_fma_f32 v152, v152, s34, -v27
    v_exp_f32 v152, v152
    v_fma_f32 v153, v153, s34, -v27
    s_waitcnt lgkmcnt(3)
    v_mfma_f32_32x32x16_bf16 v[124:139], v[88:91], v[48:51], v[124:139]
    ds_read_b128 v[104:107], v17 offset:24576
    v_exp_f32 v153, v153
    v_fma_f32 v154, v154, s34, -v27
    v_exp_f32 v154, v154
    v_fma_f32 v155, v155, s34, -v27
    v_exp_f32 v155, v155
    s_waitcnt lgkmcnt(3)
    v_mfma_f32_32x32x16_bf16 v[124:139], v[92:95], v[52:55], v[124:139]
    ds_read_b64_tr_b16 v[84:85], v18 offset:49152
    ds_read_b64_tr_b16 v[86:87], v18 offset:51200
    v_add_f32 v4, v148, v149
    v_cvt_pk_bf16_f32 v72, v148, v149
    v_add_f32 v5, v150, v151
    v_cvt_pk_bf16_f32 v73, v150, v151
    v_add_f32 v6, v152, v153
    s_waitcnt lgkmcnt(4)
    v_mfma_f32_32x32x16_bf16 v[124:139], v[96:99], v[56:59], v[124:139]
    ds_read_b64_tr_b16 v[88:89], v19 offset:49152
    ds_read_b64_tr_b16 v[90:91], v19 offset:51200
    v_cvt_pk_bf16_f32 v74, v152, v153
    v_add_f32 v7, v154, v155
    v_cvt_pk_bf16_f32 v75, v154, v155
    v_add_f32 v4, v4, v5
    v_add_f32 v6, v6, v7
    s_waitcnt lgkmcnt(5)
    v_mfma_f32_32x32x16_bf16 v[124:139], v[100:103], v[60:63], v[124:139]
    ds_read_b64_tr_b16 v[92:93], v20 offset:49152
    ds_read_b64_tr_b16 v[94:95], v20 offset:51200
    v_add_f32 v26, v26, v4
    v_add_f32 v26, v26, v6
    v_fma_f32 v156, v156, s34, -v27
    v_exp_f32 v156, v156
    v_fma_f32 v157, v157, s34, -v27
    s_waitcnt lgkmcnt(6)
    v_mfma_f32_32x32x16_bf16 v[124:139], v[104:107], v[64:67], v[124:139]
    ds_read_b64_tr_b16 v[96:97], v21 offset:49152
    ds_read_b64_tr_b16 v[98:99], v21 offset:51200
    v_exp_f32 v157, v157
    v_fma_f32 v158, v158, s34, -v27
    v_exp_f32 v158, v158
    v_fma_f32 v159, v159, s34, -v27
    v_exp_f32 v159, v159
    s_waitcnt lgkmcnt(6)
    v_mfma_f32_32x32x16_bf16 v[172:187], v[84:87], v[68:71], v[172:187]
    ds_read_b64_tr_b16 v[100:101], v18 offset:53248
    ds_read_b64_tr_b16 v[102:103], v18 offset:55296
    v_fma_f32 v160, v160, s34, -v27
    v_exp_f32 v160, v160
    v_fma_f32 v161, v161, s34, -v27
    v_exp_f32 v161, v161
    v_fma_f32 v162, v162, s34, -v27
    s_waitcnt lgkmcnt(6)
    v_mfma_f32_32x32x16_bf16 v[188:203], v[88:91], v[68:71], v[188:203]
    ds_read_b64_tr_b16 v[104:105], v19 offset:53248
    ds_read_b64_tr_b16 v[106:107], v19 offset:55296
    v_exp_f32 v162, v162
    v_fma_f32 v163, v163, s34, -v27
    v_exp_f32 v163, v163
    v_add_f32 v4, v156, v157
    v_cvt_pk_bf16_f32 v76, v156, v157
    s_waitcnt lgkmcnt(6)
    v_mfma_f32_32x32x16_bf16 v[204:219], v[92:95], v[68:71], v[204:219]
    ds_read_b64_tr_b16 v[84:85], v20 offset:53248
    ds_read_b64_tr_b16 v[86:87], v20 offset:55296
    v_add_f32 v5, v158, v159
    v_cvt_pk_bf16_f32 v77, v158, v159
    v_add_f32 v6, v160, v161
    v_cvt_pk_bf16_f32 v78, v160, v161
    v_add_f32 v7, v162, v163
    s_waitcnt lgkmcnt(6)
    v_mfma_f32_32x32x16_bf16 v[220:235], v[96:99], v[68:71], v[220:235]
    ds_read_b64_tr_b16 v[88:89], v21 offset:53248
    ds_read_b64_tr_b16 v[90:91], v21 offset:55296
    v_cvt_pk_bf16_f32 v79, v162, v163
    v_add_f32 v4, v4, v5
    v_add_f32 v6, v6, v7
    v_add_f32 v26, v26, v4
    v_add_f32 v26, v26, v6
    s_waitcnt lgkmcnt(6)
    v_mfma_f32_32x32x16_bf16 v[172:187], v[100:103], v[72:75], v[172:187]
    ds_read_b64_tr_b16 v[92:93], v18 offset:57344
    ds_read_b64_tr_b16 v[94:95], v18 offset:59392
    v_fma_f32 v164, v164, s34, -v27
    v_exp_f32 v164, v164
    v_fma_f32 v165, v165, s34, -v27
    v_exp_f32 v165, v165
    v_fma_f32 v166, v166, s34, -v27
    s_waitcnt lgkmcnt(6)
    v_mfma_f32_32x32x16_bf16 v[188:203], v[104:107], v[72:75], v[188:203]
    ds_read_b64_tr_b16 v[96:97], v19 offset:57344
    ds_read_b64_tr_b16 v[98:99], v19 offset:59392
    v_exp_f32 v166, v166
    v_fma_f32 v167, v167, s34, -v27
    v_exp_f32 v167, v167
    v_fma_f32 v168, v168, s34, -v27
    v_exp_f32 v168, v168
    s_waitcnt lgkmcnt(6)
    v_mfma_f32_32x32x16_bf16 v[204:219], v[84:87], v[72:75], v[204:219]
    ds_read_b64_tr_b16 v[100:101], v20 offset:57344
    ds_read_b64_tr_b16 v[102:103], v20 offset:59392
    v_fma_f32 v169, v169, s34, -v27
    v_exp_f32 v169, v169
    v_fma_f32 v170, v170, s34, -v27
    v_exp_f32 v170, v170
    v_fma_f32 v171, v171, s34, -v27
    s_waitcnt lgkmcnt(6)
    v_mfma_f32_32x32x16_bf16 v[220:235], v[88:91], v[72:75], v[220:235]
    ds_read_b64_tr_b16 v[104:105], v21 offset:57344
    ds_read_b64_tr_b16 v[106:107], v21 offset:59392
    v_exp_f32 v171, v171
    v_add_f32 v4, v164, v165
    v_cvt_pk_bf16_f32 v80, v164, v165
    v_add_f32 v5, v166, v167
    v_cvt_pk_bf16_f32 v81, v166, v167
    s_waitcnt lgkmcnt(6)
    v_mfma_f32_32x32x16_bf16 v[172:187], v[92:95], v[76:79], v[172:187]
    ds_read_b64_tr_b16 v[84:85], v18 offset:61440
    ds_read_b64_tr_b16 v[86:87], v18 offset:63488
    v_add_f32 v6, v168, v169
    v_cvt_pk_bf16_f32 v82, v168, v169
    v_add_f32 v7, v170, v171
    v_cvt_pk_bf16_f32 v83, v170, v171
    v_add_f32 v4, v4, v5
    s_waitcnt lgkmcnt(6)
    v_mfma_f32_32x32x16_bf16 v[188:203], v[96:99], v[76:79], v[188:203]
    ds_read_b64_tr_b16 v[88:89], v19 offset:61440
    ds_read_b64_tr_b16 v[90:91], v19 offset:63488
    v_add_f32 v6, v6, v7
    v_add_f32 v26, v26, v4
    v_add_f32 v26, v26, v6
    s_waitcnt lgkmcnt(6)
    v_mfma_f32_32x32x16_bf16 v[204:219], v[100:103], v[76:79], v[204:219]
    ds_read_b64_tr_b16 v[92:93], v20 offset:61440
    ds_read_b64_tr_b16 v[94:95], v20 offset:63488
    s_waitcnt lgkmcnt(6)
    v_mfma_f32_32x32x16_bf16 v[220:235], v[104:107], v[76:79], v[220:235]
    ds_read_b64_tr_b16 v[96:97], v21 offset:61440
    ds_read_b64_tr_b16 v[98:99], v21 offset:63488
    s_waitcnt lgkmcnt(6)
    v_mfma_f32_32x32x16_bf16 v[172:187], v[84:87], v[80:83], v[172:187]
    s_waitcnt lgkmcnt(4)
    v_mfma_f32_32x32x16_bf16 v[188:203], v[88:91], v[80:83], v[188:203]
    s_waitcnt lgkmcnt(2)
    v_mfma_f32_32x32x16_bf16 v[204:219], v[92:95], v[80:83], v[204:219]
    s_waitcnt lgkmcnt(0)
    v_mfma_f32_32x32x16_bf16 v[220:235], v[96:99], v[80:83], v[220:235]
    s_sub_u32 s31, s31, 1
    s_cmp_lg_u32 s31, 0
    s_cbranch_scc1 attn_kernel_loop
    s_waitcnt vmcnt(0)
    s_barrier
    ds_read_b128 v[84:87], v10 offset:32768
    ds_read_b128 v[88:91], v11 offset:32768
    ds_read_b128 v[92:95], v12 offset:32768
    ds_read_b128 v[96:99], v13 offset:32768
    s_add_u32 m0, s32, 0
    s_nop 0
    buffer_load_dwordx4 v22, s[16:19], s29 offen lds
    buffer_load_dwordx4 v23, s[16:19], s29 offen offset:1024 lds
    s_add_u32 s29, s29, 16384
    s_add_u32 m0, s33, 32768
    s_nop 0
    buffer_load_dwordx4 v24, s[20:23], s30 offen lds
    buffer_load_dwordx4 v24, s[20:23], s30 offen offset:1024 lds
    s_add_u32 s30, s30, 16384
    s_add_u32 m0, s32, 16384
    s_nop 0
    buffer_load_dwordx4 v22, s[16:19], s29 offen lds
    buffer_load_dwordx4 v23, s[16:19], s29 offen offset:1024 lds
    s_add_u32 s29, s29, 16384
    s_add_u32 m0, s33, 49152
    s_nop 0
    buffer_load_dwordx4 v24, s[20:23], s30 offen lds
    buffer_load_dwordx4 v24, s[20:23], s30 offen offset:1024 lds
    s_add_u32 s30, s30, 16384
    s_mov_b32 m0, s69
    s_nop 0
    buffer_load_dwordx4 v29, s[72:75], s68 offen lds
    buffer_load_dwordx4 v29, s[76:79], s68 offen lds
    v_max3_f32 v2, v108, v109, v110
    v_max3_f32 v3, v111, v112, v113
    v_max3_f32 v2, v2, v114, v115
    v_max3_f32 v3, v3, v116, v117
    v_max3_f32 v2, v2, v118, v119
    v_max3_f32 v3, v3, v120, v121
    s_waitcnt lgkmcnt(3)
    v_mfma_f32_32x32x16_bf16 v[140:155], v[84:87], v[36:39], 0
    ds_read_b128 v[100:103], v14 offset:32768
    v_max3_f32 v2, v2, v122, v123
    v_max3_f32 v3, v3, v124, v125
    v_max3_f32 v2, v2, v126, v127
    v_max3_f32 v3, v3, v128, v129
    v_max3_f32 v2, v2, v130, v131
    s_waitcnt lgkmcnt(3)
    v_mfma_f32_32x32x16_bf16 v[140:155], v[88:91], v[40:43], v[140:155]
    ds_read_b128 v[104:107], v15 offset:32768
    v_max3_f32 v3, v3, v132, v133
    v_max3_f32 v2, v2, v134, v135
    v_max3_f32 v3, v3, v136, v137
    v_max3_f32 v2, v2, v138, v139
    v_max_f32 v2, v2, v3
    s_waitcnt lgkmcnt(3)
    v_mfma_f32_32x32x16_bf16 v[140:155], v[92:95], v[44:47], v[140:155]
    ds_read_b128 v[84:87], v16 offset:32768
    v_mov_b32 v3, v2
    s_nop 1
    v_permlane32_swap_b32 v2, v3
    v_max_f32 v2, v2, v3
    v_sub_f32 v3, v2, v25
    v_cmp_lt_f32 vcc, s35, v3
    s_waitcnt lgkmcnt(3)
    v_mfma_f32_32x32x16_bf16 v[140:155], v[96:99], v[48:51], v[140:155]
    ds_read_b128 v[88:91], v17 offset:32768
    s_cbranch_vccz attn_kernel_nors5
    v_max_f32 v2, v2, v25
    v_sub_f32 v3, v25, v2
    v_mul_f32 v3, s34, v3
    v_exp_f32 v3, v3
    v_mov_b32 v25, v2
    v_mul_f32 v27, s34, v2
    v_mul_f32 v26, v26, v3
    v_mul_f32 v172, v172, v3
    v_mul_f32 v173, v173, v3
    v_mul_f32 v174, v174, v3
    v_mul_f32 v175, v175, v3
    v_mul_f32 v176, v176, v3
    v_mul_f32 v177, v177, v3
    v_mul_f32 v178, v178, v3
    v_mul_f32 v179, v179, v3
    v_mul_f32 v180, v180, v3
    v_mul_f32 v181, v181, v3
    v_mul_f32 v182, v182, v3
    v_mul_f32 v183, v183, v3
    v_mul_f32 v184, v184, v3
    v_mul_f32 v185, v185, v3
    v_mul_f32 v186, v186, v3
    v_mul_f32 v187, v187, v3
    v_mul_f32 v188, v188, v3
    v_mul_f32 v189, v189, v3
    v_mul_f32 v190, v190, v3
    v_mul_f32 v191, v191, v3
    v_mul_f32 v192, v192, v3
    v_mul_f32 v193, v193, v3
    v_mul_f32 v194, v194, v3
    v_mul_f32 v195, v195, v3
    v_mul_f32 v196, v196, v3
    v_mul_f32 v197, v197, v3
    v_mul_f32 v198, v198, v3
    v_mul_f32 v199, v199, v3
    v_mul_f32 v200, v200, v3
    v_mul_f32 v201, v201, v3
    v_mul_f32 v202, v202, v3
    v_mul_f32 v203, v203, v3
    v_mul_f32 v204, v204, v3
    v_mul_f32 v205, v205, v3
    v_mul_f32 v206, v206, v3
    v_mul_f32 v207, v207, v3
    v_mul_f32 v208, v208, v3
    v_mul_f32 v209, v209, v3
    v_mul_f32 v210, v210, v3
    v_mul_f32 v211, v211, v3
    v_mul_f32 v212, v212, v3
    v_mul_f32 v213, v213, v3
    v_mul_f32 v214, v214, v3
    v_mul_f32 v215, v215, v3
    v_mul_f32 v216, v216, v3
    v_mul_f32 v217, v217, v3
    v_mul_f32 v218, v218, v3
    v_mul_f32 v219, v219, v3
    v_mul_f32 v220, v220, v3
    v_mul_f32 v221, v221, v3
    v_mul_f32 v222, v222, v3
    v_mul_f32 v223, v223, v3
    v_mul_f32 v224, v224, v3
    v_mul_f32 v225, v225, v3
    v_mul_f32 v226, v226, v3
    v_mul_f32 v227, v227, v3
    v_mul_f32 v228, v228, v3
    v_mul_f32 v229, v229, v3
    v_mul_f32 v230, v230, v3
    v_mul_f32 v231, v231, v3
    v_mul_f32 v232, v232, v3
    v_mul_f32 v233, v233, v3
    v_mul_f32 v234, v234, v3
    v_mul_f32 v235, v235, v3
attn_kernel_nors5:
    v_fma_f32 v108, v108, s34, -v27
    v_exp_f32 v108, v108
    v_fma_f32 v109, v109, s34, -v27
    v_exp_f32 v109, v109
    s_waitcnt lgkmcnt(3)
    v_mfma_f32_32x32x16_bf16 v[140:155], v[100:103], v[52:55], v[140:155]
    ds_read_b128 v[92:95], v10 offset:40960
    v_fma_f32 v110, v110, s34, -v27
    v_exp_f32 v110, v110
    v_fma_f32 v111, v111, s34, -v27
    v_exp_f32 v111, v111
    v_fma_f32 v112, v112, s34, -v27
    s_waitcnt lgkmcnt(3)
    v_mfma_f32_32x32x16_bf16 v[140:155], v[104:107], v[56:59], v[140:155]
    ds_read_b128 v[96:99], v11 offset:40960
    v_exp_f32 v112, v112
    v_fma_f32 v113, v113, s34, -v27
    v_exp_f32 v113, v113
    v_fma_f32 v114, v114, s34, -v27
    v_exp_f32 v114, v114
    s_waitcnt lgkmcnt(3)
    v_mfma_f32_32x32x16_bf16 v[140:155], v[84:87], v[60:63], v[140:155]
    ds_read_b128 v[100:103], v12 offset:40960
    v_fma_f32 v115, v115, s34, -v27
    v_exp_f32 v115, v115
    v_add_f32 v4, v108, v109
    v_cvt_pk_bf16_f32 v68, v108, v109
    v_add_f32 v5, v110, v111
    s_waitcnt lgkmcnt(3)
    v_mfma_f32_32x32x16_bf16 v[140:155], v[88:91], v[64:67], v[140:155]
    ds_read_b128 v[104:107], v13 offset:40960
    v_cvt_pk_bf16_f32 v69, v110, v111
    v_add_f32 v6, v112, v113
    v_cvt_pk_bf16_f32 v70, v112, v113
    v_add_f32 v7, v114, v115
    v_cvt_pk_bf16_f32 v71, v114, v115
    s_waitcnt lgkmcnt(3)
    v_mfma_f32_32x32x16_bf16 v[156:171], v[92:95], v[36:39], 0
    ds_read_b128 v[84:87], v14 offset:40960
    v_add_f32 v4, v4, v5
    v_add_f32 v6, v6, v7
    v_add_f32 v26, v26, v4
    v_add_f32 v26, v26, v6
    v_fma_f32 v116, v116, s34, -v27
    s_waitcnt lgkmcnt(3)
    v_mfma_f32_32x32x16_bf16 v[156:171], v[96:99], v[40:43], v[156:171]
    ds_read_b128 v[88:91], v15 offset:40960
    v_exp_f32 v116, v116
    v_fma_f32 v117, v117, s34, -v27
    v_exp_f32 v117, v117
    v_fma_f32 v118, v118, s34, -v27
    v_exp_f32 v118, v118
    s_waitcnt lgkmcnt(3)
    v_mfma_f32_32x32x16_bf16 v[156:171], v[100:103], v[44:47], v[156:171]
    ds_read_b128 v[92:95], v16 offset:40960
    v_fma_f32 v119, v119, s34, -v27
    v_exp_f32 v119, v119
    v_fma_f32 v120, v120, s34, -v27
    v_exp_f32 v120, v120
    v_fma_f32 v121, v121, s34, -v27
    s_waitcnt lgkmcnt(3)
    v_mfma_f32_32x32x16_bf16 v[156:171], v[104:107], v[48:51], v[156:171]
    ds_read_b128 v[96:99], v17 offset:40960
    v_exp_f32 v121, v121
    v_fma_f32 v122, v122, s34, -v27
    v_exp_f32 v122, v122
    v_fma_f32 v123, v123, s34, -v27
    v_exp_f32 v123, v123
    s_waitcnt lgkmcnt(3)
    v_mfma_f32_32x32x16_bf16 v[156:171], v[84:87], v[52:55], v[156:171]
    ds_read_b64_tr_b16 v[100:101], v18 offset:0
    ds_read_b64_tr_b16 v[102:103], v18 offset:2048
    v_add_f32 v4, v116, v117
    v_cvt_pk_bf16_f32 v72, v116, v117
    v_add_f32 v5, v118, v119
    v_cvt_pk_bf16_f32 v73, v118, v119
    v_add_f32 v6, v120, v121
    s_waitcnt lgkmcnt(4)
    v_mfma_f32_32x32x16_bf16 v[156:171], v[88:91], v[56:59], v[156:171]
    ds_read_b64_tr_b16 v[104:105], v19 offset:0
    ds_read_b64_tr_b16 v[106:107], v19 offset:2048
    v_cvt_pk_bf16_f32 v74, v120, v121
    v_add_f32 v7, v122, v123
    v_cvt_pk_bf16_f32 v75, v122, v123
    v_add_f32 v4, v4, v5
    v_add_f32 v6, v6, v7
    s_waitcnt lgkmcnt(5)
    v_mfma_f32_32x32x16_bf16 v[156:171], v[92:95], v[60:63], v[156:171]
    ds_read_b64_tr_b16 v[84:85], v20 offset:0
    ds_read_b64_tr_b16 v[86:87], v20 offset:2048
    v_add_f32 v26, v26, v4
    v_add_f32 v26, v26, v6
    v_fma_f32 v124, v124, s34, -v27
    v_exp_f32 v124, v124
    v_fma_f32 v125, v125, s34, -v27
    s_waitcnt lgkmcnt(6)
    v_mfma_f32_32x32x16_bf16 v[156:171], v[96:99], v[64:67], v[156:171]
    ds_read_b64_tr_b16 v[88:89], v21 offset:0
    ds_read_b64_tr_b16 v[90:91], v21 offset:2048
    v_exp_f32 v125, v125
    v_fma_f32 v126, v126, s34, -v27
    v_exp_f32 v126, v126
    v_fma_f32 v127, v127, s34, -v27
    v_exp_f32 v127, v127
    s_waitcnt lgkmcnt(6)
    v_mfma_f32_32x32x16_bf16 v[172:187], v[100:103], v[68:71], v[172:187]
    ds_read_b64_tr_b16 v[92:93], v18 offset:4096
    ds_read_b64_tr_b16 v[94:95], v18 offset:6144
    v_fma_f32 v128, v128, s34, -v27
    v_exp_f32 v128, v128
    v_fma_f32 v129, v129, s34, -v27
    v_exp_f32 v129, v129
    v_fma_f32 v130, v130, s34, -v27
    s_waitcnt lgkmcnt(6)
    v_mfma_f32_32x32x16_bf16 v[188:203], v[104:107], v[68:71], v[188:203]
    ds_read_b64_tr_b16 v[96:97], v19 offset:4096
    ds_read_b64_tr_b16 v[98:99], v19 offset:6144
    v_exp_f32 v130, v130
    v_fma_f32 v131, v131, s34, -v27
    v_exp_f32 v131, v131
    v_add_f32 v4, v124, v125
    v_cvt_pk_bf16_f32 v76, v124, v125
    s_waitcnt lgkmcnt(6)
    v_mfma_f32_32x32x16_bf16 v[204:219], v[84:87], v[68:71], v[204:219]
    ds_read_b64_tr_b16 v[100:101], v20 offset:4096
    ds_read_b64_tr_b16 v[102:103], v20 offset:6144
    v_add_f32 v5, v126, v127
    v_cvt_pk_bf16_f32 v77, v126, v127
    v_add_f32 v6, v128, v129
    v_cvt_pk_bf16_f32 v78, v128, v129
    v_add_f32 v7, v130, v131
    s_waitcnt lgkmcnt(6)
    v_mfma_f32_32x32x16_bf16 v[220:235], v[88:91], v[68:71], v[220:235]
    ds_read_b64_tr_b16 v[104:105], v21 offset:4096
    ds_read_b64_tr_b16 v[106:107], v21 offset:6144
    v_cvt_pk_bf16_f32 v79, v130, v131
    v_add_f32 v4, v4, v5
    v_add_f32 v6, v6, v7
    v_add_f32 v26, v26, v4
    v_add_f32 v26, v26, v6
    s_waitcnt lgkmcnt(6)
    v_mfma_f32_32x32x16_bf16 v[172:187], v[92:95], v[72:75], v[172:187]
    ds_read_b64_tr_b16 v[84:85], v18 offset:8192
    ds_read_b64_tr_b16 v[86:87], v18 offset:10240
    v_fma_f32 v132, v132, s34, -v27
    v_exp_f32 v132, v132
    v_fma_f32 v133, v133, s34, -v27
    v_exp_f32 v133, v133
    v_fma_f32 v134, v134, s34, -v27
    s_waitcnt lgkmcnt(6)
    v_mfma_f32_32x32x16_bf16 v[188:203], v[96:99], v[72:75], v[188:203]
    ds_read_b64_tr_b16 v[88:89], v19 offset:8192
    ds_read_b64_tr_b16 v[90:91], v19 offset:10240
    v_exp_f32 v134, v134
    v_fma_f32 v135, v135, s34, -v27
    v_exp_f32 v135, v135
    v_fma_f32 v136, v136, s34, -v27
    v_exp_f32 v136, v136
    s_waitcnt lgkmcnt(6)
    v_mfma_f32_32x32x16_bf16 v[204:219], v[100:103], v[72:75], v[204:219]
    ds_read_b64_tr_b16 v[92:93], v20 offset:8192
    ds_read_b64_tr_b16 v[94:95], v20 offset:10240
    v_fma_f32 v137, v137, s34, -v27
    v_exp_f32 v137, v137
    v_fma_f32 v138, v138, s34, -v27
    v_exp_f32 v138, v138
    v_fma_f32 v139, v139, s34, -v27
    s_waitcnt lgkmcnt(6)
    v_mfma_f32_32x32x16_bf16 v[220:235], v[104:107], v[72:75], v[220:235]
    ds_read_b64_tr_b16 v[96:97], v21 offset:8192
    ds_read_b64_tr_b16 v[98:99], v21 offset:10240
    v_exp_f32 v139, v139
    v_add_f32 v4, v132, v133
    v_cvt_pk_bf16_f32 v80, v132, v133
    v_add_f32 v5, v134, v135
    v_cvt_pk_bf16_f32 v81, v134, v135
    s_waitcnt lgkmcnt(6)
    v_mfma_f32_32x32x16_bf16 v[172:187], v[84:87], v[76:79], v[172:187]
    ds_read_b64_tr_b16 v[100:101], v18 offset:12288
    ds_read_b64_tr_b16 v[102:103], v18 offset:14336
    v_add_f32 v6, v136, v137
    v_cvt_pk_bf16_f32 v82, v136, v137
    v_add_f32 v7, v138, v139
    v_cvt_pk_bf16_f32 v83, v138, v139
    v_add_f32 v4, v4, v5
    s_waitcnt lgkmcnt(6)
    v_mfma_f32_32x32x16_bf16 v[188:203], v[88:91], v[76:79], v[188:203]
    ds_read_b64_tr_b16 v[104:105], v19 offset:12288
    ds_read_b64_tr_b16 v[106:107], v19 offset:14336
    v_add_f32 v6, v6, v7
    v_add_f32 v26, v26, v4
    v_add_f32 v26, v26, v6
    s_waitcnt lgkmcnt(6)
    v_mfma_f32_32x32x16_bf16 v[204:219], v[92:95], v[76:79], v[204:219]
    ds_read_b64_tr_b16 v[84:85], v20 offset:12288
    ds_read_b64_tr_b16 v[86:87], v20 offset:14336
    s_waitcnt lgkmcnt(6)
    v_mfma_f32_32x32x16_bf16 v[220:235], v[96:99], v[76:79], v[220:235]
    ds_read_b64_tr_b16 v[88:89], v21 offset:12288
    ds_read_b64_tr_b16 v[90:91], v21 offset:14336
    s_waitcnt lgkmcnt(6)
    v_mfma_f32_32x32x16_bf16 v[172:187], v[100:103], v[80:83], v[172:187]
    ds_read_b128 v[92:95], v10 offset:49152
    s_waitcnt lgkmcnt(5)
    v_mfma_f32_32x32x16_bf16 v[188:203], v[104:107], v[80:83], v[188:203]
    ds_read_b128 v[96:99], v11 offset:49152
    s_waitcnt lgkmcnt(4)
    v_mfma_f32_32x32x16_bf16 v[204:219], v[84:87], v[80:83], v[204:219]
    ds_read_b128 v[100:103], v12 offset:49152
    s_waitcnt lgkmcnt(3)
    v_mfma_f32_32x32x16_bf16 v[220:235], v[88:91], v[80:83], v[220:235]
    ds_read_b128 v[104:107], v13 offset:49152
    v_max3_f32 v2, v140, v141, v142
    v_max3_f32 v3, v143, v144, v145
    v_max3_f32 v2, v2, v146, v147
    v_max3_f32 v3, v3, v148, v149
    v_max3_f32 v2, v2, v150, v151
    v_max3_f32 v3, v3, v152, v153
    s_waitcnt lgkmcnt(3)
    v_mfma_f32_32x32x16_bf16 v[108:123], v[92:95], v[36:39], 0
    ds_read_b128 v[84:87], v14 offset:49152
    v_max3_f32 v2, v2, v154, v155
    v_max3_f32 v3, v3, v156, v157
    v_max3_f32 v2, v2, v158, v159
    v_max3_f32 v3, v3, v160, v161
    v_max3_f32 v2, v2, v162, v163
    s_waitcnt lgkmcnt(3)
    v_mfma_f32_32x32x16_bf16 v[108:123], v[96:99], v[40:43], v[108:123]
    ds_read_b128 v[88:91], v15 offset:49152
    v_max3_f32 v3, v3, v164, v165
    v_max3_f32 v2, v2, v166, v167
    v_max3_f32 v3, v3, v168, v169
    v_max3_f32 v2, v2, v170, v171
    v_max_f32 v2, v2, v3
    s_waitcnt lgkmcnt(3)
    v_mfma_f32_32x32x16_bf16 v[108:123], v[100:103], v[44:47], v[108:123]
    ds_read_b128 v[92:95], v16 offset:49152
    v_mov_b32 v3, v2
    s_nop 1
    v_permlane32_swap_b32 v2, v3
    v_max_f32 v2, v2, v3
    v_sub_f32 v3, v2, v25
    v_cmp_lt_f32 vcc, s35, v3
    s_waitcnt lgkmcnt(3)
    v_mfma_f32_32x32x16_bf16 v[108:123], v[104:107], v[48:51], v[108:123]
    ds_read_b128 v[96:99], v17 offset:49152
    s_cbranch_vccz attn_kernel_nors6
    v_max_f32 v2, v2, v25
    v_sub_f32 v3, v25, v2
    v_mul_f32 v3, s34, v3
    v_exp_f32 v3, v3
    v_mov_b32 v25, v2
    v_mul_f32 v27, s34, v2
    v_mul_f32 v26, v26, v3
    v_mul_f32 v172, v172, v3
    v_mul_f32 v173, v173, v3
    v_mul_f32 v174, v174, v3
    v_mul_f32 v175, v175, v3
    v_mul_f32 v176, v176, v3
    v_mul_f32 v177, v177, v3
    v_mul_f32 v178, v178, v3
    v_mul_f32 v179, v179, v3
    v_mul_f32 v180, v180, v3
    v_mul_f32 v181, v181, v3
    v_mul_f32 v182, v182, v3
    v_mul_f32 v183, v183, v3
    v_mul_f32 v184, v184, v3
    v_mul_f32 v185, v185, v3
    v_mul_f32 v186, v186, v3
    v_mul_f32 v187, v187, v3
    v_mul_f32 v188, v188, v3
    v_mul_f32 v189, v189, v3
    v_mul_f32 v190, v190, v3
    v_mul_f32 v191, v191, v3
    v_mul_f32 v192, v192, v3
    v_mul_f32 v193, v193, v3
    v_mul_f32 v194, v194, v3
    v_mul_f32 v195, v195, v3
    v_mul_f32 v196, v196, v3
    v_mul_f32 v197, v197, v3
    v_mul_f32 v198, v198, v3
    v_mul_f32 v199, v199, v3
    v_mul_f32 v200, v200, v3
    v_mul_f32 v201, v201, v3
    v_mul_f32 v202, v202, v3
    v_mul_f32 v203, v203, v3
    v_mul_f32 v204, v204, v3
    v_mul_f32 v205, v205, v3
    v_mul_f32 v206, v206, v3
    v_mul_f32 v207, v207, v3
    v_mul_f32 v208, v208, v3
    v_mul_f32 v209, v209, v3
    v_mul_f32 v210, v210, v3
    v_mul_f32 v211, v211, v3
    v_mul_f32 v212, v212, v3
    v_mul_f32 v213, v213, v3
    v_mul_f32 v214, v214, v3
    v_mul_f32 v215, v215, v3
    v_mul_f32 v216, v216, v3
    v_mul_f32 v217, v217, v3
    v_mul_f32 v218, v218, v3
    v_mul_f32 v219, v219, v3
    v_mul_f32 v220, v220, v3
    v_mul_f32 v221, v221, v3
    v_mul_f32 v222, v222, v3
    v_mul_f32 v223, v223, v3
    v_mul_f32 v224, v224, v3
    v_mul_f32 v225, v225, v3
    v_mul_f32 v226, v226, v3
    v_mul_f32 v227, v227, v3
    v_mul_f32 v228, v228, v3
    v_mul_f32 v229, v229, v3
    v_mul_f32 v230, v230, v3
    v_mul_f32 v231, v231, v3
    v_mul_f32 v232, v232, v3
    v_mul_f32 v233, v233, v3
    v_mul_f32 v234, v234, v3
    v_mul_f32 v235, v235, v3
attn_kernel_nors6:
    v_fma_f32 v140, v140, s34, -v27
    v_exp_f32 v140, v140
    v_fma_f32 v141, v141, s34, -v27
    v_exp_f32 v141, v141
    s_waitcnt lgkmcnt(3)
    v_mfma_f32_32x32x16_bf16 v[108:123], v[84:87], v[52:55], v[108:123]
    ds_read_b128 v[100:103], v10 offset:57344
    v_fma_f32 v142, v142, s34, -v27
    v_exp_f32 v142, v142
    v_fma_f32 v143, v143, s34, -v27
    v_exp_f32 v143, v143
    v_fma_f32 v144, v144, s34, -v27
    s_waitcnt lgkmcnt(3)
    v_mfma_f32_32x32x16_bf16 v[108:123], v[88:91], v[56:59], v[108:123]
    ds_read_b128 v[104:107], v11 offset:57344
    v_exp_f32 v144, v144
    v_fma_f32 v145, v145, s34, -v27
    v_exp_f32 v145, v145
    v_fma_f32 v146, v146, s34, -v27
    v_exp_f32 v146, v146
    s_waitcnt lgkmcnt(3)
    v_mfma_f32_32x32x16_bf16 v[108:123], v[92:95], v[60:63], v[108:123]
    ds_read_b128 v[84:87], v12 offset:57344
    v_fma_f32 v147, v147, s34, -v27
    v_exp_f32 v147, v147
    v_add_f32 v4, v140, v141
    v_cvt_pk_bf16_f32 v68, v140, v141
    v_add_f32 v5, v142, v143
    s_waitcnt lgkmcnt(3)
    v_mfma_f32_32x32x16_bf16 v[108:123], v[96:99], v[64:67], v[108:123]
    ds_read_b128 v[88:91], v13 offset:57344
    v_cvt_pk_bf16_f32 v69, v142, v143
    v_add_f32 v6, v144, v145
    v_cvt_pk_bf16_f32 v70, v144, v145
    v_add_f32 v7, v146, v147
    v_cvt_pk_bf16_f32 v71, v146, v147
    s_waitcnt lgkmcnt(3)
    v_mfma_f32_32x32x16_bf16 v[124:139], v[100:103], v[36:39], 0
    ds_read_b128 v[92:95], v14 offset:57344
    v_add_f32 v4, v4, v5
    v_add_f32 v6, v6, v7
    v_add_f32 v26, v26, v4
    v_add_f32 v26, v26, v6
    v_fma_f32 v148, v148, s34, -v27
    s_waitcnt lgkmcnt(3)
    v_mfma_f32_32x32x16_bf16 v[124:139], v[104:107], v[40:43], v[124:139]
    ds_read_b128 v[96:99], v15 offset:57344
    v_exp_f32 v148, v148
    v_fma_f32 v149, v149, s34, -v27
    v_exp_f32 v149, v149
    v_fma_f32 v150, v150, s34, -v27
    v_exp_f32 v150, v150
    s_waitcnt lgkmcnt(3)
    v_mfma_f32_32x32x16_bf16 v[124:139], v[84:87], v[44:47], v[124:139]
    ds_read_b128 v[100:103], v16 offset:57344
    v_fma_f32 v151, v151, s34, -v27
    v_exp_f32 v151, v151
    v_fma_f32 v152, v152, s34, -v27
    v_exp_f32 v152, v152
    v_fma_f32 v153, v153, s34, -v27
    s_waitcnt lgkmcnt(3)
    v_mfma_f32_32x32x16_bf16 v[124:139], v[88:91], v[48:51], v[124:139]
    ds_read_b128 v[104:107], v17 offset:57344
    v_exp_f32 v153, v153
    v_fma_f32 v154, v154, s34, -v27
    v_exp_f32 v154, v154
    v_fma_f32 v155, v155, s34, -v27
    v_exp_f32 v155, v155
    s_waitcnt lgkmcnt(3)
    v_mfma_f32_32x32x16_bf16 v[124:139], v[92:95], v[52:55], v[124:139]
    ds_read_b64_tr_b16 v[84:85], v18 offset:16384
    ds_read_b64_tr_b16 v[86:87], v18 offset:18432
    v_add_f32 v4, v148, v149
    v_cvt_pk_bf16_f32 v72, v148, v149
    v_add_f32 v5, v150, v151
    v_cvt_pk_bf16_f32 v73, v150, v151
    v_add_f32 v6, v152, v153
    s_waitcnt lgkmcnt(4)
    v_mfma_f32_32x32x16_bf16 v[124:139], v[96:99], v[56:59], v[124:139]
    ds_read_b64_tr_b16 v[88:89], v19 offset:16384
    ds_read_b64_tr_b16 v[90:91], v19 offset:18432
    v_cvt_pk_bf16_f32 v74, v152, v153
    v_add_f32 v7, v154, v155
    v_cvt_pk_bf16_f32 v75, v154, v155
    v_add_f32 v4, v4, v5
    v_add_f32 v6, v6, v7
    s_waitcnt lgkmcnt(5)
    v_mfma_f32_32x32x16_bf16 v[124:139], v[100:103], v[60:63], v[124:139]
    ds_read_b64_tr_b16 v[92:93], v20 offset:16384
    ds_read_b64_tr_b16 v[94:95], v20 offset:18432
    v_add_f32 v26, v26, v4
    v_add_f32 v26, v26, v6
    v_fma_f32 v156, v156, s34, -v27
    v_exp_f32 v156, v156
    v_fma_f32 v157, v157, s34, -v27
    s_waitcnt lgkmcnt(6)
    v_mfma_f32_32x32x16_bf16 v[124:139], v[104:107], v[64:67], v[124:139]
    ds_read_b64_tr_b16 v[96:97], v21 offset:16384
    ds_read_b64_tr_b16 v[98:99], v21 offset:18432
    v_exp_f32 v157, v157
    v_fma_f32 v158, v158, s34, -v27
    v_exp_f32 v158, v158
    v_fma_f32 v159, v159, s34, -v27
    v_exp_f32 v159, v159
    s_waitcnt lgkmcnt(6)
    v_mfma_f32_32x32x16_bf16 v[172:187], v[84:87], v[68:71], v[172:187]
    ds_read_b64_tr_b16 v[100:101], v18 offset:20480
    ds_read_b64_tr_b16 v[102:103], v18 offset:22528
    v_fma_f32 v160, v160, s34, -v27
    v_exp_f32 v160, v160
    v_fma_f32 v161, v161, s34, -v27
    v_exp_f32 v161, v161
    v_fma_f32 v162, v162, s34, -v27
    s_waitcnt lgkmcnt(6)
    v_mfma_f32_32x32x16_bf16 v[188:203], v[88:91], v[68:71], v[188:203]
    ds_read_b64_tr_b16 v[104:105], v19 offset:20480
    ds_read_b64_tr_b16 v[106:107], v19 offset:22528
    v_exp_f32 v162, v162
    v_fma_f32 v163, v163, s34, -v27
    v_exp_f32 v163, v163
    v_add_f32 v4, v156, v157
    v_cvt_pk_bf16_f32 v76, v156, v157
    s_waitcnt lgkmcnt(6)
    v_mfma_f32_32x32x16_bf16 v[204:219], v[92:95], v[68:71], v[204:219]
    ds_read_b64_tr_b16 v[84:85], v20 offset:20480
    ds_read_b64_tr_b16 v[86:87], v20 offset:22528
    v_add_f32 v5, v158, v159
    v_cvt_pk_bf16_f32 v77, v158, v159
    v_add_f32 v6, v160, v161
    v_cvt_pk_bf16_f32 v78, v160, v161
    v_add_f32 v7, v162, v163
    s_waitcnt lgkmcnt(6)
    v_mfma_f32_32x32x16_bf16 v[220:235], v[96:99], v[68:71], v[220:235]
    ds_read_b64_tr_b16 v[88:89], v21 offset:20480
    ds_read_b64_tr_b16 v[90:91], v21 offset:22528
    v_cvt_pk_bf16_f32 v79, v162, v163
    v_add_f32 v4, v4, v5
    v_add_f32 v6, v6, v7
    v_add_f32 v26, v26, v4
    v_add_f32 v26, v26, v6
    s_waitcnt lgkmcnt(6)
    v_mfma_f32_32x32x16_bf16 v[172:187], v[100:103], v[72:75], v[172:187]
    ds_read_b64_tr_b16 v[92:93], v18 offset:24576
    ds_read_b64_tr_b16 v[94:95], v18 offset:26624
    v_fma_f32 v164, v164, s34, -v27
    v_exp_f32 v164, v164
    v_fma_f32 v165, v165, s34, -v27
    v_exp_f32 v165, v165
    v_fma_f32 v166, v166, s34, -v27
    s_waitcnt lgkmcnt(6)
    v_mfma_f32_32x32x16_bf16 v[188:203], v[104:107], v[72:75], v[188:203]
    ds_read_b64_tr_b16 v[96:97], v19 offset:24576
    ds_read_b64_tr_b16 v[98:99], v19 offset:26624
    v_exp_f32 v166, v166
    v_fma_f32 v167, v167, s34, -v27
    v_exp_f32 v167, v167
    v_fma_f32 v168, v168, s34, -v27
    v_exp_f32 v168, v168
    s_waitcnt lgkmcnt(6)
    v_mfma_f32_32x32x16_bf16 v[204:219], v[84:87], v[72:75], v[204:219]
    ds_read_b64_tr_b16 v[100:101], v20 offset:24576
    ds_read_b64_tr_b16 v[102:103], v20 offset:26624
    v_fma_f32 v169, v169, s34, -v27
    v_exp_f32 v169, v169
    v_fma_f32 v170, v170, s34, -v27
    v_exp_f32 v170, v170
    v_fma_f32 v171, v171, s34, -v27
    s_waitcnt lgkmcnt(6)
    v_mfma_f32_32x32x16_bf16 v[220:235], v[88:91], v[72:75], v[220:235]
    ds_read_b64_tr_b16 v[104:105], v21 offset:24576
    ds_read_b64_tr_b16 v[106:107], v21 offset:26624
    v_exp_f32 v171, v171
    v_add_f32 v4, v164, v165
    v_cvt_pk_bf16_f32 v80, v164, v165
    v_add_f32 v5, v166, v167
    v_cvt_pk_bf16_f32 v81, v166, v167
    s_waitcnt lgkmcnt(6)
    v_mfma_f32_32x32x16_bf16 v[172:187], v[92:95], v[76:79], v[172:187]
    ds_read_b64_tr_b16 v[84:85], v18 offset:28672
    ds_read_b64_tr_b16 v[86:87], v18 offset:30720
    v_add_f32 v6, v168, v169
    v_cvt_pk_bf16_f32 v82, v168, v169
    v_add_f32 v7, v170, v171
    v_cvt_pk_bf16_f32 v83, v170, v171
    v_add_f32 v4, v4, v5
    s_waitcnt lgkmcnt(6)
    v_mfma_f32_32x32x16_bf16 v[188:203], v[96:99], v[76:79], v[188:203]
    ds_read_b64_tr_b16 v[88:89], v19 offset:28672
    ds_read_b64_tr_b16 v[90:91], v19 offset:30720
    v_add_f32 v6, v6, v7
    v_add_f32 v26, v26, v4
    v_add_f32 v26, v26, v6
    s_waitcnt lgkmcnt(6)
    v_mfma_f32_32x32x16_bf16 v[204:219], v[100:103], v[76:79], v[204:219]
    ds_read_b64_tr_b16 v[92:93], v20 offset:28672
    ds_read_b64_tr_b16 v[94:95], v20 offset:30720
    s_waitcnt lgkmcnt(6)
    v_mfma_f32_32x32x16_bf16 v[220:235], v[104:107], v[76:79], v[220:235]
    ds_read_b64_tr_b16 v[96:97], v21 offset:28672
    ds_read_b64_tr_b16 v[98:99], v21 offset:30720
    s_waitcnt lgkmcnt(6)
    v_mfma_f32_32x32x16_bf16 v[172:187], v[84:87], v[80:83], v[172:187]
    s_waitcnt lgkmcnt(4)
    v_mfma_f32_32x32x16_bf16 v[188:203], v[88:91], v[80:83], v[188:203]
    s_waitcnt lgkmcnt(2)
    v_mfma_f32_32x32x16_bf16 v[204:219], v[92:95], v[80:83], v[204:219]
    s_waitcnt lgkmcnt(0)
    v_mfma_f32_32x32x16_bf16 v[220:235], v[96:99], v[80:83], v[220:235]
    s_waitcnt vmcnt(0)
    s_barrier
    ds_read_b128 v[84:87], v10 offset:0
    ds_read_b128 v[88:91], v11 offset:0
    ds_read_b128 v[92:95], v12 offset:0
    ds_read_b128 v[96:99], v13 offset:0
    v_max3_f32 v2, v108, v109, v110
    v_max3_f32 v3, v111, v112, v113
    v_max3_f32 v2, v2, v114, v115
    v_max3_f32 v3, v3, v116, v117
    v_max3_f32 v2, v2, v118, v119
    v_max3_f32 v3, v3, v120, v121
    s_waitcnt lgkmcnt(3)
    v_mfma_f32_32x32x16_bf16 v[140:155], v[84:87], v[36:39], 0
    ds_read_b128 v[100:103], v14 offset:0
    v_max3_f32 v2, v2, v122, v123
    v_max3_f32 v3, v3, v124, v125
    v_max3_f32 v2, v2, v126, v127
    v_max3_f32 v3, v3, v128, v129
    v_max3_f32 v2, v2, v130, v131
    s_waitcnt lgkmcnt(3)
    v_mfma_f32_32x32x16_bf16 v[140:155], v[88:91], v[40:43], v[140:155]
    ds_read_b128 v[104:107], v15 offset:0
    v_max3_f32 v3, v3, v132, v133
    v_max3_f32 v2, v2, v134, v135
    v_max3_f32 v3, v3, v136, v137
    v_max3_f32 v2, v2, v138, v139
    v_max_f32 v2, v2, v3
    s_waitcnt lgkmcnt(3)
    v_mfma_f32_32x32x16_bf16 v[140:155], v[92:95], v[44:47], v[140:155]
    ds_read_b128 v[84:87], v16 offset:0
    v_mov_b32 v3, v2
    s_nop 1
    v_permlane32_swap_b32 v2, v3
    v_max_f32 v2, v2, v3
    v_sub_f32 v3, v2, v25
    v_cmp_lt_f32 vcc, s35, v3
    s_waitcnt lgkmcnt(3)
    v_mfma_f32_32x32x16_bf16 v[140:155], v[96:99], v[48:51], v[140:155]
    ds_read_b128 v[88:91], v17 offset:0
    s_cbranch_vccz attn_kernel_nors7
    v_max_f32 v2, v2, v25
    v_sub_f32 v3, v25, v2
    v_mul_f32 v3, s34, v3
    v_exp_f32 v3, v3
    v_mov_b32 v25, v2
    v_mul_f32 v27, s34, v2
    v_mul_f32 v26, v26, v3
    v_mul_f32 v172, v172, v3
    v_mul_f32 v173, v173, v3
    v_mul_f32 v174, v174, v3
    v_mul_f32 v175, v175, v3
    v_mul_f32 v176, v176, v3
    v_mul_f32 v177, v177, v3
    v_mul_f32 v178, v178, v3
    v_mul_f32 v179, v179, v3
    v_mul_f32 v180, v180, v3
    v_mul_f32 v181, v181, v3
    v_mul_f32 v182, v182, v3
    v_mul_f32 v183, v183, v3
    v_mul_f32 v184, v184, v3
    v_mul_f32 v185, v185, v3
    v_mul_f32 v186, v186, v3
    v_mul_f32 v187, v187, v3
    v_mul_f32 v188, v188, v3
    v_mul_f32 v189, v189, v3
    v_mul_f32 v190, v190, v3
    v_mul_f32 v191, v191, v3
    v_mul_f32 v192, v192, v3
    v_mul_f32 v193, v193, v3
    v_mul_f32 v194, v194, v3
    v_mul_f32 v195, v195, v3
    v_mul_f32 v196, v196, v3
    v_mul_f32 v197, v197, v3
    v_mul_f32 v198, v198, v3
    v_mul_f32 v199, v199, v3
    v_mul_f32 v200, v200, v3
    v_mul_f32 v201, v201, v3
    v_mul_f32 v202, v202, v3
    v_mul_f32 v203, v203, v3
    v_mul_f32 v204, v204, v3
    v_mul_f32 v205, v205, v3
    v_mul_f32 v206, v206, v3
    v_mul_f32 v207, v207, v3
    v_mul_f32 v208, v208, v3
    v_mul_f32 v209, v209, v3
    v_mul_f32 v210, v210, v3
    v_mul_f32 v211, v211, v3
    v_mul_f32 v212, v212, v3
    v_mul_f32 v213, v213, v3
    v_mul_f32 v214, v214, v3
    v_mul_f32 v215, v215, v3
    v_mul_f32 v216, v216, v3
    v_mul_f32 v217, v217, v3
    v_mul_f32 v218, v218, v3
    v_mul_f32 v219, v219, v3
    v_mul_f32 v220, v220, v3
    v_mul_f32 v221, v221, v3
    v_mul_f32 v222, v222, v3
    v_mul_f32 v223, v223, v3
    v_mul_f32 v224, v224, v3
    v_mul_f32 v225, v225, v3
    v_mul_f32 v226, v226, v3
    v_mul_f32 v227, v227, v3
    v_mul_f32 v228, v228, v3
    v_mul_f32 v229, v229, v3
    v_mul_f32 v230, v230, v3
    v_mul_f32 v231, v231, v3
    v_mul_f32 v232, v232, v3
    v_mul_f32 v233, v233, v3
    v_mul_f32 v234, v234, v3
    v_mul_f32 v235, v235, v3
attn_kernel_nors7:
    v_fma_f32 v108, v108, s34, -v27
    v_exp_f32 v108, v108
    v_fma_f32 v109, v109, s34, -v27
    v_exp_f32 v109, v109
    s_waitcnt lgkmcnt(3)
    v_mfma_f32_32x32x16_bf16 v[140:155], v[100:103], v[52:55], v[140:155]
    ds_read_b128 v[92:95], v10 offset:8192
    v_fma_f32 v110, v110, s34, -v27
    v_exp_f32 v110, v110
    v_fma_f32 v111, v111, s34, -v27
    v_exp_f32 v111, v111
    v_fma_f32 v112, v112, s34, -v27
    s_waitcnt lgkmcnt(3)
    v_mfma_f32_32x32x16_bf16 v[140:155], v[104:107], v[56:59], v[140:155]
    ds_read_b128 v[96:99], v11 offset:8192
    v_exp_f32 v112, v112
    v_fma_f32 v113, v113, s34, -v27
    v_exp_f32 v113, v113
    v_fma_f32 v114, v114, s34, -v27
    v_exp_f32 v114, v114
    s_waitcnt lgkmcnt(3)
    v_mfma_f32_32x32x16_bf16 v[140:155], v[84:87], v[60:63], v[140:155]
    ds_read_b128 v[100:103], v12 offset:8192
    v_fma_f32 v115, v115, s34, -v27
    v_exp_f32 v115, v115
    v_add_f32 v4, v108, v109
    v_cvt_pk_bf16_f32 v68, v108, v109
    v_add_f32 v5, v110, v111
    s_waitcnt lgkmcnt(3)
    v_mfma_f32_32x32x16_bf16 v[140:155], v[88:91], v[64:67], v[140:155]
    ds_read_b128 v[104:107], v13 offset:8192
    v_cvt_pk_bf16_f32 v69, v110, v111
    v_add_f32 v6, v112, v113
    v_cvt_pk_bf16_f32 v70, v112, v113
    v_add_f32 v7, v114, v115
    v_cvt_pk_bf16_f32 v71, v114, v115
    s_waitcnt lgkmcnt(3)
    v_mfma_f32_32x32x16_bf16 v[156:171], v[92:95], v[36:39], 0
    ds_read_b128 v[84:87], v14 offset:8192
    v_add_f32 v4, v4, v5
    v_add_f32 v6, v6, v7
    v_add_f32 v26, v26, v4
    v_add_f32 v26, v26, v6
    v_fma_f32 v116, v116, s34, -v27
    s_waitcnt lgkmcnt(3)
    v_mfma_f32_32x32x16_bf16 v[156:171], v[96:99], v[40:43], v[156:171]
    ds_read_b128 v[88:91], v15 offset:8192
    v_exp_f32 v116, v116
    v_fma_f32 v117, v117, s34, -v27
    v_exp_f32 v117, v117
    v_fma_f32 v118, v118, s34, -v27
    v_exp_f32 v118, v118
    s_waitcnt lgkmcnt(3)
    v_mfma_f32_32x32x16_bf16 v[156:171], v[100:103], v[44:47], v[156:171]
    ds_read_b128 v[92:95], v16 offset:8192
    v_fma_f32 v119, v119, s34, -v27
    v_exp_f32 v119, v119
    v_fma_f32 v120, v120, s34, -v27
    v_exp_f32 v120, v120
    v_fma_f32 v121, v121, s34, -v27
    s_waitcnt lgkmcnt(3)
    v_mfma_f32_32x32x16_bf16 v[156:171], v[104:107], v[48:51], v[156:171]
    ds_read_b128 v[96:99], v17 offset:8192
    v_exp_f32 v121, v121
    v_fma_f32 v122, v122, s34, -v27
    v_exp_f32 v122, v122
    v_fma_f32 v123, v123, s34, -v27
    v_exp_f32 v123, v123
    s_waitcnt lgkmcnt(3)
    v_mfma_f32_32x32x16_bf16 v[156:171], v[84:87], v[52:55], v[156:171]
    ds_read_b64_tr_b16 v[100:101], v18 offset:32768
    ds_read_b64_tr_b16 v[102:103], v18 offset:34816
    v_add_f32 v4, v116, v117
    v_cvt_pk_bf16_f32 v72, v116, v117
    v_add_f32 v5, v118, v119
    v_cvt_pk_bf16_f32 v73, v118, v119
    v_add_f32 v6, v120, v121
    s_waitcnt lgkmcnt(4)
    v_mfma_f32_32x32x16_bf16 v[156:171], v[88:91], v[56:59], v[156:171]
    ds_read_b64_tr_b16 v[104:105], v19 offset:32768
    ds_read_b64_tr_b16 v[106:107], v19 offset:34816
    v_cvt_pk_bf16_f32 v74, v120, v121
    v_add_f32 v7, v122, v123
    v_cvt_pk_bf16_f32 v75, v122, v123
    v_add_f32 v4, v4, v5
    v_add_f32 v6, v6, v7
    s_waitcnt lgkmcnt(5)
    v_mfma_f32_32x32x16_bf16 v[156:171], v[92:95], v[60:63], v[156:171]
    ds_read_b64_tr_b16 v[84:85], v20 offset:32768
    ds_read_b64_tr_b16 v[86:87], v20 offset:34816
    v_add_f32 v26, v26, v4
    v_add_f32 v26, v26, v6
    v_fma_f32 v124, v124, s34, -v27
    v_exp_f32 v124, v124
    v_fma_f32 v125, v125, s34, -v27
    s_waitcnt lgkmcnt(6)
    v_mfma_f32_32x32x16_bf16 v[156:171], v[96:99], v[64:67], v[156:171]
    ds_read_b64_tr_b16 v[88:89], v21 offset:32768
    ds_read_b64_tr_b16 v[90:91], v21 offset:34816
    v_exp_f32 v125, v125
    v_fma_f32 v126, v126, s34, -v27
    v_exp_f32 v126, v126
    v_fma_f32 v127, v127, s34, -v27
    v_exp_f32 v127, v127
    s_waitcnt lgkmcnt(6)
    v_mfma_f32_32x32x16_bf16 v[172:187], v[100:103], v[68:71], v[172:187]
    ds_read_b64_tr_b16 v[92:93], v18 offset:36864
    ds_read_b64_tr_b16 v[94:95], v18 offset:38912
    v_fma_f32 v128, v128, s34, -v27
    v_exp_f32 v128, v128
    v_fma_f32 v129, v129, s34, -v27
    v_exp_f32 v129, v129
    v_fma_f32 v130, v130, s34, -v27
    s_waitcnt lgkmcnt(6)
    v_mfma_f32_32x32x16_bf16 v[188:203], v[104:107], v[68:71], v[188:203]
    ds_read_b64_tr_b16 v[96:97], v19 offset:36864
    ds_read_b64_tr_b16 v[98:99], v19 offset:38912
    v_exp_f32 v130, v130
    v_fma_f32 v131, v131, s34, -v27
    v_exp_f32 v131, v131
    v_add_f32 v4, v124, v125
    v_cvt_pk_bf16_f32 v76, v124, v125
    s_waitcnt lgkmcnt(6)
    v_mfma_f32_32x32x16_bf16 v[204:219], v[84:87], v[68:71], v[204:219]
    ds_read_b64_tr_b16 v[100:101], v20 offset:36864
    ds_read_b64_tr_b16 v[102:103], v20 offset:38912
    v_add_f32 v5, v126, v127
    v_cvt_pk_bf16_f32 v77, v126, v127
    v_add_f32 v6, v128, v129
    v_cvt_pk_bf16_f32 v78, v128, v129
    v_add_f32 v7, v130, v131
    s_waitcnt lgkmcnt(6)
    v_mfma_f32_32x32x16_bf16 v[220:235], v[88:91], v[68:71], v[220:235]
    ds_read_b64_tr_b16 v[104:105], v21 offset:36864
    ds_read_b64_tr_b16 v[106:107], v21 offset:38912
    v_cvt_pk_bf16_f32 v79, v130, v131
    v_add_f32 v4, v4, v5
    v_add_f32 v6, v6, v7
    v_add_f32 v26, v26, v4
    v_add_f32 v26, v26, v6
    s_waitcnt lgkmcnt(6)
    v_mfma_f32_32x32x16_bf16 v[172:187], v[92:95], v[72:75], v[172:187]
    ds_read_b64_tr_b16 v[84:85], v18 offset:40960
    ds_read_b64_tr_b16 v[86:87], v18 offset:43008
    v_fma_f32 v132, v132, s34, -v27
    v_exp_f32 v132, v132
    v_fma_f32 v133, v133, s34, -v27
    v_exp_f32 v133, v133
    v_fma_f32 v134, v134, s34, -v27
    s_waitcnt lgkmcnt(6)
    v_mfma_f32_32x32x16_bf16 v[188:203], v[96:99], v[72:75], v[188:203]
    ds_read_b64_tr_b16 v[88:89], v19 offset:40960
    ds_read_b64_tr_b16 v[90:91], v19 offset:43008
    v_exp_f32 v134, v134
    v_fma_f32 v135, v135, s34, -v27
    v_exp_f32 v135, v135
    v_fma_f32 v136, v136, s34, -v27
    v_exp_f32 v136, v136
    s_waitcnt lgkmcnt(6)
    v_mfma_f32_32x32x16_bf16 v[204:219], v[100:103], v[72:75], v[204:219]
    ds_read_b64_tr_b16 v[92:93], v20 offset:40960
    ds_read_b64_tr_b16 v[94:95], v20 offset:43008
    v_fma_f32 v137, v137, s34, -v27
    v_exp_f32 v137, v137
    v_fma_f32 v138, v138, s34, -v27
    v_exp_f32 v138, v138
    v_fma_f32 v139, v139, s34, -v27
    s_waitcnt lgkmcnt(6)
    v_mfma_f32_32x32x16_bf16 v[220:235], v[104:107], v[72:75], v[220:235]
    ds_read_b64_tr_b16 v[96:97], v21 offset:40960
    ds_read_b64_tr_b16 v[98:99], v21 offset:43008
    v_exp_f32 v139, v139
    v_add_f32 v4, v132, v133
    v_cvt_pk_bf16_f32 v80, v132, v133
    v_add_f32 v5, v134, v135
    v_cvt_pk_bf16_f32 v81, v134, v135
    s_waitcnt lgkmcnt(6)
    v_mfma_f32_32x32x16_bf16 v[172:187], v[84:87], v[76:79], v[172:187]
    ds_read_b64_tr_b16 v[100:101], v18 offset:45056
    ds_read_b64_tr_b16 v[102:103], v18 offset:47104
    v_add_f32 v6, v136, v137
    v_cvt_pk_bf16_f32 v82, v136, v137
    v_add_f32 v7, v138, v139
    v_cvt_pk_bf16_f32 v83, v138, v139
    v_add_f32 v4, v4, v5
    s_waitcnt lgkmcnt(6)
    v_mfma_f32_32x32x16_bf16 v[188:203], v[88:91], v[76:79], v[188:203]
    ds_read_b64_tr_b16 v[104:105], v19 offset:45056
    ds_read_b64_tr_b16 v[106:107], v19 offset:47104
    v_add_f32 v6, v6, v7
    v_add_f32 v26, v26, v4
    v_add_f32 v26, v26, v6
    s_waitcnt lgkmcnt(6)
    v_mfma_f32_32x32x16_bf16 v[204:219], v[92:95], v[76:79], v[204:219]
    ds_read_b64_tr_b16 v[84:85], v20 offset:45056
    ds_read_b64_tr_b16 v[86:87], v20 offset:47104
    s_waitcnt lgkmcnt(6)
    v_mfma_f32_32x32x16_bf16 v[220:235], v[96:99], v[76:79], v[220:235]
    ds_read_b64_tr_b16 v[88:89], v21 offset:45056
    ds_read_b64_tr_b16 v[90:91], v21 offset:47104
    s_waitcnt lgkmcnt(6)
    v_mfma_f32_32x32x16_bf16 v[172:187], v[100:103], v[80:83], v[172:187]
    ds_read_b64_tr_b16 v[92:93], v18 offset:49152
    ds_read_b64_tr_b16 v[94:95], v18 offset:51200
    s_waitcnt lgkmcnt(6)
    v_mfma_f32_32x32x16_bf16 v[188:203], v[104:107], v[80:83], v[188:203]
    ds_read_b64_tr_b16 v[96:97], v19 offset:49152
    ds_read_b64_tr_b16 v[98:99], v19 offset:51200
    s_waitcnt lgkmcnt(6)
    v_mfma_f32_32x32x16_bf16 v[204:219], v[84:87], v[80:83], v[204:219]
    ds_read_b64_tr_b16 v[100:101], v20 offset:49152
    ds_read_b64_tr_b16 v[102:103], v20 offset:51200
    s_waitcnt lgkmcnt(6)
    v_mfma_f32_32x32x16_bf16 v[220:235], v[88:91], v[80:83], v[220:235]
    ds_read_b64_tr_b16 v[104:105], v21 offset:49152
    ds_read_b64_tr_b16 v[106:107], v21 offset:51200
    v_max3_f32 v2, v140, v141, v142
    v_max3_f32 v3, v143, v144, v145
    v_max3_f32 v2, v2, v146, v147
    v_max3_f32 v3, v3, v148, v149
    v_max3_f32 v2, v2, v150, v151
    v_max3_f32 v3, v3, v152, v153
    v_max3_f32 v2, v2, v154, v155
    v_max3_f32 v3, v3, v156, v157
    v_max3_f32 v2, v2, v158, v159
    v_max3_f32 v3, v3, v160, v161
    v_max3_f32 v2, v2, v162, v163
    v_max3_f32 v3, v3, v164, v165
    v_max3_f32 v2, v2, v166, v167
    v_max3_f32 v3, v3, v168, v169
    v_max3_f32 v2, v2, v170, v171
    v_max_f32 v2, v2, v3
    v_mov_b32 v3, v2
    s_nop 1
    v_permlane32_swap_b32 v2, v3
    v_max_f32 v2, v2, v3
    v_sub_f32 v3, v2, v25
    v_cmp_lt_f32 vcc, s35, v3
    s_cbranch_vccz attn_kernel_nors8
    v_max_f32 v2, v2, v25
    v_sub_f32 v3, v25, v2
    v_mul_f32 v3, s34, v3
    v_exp_f32 v3, v3
    v_mov_b32 v25, v2
    v_mul_f32 v27, s34, v2
    v_mul_f32 v26, v26, v3
    v_mul_f32 v172, v172, v3
    v_mul_f32 v173, v173, v3
    v_mul_f32 v174, v174, v3
    v_mul_f32 v175, v175, v3
    v_mul_f32 v176, v176, v3
    v_mul_f32 v177, v177, v3
    v_mul_f32 v178, v178, v3
    v_mul_f32 v179, v179, v3
    v_mul_f32 v180, v180, v3
    v_mul_f32 v181, v181, v3
    v_mul_f32 v182, v182, v3
    v_mul_f32 v183, v183, v3
    v_mul_f32 v184, v184, v3
    v_mul_f32 v185, v185, v3
    v_mul_f32 v186, v186, v3
    v_mul_f32 v187, v187, v3
    v_mul_f32 v188, v188, v3
    v_mul_f32 v189, v189, v3
    v_mul_f32 v190, v190, v3
    v_mul_f32 v191, v191, v3
    v_mul_f32 v192, v192, v3
    v_mul_f32 v193, v193, v3
    v_mul_f32 v194, v194, v3
    v_mul_f32 v195, v195, v3
    v_mul_f32 v196, v196, v3
    v_mul_f32 v197, v197, v3
    v_mul_f32 v198, v198, v3
    v_mul_f32 v199, v199, v3
    v_mul_f32 v200, v200, v3
    v_mul_f32 v201, v201, v3
    v_mul_f32 v202, v202, v3
    v_mul_f32 v203, v203, v3
    v_mul_f32 v204, v204, v3
    v_mul_f32 v205, v205, v3
    v_mul_f32 v206, v206, v3
    v_mul_f32 v207, v207, v3
    v_mul_f32 v208, v208, v3
    v_mul_f32 v209, v209, v3
    v_mul_f32 v210, v210, v3
    v_mul_f32 v211, v211, v3
    v_mul_f32 v212, v212, v3
    v_mul_f32 v213, v213, v3
    v_mul_f32 v214, v214, v3
    v_mul_f32 v215, v215, v3
    v_mul_f32 v216, v216, v3
    v_mul_f32 v217, v217, v3
    v_mul_f32 v218, v218, v3
    v_mul_f32 v219, v219, v3
    v_mul_f32 v220, v220, v3
    v_mul_f32 v221, v221, v3
    v_mul_f32 v222, v222, v3
    v_mul_f32 v223, v223, v3
    v_mul_f32 v224, v224, v3
    v_mul_f32 v225, v225, v3
    v_mul_f32 v226, v226, v3
    v_mul_f32 v227, v227, v3
    v_mul_f32 v228, v228, v3
    v_mul_f32 v229, v229, v3
    v_mul_f32 v230, v230, v3
    v_mul_f32 v231, v231, v3
    v_mul_f32 v232, v232, v3
    v_mul_f32 v233, v233, v3
    v_mul_f32 v234, v234, v3
    v_mul_f32 v235, v235, v3
attn_kernel_nors8:
    v_fma_f32 v140, v140, s34, -v27
    v_exp_f32 v140, v140
    v_fma_f32 v141, v141, s34, -v27
    v_exp_f32 v141, v141
    v_fma_f32 v142, v142, s34, -v27
    v_exp_f32 v142, v142
    v_fma_f32 v143, v143, s34, -v27
    v_exp_f32 v143, v143
    v_fma_f32 v144, v144, s34, -v27
    v_exp_f32 v144, v144
    v_fma_f32 v145, v145, s34, -v27
    v_exp_f32 v145, v145
    v_fma_f32 v146, v146, s34, -v27
    v_exp_f32 v146, v146
    v_fma_f32 v147, v147, s34, -v27
    v_exp_f32 v147, v147
    v_add_f32 v4, v140, v141
    v_cvt_pk_bf16_f32 v68, v140, v141
    v_add_f32 v5, v142, v143
    v_cvt_pk_bf16_f32 v69, v142, v143
    v_add_f32 v6, v144, v145
    v_cvt_pk_bf16_f32 v70, v144, v145
    v_add_f32 v7, v146, v147
    v_cvt_pk_bf16_f32 v71, v146, v147
    v_add_f32 v4, v4, v5
    v_add_f32 v6, v6, v7
    v_add_f32 v26, v26, v4
    v_add_f32 v26, v26, v6
    v_fma_f32 v148, v148, s34, -v27
    s_waitcnt lgkmcnt(6)
    v_mfma_f32_32x32x16_bf16 v[172:187], v[92:95], v[68:71], v[172:187]
    ds_read_b64_tr_b16 v[84:85], v18 offset:53248
    ds_read_b64_tr_b16 v[86:87], v18 offset:55296
    v_exp_f32 v148, v148
    v_fma_f32 v149, v149, s34, -v27
    v_exp_f32 v149, v149
    v_fma_f32 v150, v150, s34, -v27
    v_exp_f32 v150, v150
    s_waitcnt lgkmcnt(6)
    v_mfma_f32_32x32x16_bf16 v[188:203], v[96:99], v[68:71], v[188:203]
    ds_read_b64_tr_b16 v[88:89], v19 offset:53248
    ds_read_b64_tr_b16 v[90:91], v19 offset:55296
    v_fma_f32 v151, v151, s34, -v27
    v_exp_f32 v151, v151
    v_fma_f32 v152, v152, s34, -v27
    v_exp_f32 v152, v152
    v_fma_f32 v153, v153, s34, -v27
    s_waitcnt lgkmcnt(6)
    v_mfma_f32_32x32x16_bf16 v[204:219], v[100:103], v[68:71], v[204:219]
    ds_read_b64_tr_b16 v[92:93], v20 offset:53248
    ds_read_b64_tr_b16 v[94:95], v20 offset:55296
    v_exp_f32 v153, v153
    v_fma_f32 v154, v154, s34, -v27
    v_exp_f32 v154, v154
    v_fma_f32 v155, v155, s34, -v27
    v_exp_f32 v155, v155
    s_waitcnt lgkmcnt(6)
    v_mfma_f32_32x32x16_bf16 v[220:235], v[104:107], v[68:71], v[220:235]
    ds_read_b64_tr_b16 v[96:97], v21 offset:53248
    ds_read_b64_tr_b16 v[98:99], v21 offset:55296
    v_add_f32 v4, v148, v149
    v_cvt_pk_bf16_f32 v72, v148, v149
    v_add_f32 v5, v150, v151
    v_cvt_pk_bf16_f32 v73, v150, v151
    v_add_f32 v6, v152, v153
    v_cvt_pk_bf16_f32 v74, v152, v153
    v_add_f32 v7, v154, v155
    v_cvt_pk_bf16_f32 v75, v154, v155
    v_add_f32 v4, v4, v5
    v_add_f32 v6, v6, v7
    v_add_f32 v26, v26, v4
    v_add_f32 v26, v26, v6
    v_fma_f32 v156, v156, s34, -v27
    s_waitcnt lgkmcnt(6)
    v_mfma_f32_32x32x16_bf16 v[172:187], v[84:87], v[72:75], v[172:187]
    ds_read_b64_tr_b16 v[100:101], v18 offset:57344
    ds_read_b64_tr_b16 v[102:103], v18 offset:59392
    v_exp_f32 v156, v156
    v_fma_f32 v157, v157, s34, -v27
    v_exp_f32 v157, v157
    v_fma_f32 v158, v158, s34, -v27
    v_exp_f32 v158, v158
    s_waitcnt lgkmcnt(6)
    v_mfma_f32_32x32x16_bf16 v[188:203], v[88:91], v[72:75], v[188:203]
    ds_read_b64_tr_b16 v[104:105], v19 offset:57344
    ds_read_b64_tr_b16 v[106:107], v19 offset:59392
    v_fma_f32 v159, v159, s34, -v27
    v_exp_f32 v159, v159
    v_fma_f32 v160, v160, s34, -v27
    v_exp_f32 v160, v160
    v_fma_f32 v161, v161, s34, -v27
    s_waitcnt lgkmcnt(6)
    v_mfma_f32_32x32x16_bf16 v[204:219], v[92:95], v[72:75], v[204:219]
    ds_read_b64_tr_b16 v[84:85], v20 offset:57344
    ds_read_b64_tr_b16 v[86:87], v20 offset:59392
    v_exp_f32 v161, v161
    v_fma_f32 v162, v162, s34, -v27
    v_exp_f32 v162, v162
    v_fma_f32 v163, v163, s34, -v27
    v_exp_f32 v163, v163
    s_waitcnt lgkmcnt(6)
    v_mfma_f32_32x32x16_bf16 v[220:235], v[96:99], v[72:75], v[220:235]
    ds_read_b64_tr_b16 v[88:89], v21 offset:57344
    ds_read_b64_tr_b16 v[90:91], v21 offset:59392
    v_add_f32 v4, v156, v157
    v_cvt_pk_bf16_f32 v76, v156, v157
    v_add_f32 v5, v158, v159
    v_cvt_pk_bf16_f32 v77, v158, v159
    v_add_f32 v6, v160, v161
    v_cvt_pk_bf16_f32 v78, v160, v161
    v_add_f32 v7, v162, v163
    v_cvt_pk_bf16_f32 v79, v162, v163
    v_add_f32 v4, v4, v5
    v_add_f32 v6, v6, v7
    v_add_f32 v26, v26, v4
    v_add_f32 v26, v26, v6
    v_fma_f32 v164, v164, s34, -v27
    s_waitcnt lgkmcnt(6)
    v_mfma_f32_32x32x16_bf16 v[172:187], v[100:103], v[76:79], v[172:187]
    ds_read_b64_tr_b16 v[92:93], v18 offset:61440
    ds_read_b64_tr_b16 v[94:95], v18 offset:63488
    v_exp_f32 v164, v164
    v_fma_f32 v165, v165, s34, -v27
    v_exp_f32 v165, v165
    v_fma_f32 v166, v166, s34, -v27
    v_exp_f32 v166, v166
    s_waitcnt lgkmcnt(6)
    v_mfma_f32_32x32x16_bf16 v[188:203], v[104:107], v[76:79], v[188:203]
    ds_read_b64_tr_b16 v[96:97], v19 offset:61440
    ds_read_b64_tr_b16 v[98:99], v19 offset:63488
    v_fma_f32 v167, v167, s34, -v27
    v_exp_f32 v167, v167
    v_fma_f32 v168, v168, s34, -v27
    v_exp_f32 v168, v168
    v_fma_f32 v169, v169, s34, -v27
    s_waitcnt lgkmcnt(6)
    v_mfma_f32_32x32x16_bf16 v[204:219], v[84:87], v[76:79], v[204:219]
    ds_read_b64_tr_b16 v[100:101], v20 offset:61440
    ds_read_b64_tr_b16 v[102:103], v20 offset:63488
    v_exp_f32 v169, v169
    v_fma_f32 v170, v170, s34, -v27
    v_exp_f32 v170, v170
    v_fma_f32 v171, v171, s34, -v27
    v_exp_f32 v171, v171
    s_waitcnt lgkmcnt(6)
    v_mfma_f32_32x32x16_bf16 v[220:235], v[88:91], v[76:79], v[220:235]
    ds_read_b64_tr_b16 v[104:105], v21 offset:61440
    ds_read_b64_tr_b16 v[106:107], v21 offset:63488
    v_add_f32 v4, v164, v165
    v_cvt_pk_bf16_f32 v80, v164, v165
    v_add_f32 v5, v166, v167
    v_cvt_pk_bf16_f32 v81, v166, v167
    v_add_f32 v6, v168, v169
    v_cvt_pk_bf16_f32 v82, v168, v169
    v_add_f32 v7, v170, v171
    v_cvt_pk_bf16_f32 v83, v170, v171
    v_add_f32 v4, v4, v5
    v_add_f32 v6, v6, v7
    v_add_f32 v26, v26, v4
    v_add_f32 v26, v26, v6
    s_waitcnt lgkmcnt(6)
    v_mfma_f32_32x32x16_bf16 v[172:187], v[92:95], v[80:83], v[172:187]
    s_waitcnt lgkmcnt(4)
    v_mfma_f32_32x32x16_bf16 v[188:203], v[96:99], v[80:83], v[188:203]
    s_waitcnt lgkmcnt(2)
    v_mfma_f32_32x32x16_bf16 v[204:219], v[100:103], v[80:83], v[204:219]
    s_waitcnt lgkmcnt(0)
    v_mfma_f32_32x32x16_bf16 v[220:235], v[104:107], v[80:83], v[220:235]
    v_mov_b32 v2, v26
    s_nop 1
    v_permlane32_swap_b32 v26, v2
    v_add_f32 v26, v26, v2
    v_rcp_f32 v26, v26
    s_nop 0
    v_mul_f32 v172, v172, v26
    v_mul_f32 v173, v173, v26
    v_cvt_pk_bf16_f32 v108, v172, v173
    v_mul_f32 v174, v174, v26
    v_mul_f32 v175, v175, v26
    v_cvt_pk_bf16_f32 v109, v174, v175
    v_mul_f32 v176, v176, v26
    v_mul_f32 v177, v177, v26
    v_cvt_pk_bf16_f32 v110, v176, v177
    v_mul_f32 v178, v178, v26
    v_mul_f32 v179, v179, v26
    v_cvt_pk_bf16_f32 v111, v178, v179
    v_mul_f32 v180, v180, v26
    v_mul_f32 v181, v181, v26
    v_cvt_pk_bf16_f32 v112, v180, v181
    v_mul_f32 v182, v182, v26
    v_mul_f32 v183, v183, v26
    v_cvt_pk_bf16_f32 v113, v182, v183
    v_mul_f32 v184, v184, v26
    v_mul_f32 v185, v185, v26
    v_cvt_pk_bf16_f32 v114, v184, v185
    v_mul_f32 v186, v186, v26
    v_mul_f32 v187, v187, v26
    v_cvt_pk_bf16_f32 v115, v186, v187
    v_permlane32_swap_b32 v108, v110
    v_permlane32_swap_b32 v109, v111
    buffer_store_dwordx4 v[108:111], v28, s[24:27], 0 offen offset:0
    v_permlane32_swap_b32 v112, v114
    v_permlane32_swap_b32 v113, v115
    buffer_store_dwordx4 v[112:115], v28, s[24:27], 0 offen offset:32
    v_mul_f32 v188, v188, v26
    v_mul_f32 v189, v189, v26
    v_cvt_pk_bf16_f32 v116, v188, v189
    v_mul_f32 v190, v190, v26
    v_mul_f32 v191, v191, v26
    v_cvt_pk_bf16_f32 v117, v190, v191
    v_mul_f32 v192, v192, v26
    v_mul_f32 v193, v193, v26
    v_cvt_pk_bf16_f32 v118, v192, v193
    v_mul_f32 v194, v194, v26
    v_mul_f32 v195, v195, v26
    v_cvt_pk_bf16_f32 v119, v194, v195
    v_mul_f32 v196, v196, v26
    v_mul_f32 v197, v197, v26
    v_cvt_pk_bf16_f32 v120, v196, v197
    v_mul_f32 v198, v198, v26
    v_mul_f32 v199, v199, v26
    v_cvt_pk_bf16_f32 v121, v198, v199
    v_mul_f32 v200, v200, v26
    v_mul_f32 v201, v201, v26
    v_cvt_pk_bf16_f32 v122, v200, v201
    v_mul_f32 v202, v202, v26
    v_mul_f32 v203, v203, v26
    v_cvt_pk_bf16_f32 v123, v202, v203
    v_permlane32_swap_b32 v116, v118
    v_permlane32_swap_b32 v117, v119
    buffer_store_dwordx4 v[116:119], v28, s[24:27], 0 offen offset:64
    v_permlane32_swap_b32 v120, v122
    v_permlane32_swap_b32 v121, v123
    buffer_store_dwordx4 v[120:123], v28, s[24:27], 0 offen offset:96
    v_mul_f32 v204, v204, v26
    v_mul_f32 v205, v205, v26
    v_cvt_pk_bf16_f32 v124, v204, v205
    v_mul_f32 v206, v206, v26
    v_mul_f32 v207, v207, v26
    v_cvt_pk_bf16_f32 v125, v206, v207
    v_mul_f32 v208, v208, v26
    v_mul_f32 v209, v209, v26
    v_cvt_pk_bf16_f32 v126, v208, v209
    v_mul_f32 v210, v210, v26
    v_mul_f32 v211, v211, v26
    v_cvt_pk_bf16_f32 v127, v210, v211
    v_mul_f32 v212, v212, v26
    v_mul_f32 v213, v213, v26
    v_cvt_pk_bf16_f32 v128, v212, v213
    v_mul_f32 v214, v214, v26
    v_mul_f32 v215, v215, v26
    v_cvt_pk_bf16_f32 v129, v214, v215
    v_mul_f32 v216, v216, v26
    v_mul_f32 v217, v217, v26
    v_cvt_pk_bf16_f32 v130, v216, v217
    v_mul_f32 v218, v218, v26
    v_mul_f32 v219, v219, v26
    v_cvt_pk_bf16_f32 v131, v218, v219
    v_permlane32_swap_b32 v124, v126
    v_permlane32_swap_b32 v125, v127
    buffer_store_dwordx4 v[124:127], v28, s[24:27], 0 offen offset:128
    v_permlane32_swap_b32 v128, v130
    v_permlane32_swap_b32 v129, v131
    buffer_store_dwordx4 v[128:131], v28, s[24:27], 0 offen offset:160
    v_mul_f32 v220, v220, v26
    v_mul_f32 v221, v221, v26
    v_cvt_pk_bf16_f32 v132, v220, v221
    v_mul_f32 v222, v222, v26
    v_mul_f32 v223, v223, v26
    v_cvt_pk_bf16_f32 v133, v222, v223
    v_mul_f32 v224, v224, v26
    v_mul_f32 v225, v225, v26
    v_cvt_pk_bf16_f32 v134, v224, v225
    v_mul_f32 v226, v226, v26
    v_mul_f32 v227, v227, v26
    v_cvt_pk_bf16_f32 v135, v226, v227
    v_mul_f32 v228, v228, v26
    v_mul_f32 v229, v229, v26
    v_cvt_pk_bf16_f32 v136, v228, v229
    v_mul_f32 v230, v230, v26
    v_mul_f32 v231, v231, v26
    v_cvt_pk_bf16_f32 v137, v230, v231
    v_mul_f32 v232, v232, v26
    v_mul_f32 v233, v233, v26
    v_cvt_pk_bf16_f32 v138, v232, v233
    v_mul_f32 v234, v234, v26
    v_mul_f32 v235, v235, v26
    v_cvt_pk_bf16_f32 v139, v234, v235
    v_permlane32_swap_b32 v132, v134
    v_permlane32_swap_b32 v133, v135
    buffer_store_dwordx4 v[132:135], v28, s[24:27], 0 offen offset:192
    v_permlane32_swap_b32 v136, v138
    v_permlane32_swap_b32 v137, v139
    buffer_store_dwordx4 v[136:139], v28, s[24:27], 0 offen offset:224
attn_kernel_end:
    s_endpgm
.section .rodata,"a"
.p2align 6
.amdhsa_kernel attn_kernel
  .amdhsa_next_free_vgpr 236
  .amdhsa_next_free_sgpr 100
  .amdhsa_accum_offset 236
  .amdhsa_group_segment_fixed_size 0
  .amdhsa_kernarg_size 112
  .amdhsa_user_sgpr_count 2
  .amdhsa_user_sgpr_kernarg_segment_ptr 1
  .amdhsa_system_sgpr_workgroup_id_x 1
.end_amdhsa_kernel

.text
.globl oproj_kernel
.p2align 8
.type oproj_kernel,@function
oproj_kernel:
    s_cmp_ge_u32 s2, 256
    s_cbranch_scc1 oproj_kernel_end
    s_load_dwordx2 s[4:5], s[0:1], 104
    s_load_dwordx2 s[6:7], s[0:1], 32
    s_load_dwordx2 s[10:11], s[0:1], 0
    s_load_dwordx2 s[52:53], s[0:1], 88
    v_and_b32 v1, 63, v0
    v_lshrrev_b32 v2, 6, v0
    s_nop 0
    v_readfirstlane_b32 s38, v2
    s_and_b32 s45, s2, 7
    s_lshr_b32 s46, s2, 3
    s_and_b32 s47, s45, 1
    s_lshr_b32 s48, s45, 1
    s_and_b32 s49, s46, 7
    s_lshr_b32 s50, s46, 3
    s_mul_i32 s47, s47, 8
    s_add_u32 s36, s47, s49
    s_mul_i32 s48, s48, 4
    s_add_u32 s37, s48, s50
    s_mul_i32 s36, s36, 128
    s_mul_i32 s37, s37, 64
    s_waitcnt lgkmcnt(0)
    s_add_u32 s12, s4, 0x1500000
    s_addc_u32 s13, s5, 0
    s_mov_b32 s14, 0x1000000
    s_mov_b32 s15, 0x00020000
    s_mov_b32 s16, s6
    s_mov_b32 s17, s7
    s_mov_b32 s18, 0x800000
    s_mov_b32 s19, 0x00020000
    s_add_u32 s24, s4, 0x2500000
    s_addc_u32 s25, s5, 0
    s_mov_b32 s26, 0x400000
    s_mov_b32 s27, 0x00020000
    s_mov_b32 s28, s10
    s_mov_b32 s29, s11
    s_mov_b32 s30, 0x400000
    s_mov_b32 s31, 0x00020000
    s_mov_b32 s32, s4
    s_mov_b32 s33, s5
    s_mov_b32 s34, 0x6000
    s_mov_b32 s35, 0x00020000
    s_mul_i32 s45, s38, 16
    s_mov_b32 s46, 8192
    v_lshrrev_b32 v2, 3, v1
    v_add_u32 v2, s45, v2
    v_and_b32 v3, 7, v1
    v_add_u32 v4, 0, v2
    v_bfe_u32 v5, v4, 1, 3
    v_xor_b32 v5, v5, v3
    v_add_u32 v4, s36, v4
    v_mul_lo_u32 v4, v4, s46
    v_lshl_add_u32 v8, v5, 4, v4
    v_add_u32 v4, 8, v2
    v_bfe_u32 v5, v4, 1, 3
    v_xor_b32 v5, v5, v3
    v_add_u32 v4, s36, v4
    v_mul_lo_u32 v4, v4, s46
    v_lshl_add_u32 v9, v5, 4, v4
    v_subrev_u32 v9, 1024, v9
    s_mul_i32 s45, s38, 8
    s_mov_b32 s46, 2048
    s_lshl_b32 s47, s37, 1
    v_lshrrev_b32 v2, 3, v1
    v_add_u32 v2, s45, v2
    v_and_b32 v3, 7, v1
    v_add_u32 v4, 0, v2
    v_lshrrev_b32 v5, 1, v4
    v_and_b32 v5, 1, v5
    v_lshlrev_b32 v5, 2, v5
    v_xor_b32 v5, v5, v3
    v_mul_lo_u32 v4, v4, s46
    v_lshl_add_u32 v10, v5, 4, v4
    v_add_u32 v10, s47, v10
    s_mul_i32 s42, s38, 2048
    s_mul_i32 s43, s38, 1024
    s_add_u32 s43, s43, 16384
    s_mov_b32 s39, 0
    s_mov_b32 s40, 0
    s_add_u32 m0, s42, 0
    s_nop 0
    buffer_load_dwordx4 v8, s[12:15], s39 offen offset:0 lds
    buffer_load_dwordx4 v9, s[12:15], s39 offen offset:1024 lds
    s_add_u32 m0, s43, 0
    s_nop 0
    buffer_load_dwordx4 v10, s[16:19], s40 offen offset:0 lds
    s_add_u32 s39, s39, 128
    s_add_u32 s40, s40, 131072
    s_add_u32 m0, s42, 24576
    s_nop 0
    buffer_load_dwordx4 v8, s[12:15], s39 offen offset:0 lds
    buffer_load_dwordx4 v9, s[12:15], s39 offen offset:1024 lds
    s_add_u32 m0, s43, 24576
    s_nop 0
    buffer_load_dwordx4 v10, s[16:19], s40 offen offset:0 lds
    s_add_u32 s39, s39, 128
    s_add_u32 s40, s40, 131072
    s_add_u32 m0, s42, 49152
    s_nop 0
    buffer_load_dwordx4 v8, s[12:15], s39 offen offset:0 lds
    buffer_load_dwordx4 v9, s[12:15], s39 offen offset:1024 lds
    s_add_u32 m0, s43, 49152
    s_nop 0
    buffer_load_dwordx4 v10, s[16:19], s40 offen offset:0 lds
    s_add_u32 s39, s39, 128
    s_add_u32 s40, s40, 131072
    s_add_u32 m0, s42, 73728
    s_nop 0
    buffer_load_dwordx4 v8, s[12:15], s39 offen offset:0 lds
    buffer_load_dwordx4 v9, s[12:15], s39 offen offset:1024 lds
    s_add_u32 m0, s43, 73728
    s_nop 0
    buffer_load_dwordx4 v10, s[16:19], s40 offen offset:0 lds
    s_add_u32 s39, s39, 128
    s_add_u32 s40, s40, 131072
    s_lshr_b32 s45, s38, 1
    s_and_b32 s46, s38, 1
    s_mul_i32 s47, s45, 32
    s_mul_i32 s48, s46, 32
    v_and_b32 v2, 31, v1
    v_add_u32 v2, s47, v2
    v_lshrrev_b32 v3, 5, v1
    v_bfe_u32 v4, v2, 1, 3
    v_xor_b32 v4, v4, v3
    v_lshlrev_b32 v4, 4, v4
    v_lshl_add_u32 v4, v2, 7, v4
    v_xor_b32 v11, 0, v4
    v_add_u32 v15, 24576, v11
    v_add_u32 v19, 49152, v11
    v_add_u32 v23, 73728, v11
    v_xor_b32 v12, 32, v4
    v_add_u32 v16, 24576, v12
    v_add_u32 v20, 49152, v12
    v_add_u32 v24, 73728, v12
    v_xor_b32 v13, 64, v4
    v_add_u32 v17, 24576, v13
    v_add_u32 v21, 49152, v13
    v_add_u32 v25, 73728, v13
    v_xor_b32 v14, 96, v4
    v_add_u32 v18, 24576, v14
    v_add_u32 v22, 49152, v14
    v_add_u32 v26, 73728, v14
    v_add_u32 v2, s36, v2
    s_add_u32 s48, s48, s37
    s_lshl_b32 s49, s48, 1
    s_mov_b32 s50, 2048
    v_mul_lo_u32 v31, v2, s50
    v_add_u32 v31, s49, v31
    v_lshl_add_u32 v31, v3, 4, v31
    v_lshlrev_b32 v32, 11, v2
    v_add_u32 v32, s49, v32
    v_lshl_add_u32 v32, v3, 3, v32
    s_lshl_b32 s49, s48, 2
    s_add_u32 s49, s49, 8192
    v_lshlrev_b32 v33, 4, v3
    v_add_u32 v33, s49, v33
    s_mov_b32 s50, 0
    s_mov_b32 s58, 65536
    buffer_load_dwordx4 v[84:87], v33, s[32:35], 0 offen offset:0
    buffer_load_dwordx4 v[88:91], v33, s[32:35], 0 offen offset:32
    buffer_load_dwordx4 v[92:95], v33, s[32:35], 0 offen offset:64
    buffer_load_dwordx4 v[96:99], v33, s[32:35], 0 offen offset:96
    buffer_load_dwordx2 v[100:101], v32, s[28:31], s50 offen offset:0
    buffer_load_dwordx2 v[102:103], v32, s[28:31], s50 offen offset:16
    buffer_load_dwordx2 v[104:105], v32, s[28:31], s50 offen offset:32
    buffer_load_dwordx2 v[106:107], v32, s[28:31], s50 offen offset:48
    s_mul_i32 s48, s46, 4
    v_bfe_u32 v2, v1, 2, 2
    v_and_b32 v3, 3, v1
    v_bfe_u32 v4, v1, 4, 1
    v_lshrrev_b32 v5, 5, v1
    v_lshl_add_u32 v5, v5, 3, v2
    v_lshlrev_b32 v5, 7, v5
    v_and_b32 v6, 1, v3
    v_lshl_add_u32 v5, v6, 3, v5
    v_add_u32 v5, 16384, v5
    v_lshrrev_b32 v3, 1, v3
    v_lshl_add_u32 v3, v4, 1, v3
    v_add_u32 v3, s48, v3
    v_lshrrev_b32 v2, 1, v2
    v_and_b32 v2, 1, v2
    v_lshlrev_b32 v2, 2, v2
    v_add_u32 v4, 0, v3
    v_xor_b32 v4, v4, v2
    v_lshl_add_u32 v27, v4, 4, v5
    v_add_u32 v28, 24576, v27
    v_add_u32 v29, 49152, v27
    v_add_u32 v30, 73728, v27
    v_mov_b32 v108, 0
    v_mov_b32 v109, 0
    v_mov_b32 v110, 0
    v_mov_b32 v111, 0
    v_mov_b32 v112, 0
    v_mov_b32 v113, 0
    v_mov_b32 v114, 0
    v_mov_b32 v115, 0
    v_mov_b32 v116, 0
    v_mov_b32 v117, 0
    v_mov_b32 v118, 0
    v_mov_b32 v119, 0
    v_mov_b32 v120, 0
    v_mov_b32 v121, 0
    v_mov_b32 v122, 0
    v_mov_b32 v123, 0
    s_waitcnt vmcnt(17)
    s_barrier
    ds_read_b128 v[36:39], v11 offset:0
    ds_read_b64_tr_b16 v[44:45], v27 offset:0
    ds_read_b64_tr_b16 v[46:47], v27 offset:512
    s_mov_b32 s41, 15
oproj_kernel_loop:
    s_waitcnt lgkmcnt(0)
    v_mfma_f32_32x32x16_bf16 v[108:123], v[44:47], v[36:39], v[108:123]
    ds_read_b128 v[40:43], v12 offset:0
    ds_read_b64_tr_b16 v[48:49], v27 offset:2048
    ds_read_b64_tr_b16 v[50:51], v27 offset:2560
    s_waitcnt lgkmcnt(0)
    v_mfma_f32_32x32x16_bf16 v[108:123], v[48:51], v[40:43], v[108:123]
    ds_read_b128 v[36:39], v13 offset:0
    ds_read_b64_tr_b16 v[44:45], v27 offset:4096
    ds_read_b64_tr_b16 v[46:47], v27 offset:4608
    s_waitcnt lgkmcnt(0)
    v_mfma_f32_32x32x16_bf16 v[108:123], v[44:47], v[36:39], v[108:123]
    ds_read_b128 v[40:43], v14 offset:0
    ds_read_b64_tr_b16 v[48:49], v27 offset:6144
    ds_read_b64_tr_b16 v[50:51], v27 offset:6656
    s_waitcnt vmcnt(6) lgkmcnt(0)
    s_barrier
    v_mfma_f32_32x32x16_bf16 v[108:123], v[48:51], v[40:43], v[108:123]
    ds_read_b128 v[36:39], v15 offset:0
    ds_read_b64_tr_b16 v[44:45], v28 offset:0
    ds_read_b64_tr_b16 v[46:47], v28 offset:512
    s_add_u32 m0, s42, 0
    s_nop 0
    buffer_load_dwordx4 v8, s[12:15], s39 offen offset:0 lds
    buffer_load_dwordx4 v9, s[12:15], s39 offen offset:1024 lds
    s_add_u32 m0, s43, 0
    s_nop 0
    buffer_load_dwordx4 v10, s[16:19], s40 offen offset:0 lds
    s_add_u32 s39, s39, 128
    s_add_u32 s40, s40, 131072
    s_waitcnt lgkmcnt(0)
    v_mfma_f32_32x32x16_bf16 v[108:123], v[44:47], v[36:39], v[108:123]
    ds_read_b128 v[40:43], v16 offset:0
    ds_read_b64_tr_b16 v[48:49], v28 offset:2048
    ds_read_b64_tr_b16 v[50:51], v28 offset:2560
    s_waitcnt lgkmcnt(0)
    v_mfma_f32_32x32x16_bf16 v[108:123], v[48:51], v[40:43], v[108:123]
    ds_read_b128 v[36:39], v17 offset:0
    ds_read_b64_tr_b16 v[44:45], v28 offset:4096
    ds_read_b64_tr_b16 v[46:47], v28 offset:4608
    s_waitcnt lgkmcnt(0)
    v_mfma_f32_32x32x16_bf16 v[108:123], v[44:47], v[36:39], v[108:123]
    ds_read_b128 v[40:43], v18 offset:0
    ds_read_b64_tr_b16 v[48:49], v28 offset:6144
    ds_read_b64_tr_b16 v[50:51], v28 offset:6656
    s_waitcnt vmcnt(6) lgkmcnt(0)
    s_barrier
    v_mfma_f32_32x32x16_bf16 v[108:123], v[48:51], v[40:43], v[108:123]
    ds_read_b128 v[36:39], v19 offset:0
    ds_read_b64_tr_b16 v[44:45], v29 offset:0
    ds_read_b64_tr_b16 v[46:47], v29 offset:512
    s_add_u32 m0, s42, 24576
    s_nop 0
    buffer_load_dwordx4 v8, s[12:15], s39 offen offset:0 lds
    buffer_load_dwordx4 v9, s[12:15], s39 offen offset:1024 lds
    s_add_u32 m0, s43, 24576
    s_nop 0
    buffer_load_dwordx4 v10, s[16:19], s40 offen offset:0 lds
    s_add_u32 s39, s39, 128
    s_add_u32 s40, s40, 131072
    s_waitcnt lgkmcnt(0)
    v_mfma_f32_32x32x16_bf16 v[108:123], v[44:47], v[36:39], v[108:123]
    ds_read_b128 v[40:43], v20 offset:0
    ds_read_b64_tr_b16 v[48:49], v29 offset:2048
    ds_read_b64_tr_b16 v[50:51], v29 offset:2560
    s_waitcnt lgkmcnt(0)
    v_mfma_f32_32x32x16_bf16 v[108:123], v[48:51], v[40:43], v[108:123]
    ds_read_b128 v[36:39], v21 offset:0
    ds_read_b64_tr_b16 v[44:45], v29 offset:4096
    ds_read_b64_tr_b16 v[46:47], v29 offset:4608
    s_waitcnt lgkmcnt(0)
    v_mfma_f32_32x32x16_bf16 v[108:123], v[44:47], v[36:39], v[108:123]
    ds_read_b128 v[40:43], v22 offset:0
    ds_read_b64_tr_b16 v[48:49], v29 offset:6144
    ds_read_b64_tr_b16 v[50:51], v29 offset:6656
    s_waitcnt vmcnt(6) lgkmcnt(0)
    s_barrier
    v_mfma_f32_32x32x16_bf16 v[108:123], v[48:51], v[40:43], v[108:123]
    ds_read_b128 v[36:39], v23 offset:0
    ds_read_b64_tr_b16 v[44:45], v30 offset:0
    ds_read_b64_tr_b16 v[46:47], v30 offset:512
    s_add_u32 m0, s42, 49152
    s_nop 0
    buffer_load_dwordx4 v8, s[12:15], s39 offen offset:0 lds
    buffer_load_dwordx4 v9, s[12:15], s39 offen offset:1024 lds
    s_add_u32 m0, s43, 49152
    s_nop 0
    buffer_load_dwordx4 v10, s[16:19], s40 offen offset:0 lds
    s_add_u32 s39, s39, 128
    s_add_u32 s40, s40, 131072
    s_waitcnt lgkmcnt(0)
    v_mfma_f32_32x32x16_bf16 v[108:123], v[44:47], v[36:39], v[108:123]
    ds_read_b128 v[40:43], v24 offset:0
    ds_read_b64_tr_b16 v[48:49], v30 offset:2048
    ds_read_b64_tr_b16 v[50:51], v30 offset:2560
    s_waitcnt lgkmcnt(0)
    v_mfma_f32_32x32x16_bf16 v[108:123], v[48:51], v[40:43], v[108:123]
    ds_read_b128 v[36:39], v25 offset:0
    ds_read_b64_tr_b16 v[44:45], v30 offset:4096
    ds_read_b64_tr_b16 v[46:47], v30 offset:4608
    s_waitcnt lgkmcnt(0)
    v_mfma_f32_32x32x16_bf16 v[108:123], v[44:47], v[36:39], v[108:123]
    ds_read_b128 v[40:43], v26 offset:0
    ds_read_b64_tr_b16 v[48:49], v30 offset:6144
    ds_read_b64_tr_b16 v[50:51], v30 offset:6656
    s_waitcnt vmcnt(6) lgkmcnt(0)
    s_barrier
    v_mfma_f32_32x32x16_bf16 v[108:123], v[48:51], v[40:43], v[108:123]
    ds_read_b128 v[36:39], v11 offset:0
    ds_read_b64_tr_b16 v[44:45], v27 offset:0
    ds_read_b64_tr_b16 v[46:47], v27 offset:512
    s_add_u32 m0, s42, 73728
    s_nop 0
    buffer_load_dwordx4 v8, s[12:15], s39 offen offset:0 lds
    buffer_load_dwordx4 v9, s[12:15], s39 offen offset:1024 lds
    s_add_u32 m0, s43, 73728
    s_nop 0
    buffer_load_dwordx4 v10, s[16:19], s40 offen offset:0 lds
    s_add_u32 s39, s39, 128
    s_add_u32 s40, s40, 131072
    s_sub_u32 s41, s41, 1
    s_cmp_lg_u32 s41, 0
    s_cbranch_scc1 oproj_kernel_loop
    s_waitcnt lgkmcnt(0)
    v_mfma_f32_32x32x16_bf16 v[108:123], v[44:47], v[36:39], v[108:123]
    ds_read_b128 v[40:43], v12 offset:0
    ds_read_b64_tr_b16 v[48:49], v27 offset:2048
    ds_read_b64_tr_b16 v[50:51], v27 offset:2560
    s_waitcnt lgkmcnt(0)
    v_mfma_f32_32x32x16_bf16 v[108:123], v[48:51], v[40:43], v[108:123]
    ds_read_b128 v[36:39], v13 offset:0
    ds_read_b64_tr_b16 v[44:45], v27 offset:4096
    ds_read_b64_tr_b16 v[46:47], v27 offset:4608
    s_waitcnt lgkmcnt(0)
    v_mfma_f32_32x32x16_bf16 v[108:123], v[44:47], v[36:39], v[108:123]
    ds_read_b128 v[40:43], v14 offset:0
    ds_read_b64_tr_b16 v[48:49], v27 offset:6144
    ds_read_b64_tr_b16 v[50:51], v27 offset:6656
    s_waitcnt vmcnt(6) lgkmcnt(0)
    s_barrier
    v_mfma_f32_32x32x16_bf16 v[108:123], v[48:51], v[40:43], v[108:123]
    ds_read_b128 v[36:39], v15 offset:0
    ds_read_b64_tr_b16 v[44:45], v28 offset:0
    ds_read_b64_tr_b16 v[46:47], v28 offset:512
    s_waitcnt lgkmcnt(0)
    v_mfma_f32_32x32x16_bf16 v[108:123], v[44:47], v[36:39], v[108:123]
    ds_read_b128 v[40:43], v16 offset:0
    ds_read_b64_tr_b16 v[48:49], v28 offset:2048
    ds_read_b64_tr_b16 v[50:51], v28 offset:2560
    s_waitcnt lgkmcnt(0)
    v_mfma_f32_32x32x16_bf16 v[108:123], v[48:51], v[40:43], v[108:123]
    ds_read_b128 v[36:39], v17 offset:0
    ds_read_b64_tr_b16 v[44:45], v28 offset:4096
    ds_read_b64_tr_b16 v[46:47], v28 offset:4608
    s_waitcnt lgkmcnt(0)
    v_mfma_f32_32x32x16_bf16 v[108:123], v[44:47], v[36:39], v[108:123]
    ds_read_b128 v[40:43], v18 offset:0
    ds_read_b64_tr_b16 v[48:49], v28 offset:6144
    ds_read_b64_tr_b16 v[50:51], v28 offset:6656
    s_waitcnt vmcnt(3) lgkmcnt(0)
    s_barrier
    v_mfma_f32_32x32x16_bf16 v[108:123], v[48:51], v[40:43], v[108:123]
    ds_read_b128 v[36:39], v19 offset:0
    ds_read_b64_tr_b16 v[44:45], v29 offset:0
    ds_read_b64_tr_b16 v[46:47], v29 offset:512
    s_waitcnt lgkmcnt(0)
    v_mfma_f32_32x32x16_bf16 v[108:123], v[44:47], v[36:39], v[108:123]
    ds_read_b128 v[40:43], v20 offset:0
    ds_read_b64_tr_b16 v[48:49], v29 offset:2048
    ds_read_b64_tr_b16 v[50:51], v29 offset:2560
    s_waitcnt lgkmcnt(0)
    v_mfma_f32_32x32x16_bf16 v[108:123], v[48:51], v[40:43], v[108:123]
    ds_read_b128 v[36:39], v21 offset:0
    ds_read_b64_tr_b16 v[44:45], v29 offset:4096
    ds_read_b64_tr_b16 v[46:47], v29 offset:4608
    s_waitcnt lgkmcnt(0)
    v_mfma_f32_32x32x16_bf16 v[108:123], v[44:47], v[36:39], v[108:123]
    ds_read_b128 v[40:43], v22 offset:0
    ds_read_b64_tr_b16 v[48:49], v29 offset:6144
    ds_read_b64_tr_b16 v[50:51], v29 offset:6656
    s_waitcnt vmcnt(0) lgkmcnt(0)
    s_barrier
    v_mfma_f32_32x32x16_bf16 v[108:123], v[48:51], v[40:43], v[108:123]
    ds_read_b128 v[36:39], v23 offset:0
    ds_read_b64_tr_b16 v[44:45], v30 offset:0
    ds_read_b64_tr_b16 v[46:47], v30 offset:512
    s_waitcnt lgkmcnt(0)
    v_mfma_f32_32x32x16_bf16 v[108:123], v[44:47], v[36:39], v[108:123]
    ds_read_b128 v[40:43], v24 offset:0
    ds_read_b64_tr_b16 v[48:49], v30 offset:2048
    ds_read_b64_tr_b16 v[50:51], v30 offset:2560
    s_waitcnt lgkmcnt(0)
    v_mfma_f32_32x32x16_bf16 v[108:123], v[48:51], v[40:43], v[108:123]
    ds_read_b128 v[36:39], v25 offset:0
    ds_read_b64_tr_b16 v[44:45], v30 offset:4096
    ds_read_b64_tr_b16 v[46:47], v30 offset:4608
    s_waitcnt lgkmcnt(0)
    v_mfma_f32_32x32x16_bf16 v[108:123], v[44:47], v[36:39], v[108:123]
    ds_read_b128 v[40:43], v26 offset:0
    ds_read_b64_tr_b16 v[48:49], v30 offset:6144
    ds_read_b64_tr_b16 v[50:51], v30 offset:6656
    s_waitcnt lgkmcnt(0)
    v_mfma_f32_32x32x16_bf16 v[108:123], v[48:51], v[40:43], v[108:123]
    s_mov_b32 s46, 0
    s_mov_b32 s45, 65536
    s_mov_b32 s47, 65536
    s_nop 8
    v_cvt_pk_bf16_f32 v2, v108, v109
    v_lshlrev_b32 v108, 16, v2
    v_and_b32 v109, 0xffff0000, v2
    v_mul_f32 v108, v108, v84
    v_mul_f32 v109, v109, v85
    v_cvt_pk_bf16_f32 v2, v108, v109
    v_lshlrev_b32 v108, 16, v2
    v_and_b32 v109, 0xffff0000, v2
    v_lshlrev_b32 v3, 16, v100
    v_and_b32 v4, 0xffff0000, v100
    v_add_f32 v108, v108, v3
    v_add_f32 v109, v109, v4
    v_cvt_pk_bf16_f32 v52, v108, v109
    v_cvt_pk_bf16_f32 v2, v110, v111
    v_lshlrev_b32 v110, 16, v2
    v_and_b32 v111, 0xffff0000, v2
    v_mul_f32 v110, v110, v86
    v_mul_f32 v111, v111, v87
    v_cvt_pk_bf16_f32 v2, v110, v111
    v_lshlrev_b32 v110, 16, v2
    v_and_b32 v111, 0xffff0000, v2
    v_lshlrev_b32 v3, 16, v101
    v_and_b32 v4, 0xffff0000, v101
    v_add_f32 v110, v110, v3
    v_add_f32 v111, v111, v4
    v_cvt_pk_bf16_f32 v53, v110, v111
    v_cvt_pk_bf16_f32 v2, v112, v113
    v_lshlrev_b32 v112, 16, v2
    v_and_b32 v113, 0xffff0000, v2
    v_mul_f32 v112, v112, v88
    v_mul_f32 v113, v113, v89
    v_cvt_pk_bf16_f32 v2, v112, v113
    v_lshlrev_b32 v112, 16, v2
    v_and_b32 v113, 0xffff0000, v2
    v_lshlrev_b32 v3, 16, v102
    v_and_b32 v4, 0xffff0000, v102
    v_add_f32 v112, v112, v3
    v_add_f32 v113, v113, v4
    v_cvt_pk_bf16_f32 v54, v112, v113
    v_cvt_pk_bf16_f32 v2, v114, v115
    v_lshlrev_b32 v114, 16, v2
    v_and_b32 v115, 0xffff0000, v2
    v_mul_f32 v114, v114, v90
    v_mul_f32 v115, v115, v91
    v_cvt_pk_bf16_f32 v2, v114, v115
    v_lshlrev_b32 v114, 16, v2
    v_and_b32 v115, 0xffff0000, v2
    v_lshlrev_b32 v3, 16, v103
    v_and_b32 v4, 0xffff0000, v103
    v_add_f32 v114, v114, v3
    v_add_f32 v115, v115, v4
    v_cvt_pk_bf16_f32 v55, v114, v115
    v_cvt_pk_bf16_f32 v2, v116, v117
    v_lshlrev_b32 v116, 16, v2
    v_and_b32 v117, 0xffff0000, v2
    v_mul_f32 v116, v116, v92
    v_mul_f32 v117, v117, v93
    v_cvt_pk_bf16_f32 v2, v116, v117
    v_lshlrev_b32 v116, 16, v2
    v_and_b32 v117, 0xffff0000, v2
    v_lshlrev_b32 v3, 16, v104
    v_and_b32 v4, 0xffff0000, v104
    v_add_f32 v116, v116, v3
    v_add_f32 v117, v117, v4
    v_cvt_pk_bf16_f32 v56, v116, v117
    v_cvt_pk_bf16_f32 v2, v118, v119
    v_lshlrev_b32 v118, 16, v2
    v_and_b32 v119, 0xffff0000, v2
    v_mul_f32 v118, v118, v94
    v_mul_f32 v119, v119, v95
    v_cvt_pk_bf16_f32 v2, v118, v119
    v_lshlrev_b32 v118, 16, v2
    v_and_b32 v119, 0xffff0000, v2
    v_lshlrev_b32 v3, 16, v105
    v_and_b32 v4, 0xffff0000, v105
    v_add_f32 v118, v118, v3
    v_add_f32 v119, v119, v4
    v_cvt_pk_bf16_f32 v57, v118, v119
    v_cvt_pk_bf16_f32 v2, v120, v121
    v_lshlrev_b32 v120, 16, v2
    v_and_b32 v121, 0xffff0000, v2
    v_mul_f32 v120, v120, v96
    v_mul_f32 v121, v121, v97
    v_cvt_pk_bf16_f32 v2, v120, v121
    v_lshlrev_b32 v120, 16, v2
    v_and_b32 v121, 0xffff0000, v2
    v_lshlrev_b32 v3, 16, v106
    v_and_b32 v4, 0xffff0000, v106
    v_add_f32 v120, v120, v3
    v_add_f32 v121, v121, v4
    v_cvt_pk_bf16_f32 v58, v120, v121
    v_cvt_pk_bf16_f32 v2, v122, v123
    v_lshlrev_b32 v122, 16, v2
    v_and_b32 v123, 0xffff0000, v2
    v_mul_f32 v122, v122, v98
    v_mul_f32 v123, v123, v99
    v_cvt_pk_bf16_f32 v2, v122, v123
    v_lshlrev_b32 v122, 16, v2
    v_and_b32 v123, 0xffff0000, v2
    v_lshlrev_b32 v3, 16, v107
    v_and_b32 v4, 0xffff0000, v107
    v_add_f32 v122, v122, v3
    v_add_f32 v123, v123, v4
    v_cvt_pk_bf16_f32 v59, v122, v123
    v_permlane32_swap_b32 v52, v54
    v_permlane32_swap_b32 v53, v55
    buffer_store_dwordx4 v[52:55], v31, s[24:27], s46 offen offset:0
    v_permlane32_swap_b32 v56, v58
    v_permlane32_swap_b32 v57, v59
    buffer_store_dwordx4 v[56:59], v31, s[24:27], s46 offen offset:32
oproj_kernel_end:
    s_endpgm
.section .rodata,"a"
.p2align 6
.amdhsa_kernel oproj_kernel
  .amdhsa_next_free_vgpr 124
  .amdhsa_next_free_sgpr 64
  .amdhsa_accum_offset 124
  .amdhsa_group_segment_fixed_size 0
  .amdhsa_kernarg_size 112
  .amdhsa_user_sgpr_count 2
  .amdhsa_user_sgpr_kernarg_segment_ptr 1
  .amdhsa_system_sgpr_workgroup_id_x 1
.end_amdhsa_kernel

.text
.globl ln2_kernel
.p2align 8
.type ln2_kernel,@function
ln2_kernel:
    s_cmp_ge_u32 s2, 512
    s_cbranch_scc1 ln2_kernel_end
    s_load_dwordx2 s[4:5], s[0:1], 0
    s_load_dwordx2 s[8:9], s[0:1], 104
    v_and_b32 v1, 63, v0
    v_lshrrev_b32 v2, 6, v0
    s_lshl_b32 s3, s2, 2
    v_add_u32 v2, s3, v2
    v_lshlrev_b32 v2, 11, v2
    v_lshl_add_u32 v2, v1, 4, v2
    v_lshlrev_b32 v3, 5, v1
    s_waitcnt lgkmcnt(0)
    s_add_u32 s12, s8, 0x2500000
    s_addc_u32 s13, s9, 0
    s_mov_b32 s14, 0x400000
    s_mov_b32 s15, 0x00020000
    s_add_u32 s16, s8, 0x2900000
    s_addc_u32 s17, s9, 0
    s_mov_b32 s18, 0x400000
    s_mov_b32 s19, 0x00020000
    s_mov_b32 s20, s8
    s_mov_b32 s21, s9
    s_mov_b32 s22, 0x6000
    s_mov_b32 s23, 0x00020000
    buffer_load_dwordx4 v[8:11], v2, s[12:15], 0 offen
    buffer_load_dwordx4 v[12:15], v2, s[12:15], 0 offen offset:1024
    s_mov_b32 s24, 16384
    s_mov_b32 s25, 12288
    buffer_load_dwordx4 v[32:35], v3, s[20:23], s24 offen
    buffer_load_dwordx4 v[36:39], v3, s[20:23], s24 offen offset:16
    buffer_load_dwordx4 v[40:43], v3, s[20:23], s24 offen offset:2048
    buffer_load_dwordx4 v[44:47], v3, s[20:23], s24 offen offset:2064
    buffer_load_dwordx4 v[48:51], v3, s[20:23], s25 offen
    buffer_load_dwordx4 v[52:55], v3, s[20:23], s25 offen offset:16
    buffer_load_dwordx4 v[56:59], v3, s[20:23], s25 offen offset:2048
    buffer_load_dwordx4 v[60:63], v3, s[20:23], s25 offen offset:2064
    s_waitcnt vmcnt(9)
    v_lshlrev_b32 v16, 16, v8
    v_and_b32 v17, 0xffff0000, v8
    v_lshlrev_b32 v18, 16, v9
    v_and_b32 v19, 0xffff0000, v9
    v_lshlrev_b32 v20, 16, v10
    v_and_b32 v21, 0xffff0000, v10
    v_lshlrev_b32 v22, 16, v11
    v_and_b32 v23, 0xffff0000, v11
    s_waitcnt vmcnt(8)
    v_lshlrev_b32 v24, 16, v12
    v_and_b32 v25, 0xffff0000, v12
    v_lshlrev_b32 v26, 16, v13
    v_and_b32 v27, 0xffff0000, v13
    v_lshlrev_b32 v28, 16, v14
    v_and_b32 v29, 0xffff0000, v14
    v_lshlrev_b32 v30, 16, v15
    v_and_b32 v31, 0xffff0000, v15
    v_add_f32 v4, v16, v17
    v_add_f32 v4, v4, v18
    v_add_f32 v4, v4, v19
    v_add_f32 v4, v4, v20
    v_add_f32 v4, v4, v21
    v_add_f32 v4, v4, v22
    v_add_f32 v4, v4, v23
    v_add_f32 v4, v4, v24
    v_add_f32 v4, v4, v25
    v_add_f32 v4, v4, v26
    v_add_f32 v4, v4, v27
    v_add_f32 v4, v4, v28
    v_add_f32 v4, v4, v29
    v_add_f32 v4, v4, v30
    v_add_f32 v4, v4, v31
    s_nop 1
    v_add_f32_dpp v5, v4, v4 quad_perm:[1,0,3,2] row_mask:0xf bank_mask:0xf
    s_nop 1
    v_add_f32_dpp v4, v5, v5 quad_perm:[2,3,0,1] row_mask:0xf bank_mask:0xf
    s_nop 1
    v_add_f32_dpp v5, v4, v4 row_half_mirror row_mask:0xf bank_mask:0xf
    s_nop 1
    v_add_f32_dpp v4, v5, v5 row_mirror row_mask:0xf bank_mask:0xf
    ds_swizzle_b32 v5, v4 offset:0x401F
    s_waitcnt lgkmcnt(0)
    v_add_f32 v4, v4, v5
    v_mov_b32 v5, v4
    s_nop 1
    v_permlane32_swap_b32 v4, v5
    v_add_f32 v4, v4, v5
    v_mul_f32 v4, 0x3a800000, v4
    v_sub_f32 v6, v16, v4
    v_mul_f32 v7, v6, v6
    v_sub_f32 v6, v17, v4
    v_fmac_f32 v7, v6, v6
    v_sub_f32 v6, v18, v4
    v_fmac_f32 v7, v6, v6
    v_sub_f32 v6, v19, v4
    v_fmac_f32 v7, v6, v6
    v_sub_f32 v6, v20, v4
    v_fmac_f32 v7, v6, v6
    v_sub_f32 v6, v21, v4
    v_fmac_f32 v7, v6, v6
    v_sub_f32 v6, v22, v4
    v_fmac_f32 v7, v6, v6
    v_sub_f32 v6, v23, v4
    v_fmac_f32 v7, v6, v6
    v_sub_f32 v6, v24, v4
    v_fmac_f32 v7, v6, v6
    v_sub_f32 v6, v25, v4
    v_fmac_f32 v7, v6, v6
    v_sub_f32 v6, v26, v4
    v_fmac_f32 v7, v6, v6
    v_sub_f32 v6, v27, v4
    v_fmac_f32 v7, v6, v6
    v_sub_f32 v6, v28, v4
    v_fmac_f32 v7, v6, v6
    v_sub_f32 v6, v29, v4
    v_fmac_f32 v7, v6, v6
    v_sub_f32 v6, v30, v4
    v_fmac_f32 v7, v6, v6
    v_sub_f32 v6, v31, v4
    v_fmac_f32 v7, v6, v6
    s_nop 1
    v_add_f32_dpp v5, v7, v7 quad_perm:[1,0,3,2] row_mask:0xf bank_mask:0xf
    s_nop 1
    v_add_f32_dpp v7, v5, v5 quad_perm:[2,3,0,1] row_mask:0xf bank_mask:0xf
    s_nop 1
    v_add_f32_dpp v5, v7, v7 row_half_mirror row_mask:0xf bank_mask:0xf
    s_nop 1
    v_add_f32_dpp v7, v5, v5 row_mirror row_mask:0xf bank_mask:0xf
    ds_swizzle_b32 v5, v7 offset:0x401F
    s_waitcnt lgkmcnt(0)
    v_add_f32 v7, v7, v5
    v_mov_b32 v5, v7
    s_nop 1
    v_permlane32_swap_b32 v7, v5
    v_add_f32 v7, v7, v5
    v_mul_f32 v7, 0x3a800000, v7
    v_cvt_pk_bf16_f32 v5, v4, v7
    v_lshlrev_b32 v4, 16, v5
    v_and_b32 v7, 0xffff0000, v5
    v_add_f32 v7, 0x3727c5ac, v7
    v_cvt_pk_bf16_f32 v5, v7, v7
    v_lshlrev_b32 v7, 16, v5
    v_and_b32 v6, 0xffff0000, v5
    v_sqrt_f32 v7, v7
    s_nop 0
    v_cvt_pk_bf16_f32 v5, v7, v7
    v_lshlrev_b32 v7, 16, v5
    v_and_b32 v6, 0xffff0000, v5
    v_rcp_f32 v7, v7
    v_sub_f32 v16, v16, v4
    v_sub_f32 v17, v17, v4
    v_cvt_pk_bf16_f32 v5, v16, v17
    v_lshlrev_b32 v16, 16, v5
    v_and_b32 v17, 0xffff0000, v5
    v_mul_f32 v16, v16, v7
    v_mul_f32 v17, v17, v7
    v_cvt_pk_bf16_f32 v5, v16, v17
    v_lshlrev_b32 v16, 16, v5
    v_and_b32 v17, 0xffff0000, v5
    s_waitcnt vmcnt(7)
    v_add_f32 v32, 1.0, v32
    v_add_f32 v33, 1.0, v33
    v_cvt_pk_bf16_f32 v5, v32, v33
    v_lshlrev_b32 v32, 16, v5
    v_and_b32 v33, 0xffff0000, v5
    v_mul_f32 v16, v16, v32
    v_mul_f32 v17, v17, v33
    v_cvt_pk_bf16_f32 v5, v16, v17
    v_lshlrev_b32 v16, 16, v5
    v_and_b32 v17, 0xffff0000, v5
    s_waitcnt vmcnt(3)
    v_add_f32 v16, v16, v48
    v_add_f32 v17, v17, v49
    v_cvt_pk_bf16_f32 v8, v16, v17
    v_sub_f32 v18, v18, v4
    v_sub_f32 v19, v19, v4
    v_cvt_pk_bf16_f32 v5, v18, v19
    v_lshlrev_b32 v18, 16, v5
    v_and_b32 v19, 0xffff0000, v5
    v_mul_f32 v18, v18, v7
    v_mul_f32 v19, v19, v7
    v_cvt_pk_bf16_f32 v5, v18, v19
    v_lshlrev_b32 v18, 16, v5
    v_and_b32 v19, 0xffff0000, v5
    v_add_f32 v34, 1.0, v34
    v_add_f32 v35, 1.0, v35
    v_cvt_pk_bf16_f32 v5, v34, v35
    v_lshlrev_b32 v34, 16, v5
    v_and_b32 v35, 0xffff0000, v5
    v_mul_f32 v18, v18, v34
    v_mul_f32 v19, v19, v35
    v_cvt_pk_bf16_f32 v5, v18, v19
    v_lshlrev_b32 v18, 16, v5
    v_and_b32 v19, 0xffff0000, v5
    v_add_f32 v18, v18, v50
    v_add_f32 v19, v19, v51
    v_cvt_pk_bf16_f32 v9, v18, v19
    v_sub_f32 v20, v20, v4
    v_sub_f32 v21, v21, v4
    v_cvt_pk_bf16_f32 v5, v20, v21
    v_lshlrev_b32 v20, 16, v5
    v_and_b32 v21, 0xffff0000, v5
    v_mul_f32 v20, v20, v7
    v_mul_f32 v21, v21, v7
    v_cvt_pk_bf16_f32 v5, v20, v21
    v_lshlrev_b32 v20, 16, v5
    v_and_b32 v21, 0xffff0000, v5
    v_add_f32 v36, 1.0, v36
    v_add_f32 v37, 1.0, v37
    v_cvt_pk_bf16_f32 v5, v36, v37
    v_lshlrev_b32 v36, 16, v5
    v_and_b32 v37, 0xffff0000, v5
    v_mul_f32 v20, v20, v36
    v_mul_f32 v21, v21, v37
    v_cvt_pk_bf16_f32 v5, v20, v21
    v_lshlrev_b32 v20, 16, v5
    v_and_b32 v21, 0xffff0000, v5
    s_waitcnt vmcnt(2)
    v_add_f32 v20, v20, v52
    v_add_f32 v21, v21, v53
    v_cvt_pk_bf16_f32 v10, v20, v21
    v_sub_f32 v22, v22, v4
    v_sub_f32 v23, v23, v4
    v_cvt_pk_bf16_f32 v5, v22, v23
    v_lshlrev_b32 v22, 16, v5
    v_and_b32 v23, 0xffff0000, v5
    v_mul_f32 v22, v22, v7
    v_mul_f32 v23, v23, v7
    v_cvt_pk_bf16_f32 v5, v22, v23
    v_lshlrev_b32 v22, 16, v5
    v_and_b32 v23, 0xffff0000, v5
    v_add_f32 v38, 1.0, v38
    v_add_f32 v39, 1.0, v39
    v_cvt_pk_bf16_f32 v5, v38, v39
    v_lshlrev_b32 v38, 16, v5
    v_and_b32 v39, 0xffff0000, v5
    v_mul_f32 v22, v22, v38
    v_mul_f32 v23, v23, v39
    v_cvt_pk_bf16_f32 v5, v22, v23
    v_lshlrev_b32 v22, 16, v5
    v_and_b32 v23, 0xffff0000, v5
    v_add_f32 v22, v22, v54
    v_add_f32 v23, v23, v55
    v_cvt_pk_bf16_f32 v11, v22, v23
    v_sub_f32 v24, v24, v4
    v_sub_f32 v25, v25, v4
    v_cvt_pk_bf16_f32 v5, v24, v25
    v_lshlrev_b32 v24, 16, v5
    v_and_b32 v25, 0xffff0000, v5
    v_mul_f32 v24, v24, v7
    v_mul_f32 v25, v25, v7
    v_cvt_pk_bf16_f32 v5, v24, v25
    v_lshlrev_b32 v24, 16, v5
    v_and_b32 v25, 0xffff0000, v5
    v_add_f32 v40, 1.0, v40
    v_add_f32 v41, 1.0, v41
    v_cvt_pk_bf16_f32 v5, v40, v41
    v_lshlrev_b32 v40, 16, v5
    v_and_b32 v41, 0xffff0000, v5
    v_mul_f32 v24, v24, v40
    v_mul_f32 v25, v25, v41
    v_cvt_pk_bf16_f32 v5, v24, v25
    v_lshlrev_b32 v24, 16, v5
    v_and_b32 v25, 0xffff0000, v5
    s_waitcnt vmcnt(1)
    v_add_f32 v24, v24, v56
    v_add_f32 v25, v25, v57
    v_cvt_pk_bf16_f32 v12, v24, v25
    v_sub_f32 v26, v26, v4
    v_sub_f32 v27, v27, v4
    v_cvt_pk_bf16_f32 v5, v26, v27
    v_lshlrev_b32 v26, 16, v5
    v_and_b32 v27, 0xffff0000, v5
    v_mul_f32 v26, v26, v7
    v_mul_f32 v27, v27, v7
    v_cvt_pk_bf16_f32 v5, v26, v27
    v_lshlrev_b32 v26, 16, v5
    v_and_b32 v27, 0xffff0000, v5
    v_add_f32 v42, 1.0, v42
    v_add_f32 v43, 1.0, v43
    v_cvt_pk_bf16_f32 v5, v42, v43
    v_lshlrev_b32 v42, 16, v5
    v_and_b32 v43, 0xffff0000, v5
    v_mul_f32 v26, v26, v42
    v_mul_f32 v27, v27, v43
    v_cvt_pk_bf16_f32 v5, v26, v27
    v_lshlrev_b32 v26, 16, v5
    v_and_b32 v27, 0xffff0000, v5
    v_add_f32 v26, v26, v58
    v_add_f32 v27, v27, v59
    v_cvt_pk_bf16_f32 v13, v26, v27
    v_sub_f32 v28, v28, v4
    v_sub_f32 v29, v29, v4
    v_cvt_pk_bf16_f32 v5, v28, v29
    v_lshlrev_b32 v28, 16, v5
    v_and_b32 v29, 0xffff0000, v5
    v_mul_f32 v28, v28, v7
    v_mul_f32 v29, v29, v7
    v_cvt_pk_bf16_f32 v5, v28, v29
    v_lshlrev_b32 v28, 16, v5
    v_and_b32 v29, 0xffff0000, v5
    v_add_f32 v44, 1.0, v44
    v_add_f32 v45, 1.0, v45
    v_cvt_pk_bf16_f32 v5, v44, v45
    v_lshlrev_b32 v44, 16, v5
    v_and_b32 v45, 0xffff0000, v5
    v_mul_f32 v28, v28, v44
    v_mul_f32 v29, v29, v45
    v_cvt_pk_bf16_f32 v5, v28, v29
    v_lshlrev_b32 v28, 16, v5
    v_and_b32 v29, 0xffff0000, v5
    s_waitcnt vmcnt(0)
    v_add_f32 v28, v28, v60
    v_add_f32 v29, v29, v61
    v_cvt_pk_bf16_f32 v14, v28, v29
    v_sub_f32 v30, v30, v4
    v_sub_f32 v31, v31, v4
    v_cvt_pk_bf16_f32 v5, v30, v31
    v_lshlrev_b32 v30, 16, v5
    v_and_b32 v31, 0xffff0000, v5
    v_mul_f32 v30, v30, v7
    v_mul_f32 v31, v31, v7
    v_cvt_pk_bf16_f32 v5, v30, v31
    v_lshlrev_b32 v30, 16, v5
    v_and_b32 v31, 0xffff0000, v5
    v_add_f32 v46, 1.0, v46
    v_add_f32 v47, 1.0, v47
    v_cvt_pk_bf16_f32 v5, v46, v47
    v_lshlrev_b32 v46, 16, v5
    v_and_b32 v47, 0xffff0000, v5
    v_mul_f32 v30, v30, v46
    v_mul_f32 v31, v31, v47
    v_cvt_pk_bf16_f32 v5, v30, v31
    v_lshlrev_b32 v30, 16, v5
    v_and_b32 v31, 0xffff0000, v5
    v_add_f32 v30, v30, v62
    v_add_f32 v31, v31, v63
    v_cvt_pk_bf16_f32 v15, v30, v31
    buffer_store_dwordx4 v[8:11], v2, s[16:19], 0 offen
    buffer_store_dwordx4 v[12:15], v2, s[16:19], 0 offen offset:1024
ln2_kernel_end:
    s_endpgm
.section .rodata,"a"
.p2align 6
.amdhsa_kernel ln2_kernel
  .amdhsa_next_free_vgpr 64
  .amdhsa_next_free_sgpr 40
  .amdhsa_accum_offset 64
  .amdhsa_group_segment_fixed_size 0
  .amdhsa_kernarg_size 112
  .amdhsa_user_sgpr_count 2
  .amdhsa_user_sgpr_kernarg_segment_ptr 1
  .amdhsa_system_sgpr_workgroup_id_x 1
.end_amdhsa_kernel

.text
.globl gateup_kernel
.p2align 8
.type gateup_kernel,@function
gateup_kernel:
    s_cmp_ge_u32 s2, 224
    s_cbranch_scc1 gateup_kernel_end
    s_load_dwordx2 s[4:5], s[0:1], 104
    s_load_dwordx2 s[6:7], s[0:1], 48
    s_load_dwordx2 s[8:9], s[0:1], 56
    s_load_dwordx2 s[10:11], s[0:1], 0
    s_load_dwordx2 s[52:53], s[0:1], 88
    v_and_b32 v1, 63, v0
    v_lshrrev_b32 v2, 6, v0
    s_nop 0
    v_readfirstlane_b32 s38, v2
    s_and_b32 s45, s2, 7
    s_lshr_b32 s46, s2, 3
    s_and_b32 s47, s45, 1
    s_lshr_b32 s48, s45, 1
    s_and_b32 s49, s46, 3
    s_lshr_b32 s50, s46, 2
    s_mul_i32 s47, s47, 4
    s_add_u32 s36, s47, s49
    s_mul_i32 s48, s48, 7
    s_add_u32 s37, s48, s50
    s_mul_i32 s36, s36, 256
    s_mul_i32 s37, s37, 128
    s_waitcnt lgkmcnt(0)
    s_add_u32 s12, s4, 0x2900000
    s_addc_u32 s13, s5, 0
    s_mov_b32 s14, 0x400000
    s_mov_b32 s15, 0x00020000
    s_mov_b32 s16, s6
    s_mov_b32 s17, s7
    s_mov_b32 s18, 0x700000
    s_mov_b32 s19, 0x00020000
    s_mov_b32 s20, s8
    s_mov_b32 s21, s9
    s_mov_b32 s22, 0x700000
    s_mov_b32 s23, 0x00020000
    s_add_u32 s24, s4, 0x2d00000
    s_addc_u32 s25, s5, 0
    s_mov_b32 s26, 0xe00000
    s_mov_b32 s27, 0x00020000
    s_mul_i32 s45, s38, 32
    s_mov_b32 s46, 2048
    v_lshrrev_b32 v2, 3, v1
    v_add_u32 v2, s45, v2
    v_and_b32 v3, 7, v1
    v_add_u32 v4, 0, v2
    v_bfe_u32 v5, v4, 1, 3
    v_xor_b32 v5, v5, v3
    v_add_u32 v4, s36, v4
    v_mul_lo_u32 v4, v4, s46
    v_lshl_add_u32 v8, v5, 4, v4
    v_add_u32 v4, 8, v2
    v_bfe_u32 v5, v4, 1, 3
    v_xor_b32 v5, v5, v3
    v_add_u32 v4, s36, v4
    v_mul_lo_u32 v4, v4, s46
    v_lshl_add_u32 v9, v5, 4, v4
    v_subrev_u32 v9, 1024, v9
    v_add_u32 v4, 16, v2
    v_bfe_u32 v5, v4, 1, 3
    v_xor_b32 v5, v5, v3
    v_add_u32 v4, s36, v4
    v_mul_lo_u32 v4, v4, s46
    v_lshl_add_u32 v10, v5, 4, v4
    v_subrev_u32 v10, 2048, v10
    v_add_u32 v4, 24, v2
    v_bfe_u32 v5, v4, 1, 3
    v_xor_b32 v5, v5, v3
    v_add_u32 v4, s36, v4
    v_mul_lo_u32 v4, v4, s46
    v_lshl_add_u32 v11, v5, 4, v4
    v_subrev_u32 v11, 3072, v11
    s_mul_i32 s45, s38, 8
    s_mov_b32 s46, 7168
    s_lshl_b32 s47, s37, 1
    v_lshrrev_b32 v2, 4, v1
    v_add_u32 v2, s45, v2
    v_and_b32 v3, 15, v1
    v_add_u32 v4, 0, v2
    v_lshrrev_b32 v5, 0, v4
    v_and_b32 v5, 3, v5
    v_lshlrev_b32 v5, 2, v5
    v_xor_b32 v5, v5, v3
    v_mul_lo_u32 v4, v4, s46
    v_lshl_add_u32 v12, v5, 4, v4
    v_add_u32 v12, s47, v12
    v_add_u32 v4, 4, v2
    v_lshrrev_b32 v5, 0, v4
    v_and_b32 v5, 3, v5
    v_lshlrev_b32 v5, 2, v5
    v_xor_b32 v5, v5, v3
    v_mul_lo_u32 v4, v4, s46
    v_lshl_add_u32 v13, v5, 4, v4
    v_add_u32 v13, s47, v13
    v_subrev_u32 v13, 1024, v13
    s_mul_i32 s42, s38, 4096
    s_mul_i32 s43, s38, 2048
    s_add_u32 s43, s43, 32768
    s_mul_i32 s44, s38, 2048
    s_add_u32 s44, s44, 49152
    s_mov_b32 s39, 0
    s_mov_b32 s40, 0
    s_add_u32 m0, s42, 0
    s_nop 0
    buffer_load_dwordx4 v8, s[12:15], s39 offen offset:0 lds
    buffer_load_dwordx4 v9, s[12:15], s39 offen offset:1024 lds
    buffer_load_dwordx4 v10, s[12:15], s39 offen offset:2048 lds
    buffer_load_dwordx4 v11, s[12:15], s39 offen offset:3072 lds
    s_add_u32 m0, s43, 0
    s_nop 0
    buffer_load_dwordx4 v12, s[16:19], s40 offen offset:0 lds
    buffer_load_dwordx4 v13, s[16:19], s40 offen offset:1024 lds
    s_add_u32 m0, s44, 0
    s_nop 0
    buffer_load_dwordx4 v12, s[20:23], s40 offen offset:0 lds
    buffer_load_dwordx4 v13, s[20:23], s40 offen offset:1024 lds
    s_add_u32 s39, s39, 128
    s_add_u32 s40, s40, 458752
    s_add_u32 m0, s42, 65536
    s_nop 0
    buffer_load_dwordx4 v8, s[12:15], s39 offen offset:0 lds
    buffer_load_dwordx4 v9, s[12:15], s39 offen offset:1024 lds
    buffer_load_dwordx4 v10, s[12:15], s39 offen offset:2048 lds
    buffer_load_dwordx4 v11, s[12:15], s39 offen offset:3072 lds
    s_add_u32 m0, s43, 65536
    s_nop 0
    buffer_load_dwordx4 v12, s[16:19], s40 offen offset:0 lds
    buffer_load_dwordx4 v13, s[16:19], s40 offen offset:1024 lds
    s_add_u32 m0, s44, 65536
    s_nop 0
    buffer_load_dwordx4 v12, s[20:23], s40 offen offset:0 lds
    buffer_load_dwordx4 v13, s[20:23], s40 offen offset:1024 lds
    s_add_u32 s39, s39, 128
    s_add_u32 s40, s40, 458752
    s_lshr_b32 s45, s38, 1
    s_and_b32 s46, s38, 1
    s_mul_i32 s47, s45, 64
    s_mul_i32 s48, s46, 64
    v_and_b32 v2, 31, v1
    v_add_u32 v2, s47, v2
    v_lshrrev_b32 v3, 5, v1
    v_bfe_u32 v4, v2, 1, 3
    v_xor_b32 v4, v4, v3
    v_lshlrev_b32 v4, 4, v4
    v_lshl_add_u32 v4, v2, 7, v4
    v_xor_b32 v14, 0, v4
    v_add_u32 v18, 65536, v14
    v_xor_b32 v15, 32, v4
    v_add_u32 v19, 65536, v15
    v_xor_b32 v16, 64, v4
    v_add_u32 v20, 65536, v16
    v_xor_b32 v17, 96, v4
    v_add_u32 v21, 65536, v17
    v_add_u32 v2, s36, v2
    s_add_u32 s48, s48, s37
    s_lshl_b32 s49, s48, 1
    s_mov_b32 s50, 7168
    v_mul_lo_u32 v26, v2, s50
    v_add_u32 v26, s49, v26
    v_lshl_add_u32 v26, v3, 4, v26
    s_mul_i32 s48, s46, 8
    v_bfe_u32 v2, v1, 2, 2
    v_and_b32 v3, 3, v1
    v_bfe_u32 v4, v1, 4, 1
    v_lshrrev_b32 v5, 5, v1
    v_lshl_add_u32 v5, v5, 3, v2
    v_lshlrev_b32 v5, 8, v5
    v_and_b32 v6, 1, v3
    v_lshl_add_u32 v5, v6, 3, v5
    v_add_u32 v5, 32768, v5
    v_lshrrev_b32 v3, 1, v3
    v_lshl_add_u32 v3, v4, 1, v3
    v_add_u32 v3, s48, v3
    v_lshrrev_b32 v2, 0, v2
    v_and_b32 v2, 3, v2
    v_lshlrev_b32 v2, 2, v2
    v_add_u32 v4, 0, v3
    v_xor_b32 v4, v4, v2
    v_lshl_add_u32 v22, v4, 4, v5
    v_add_u32 v24, 65536, v22
    v_add_u32 v4, 4, v3
    v_xor_b32 v4, v4, v2
    v_lshl_add_u32 v23, v4, 4, v5
    v_add_u32 v25, 65536, v23
    v_mov_b32 v112, 0
    v_mov_b32 v113, 0
    v_mov_b32 v114, 0
    v_mov_b32 v115, 0
    v_mov_b32 v116, 0
    v_mov_b32 v117, 0
    v_mov_b32 v118, 0
    v_mov_b32 v119, 0
    v_mov_b32 v120, 0
    v_mov_b32 v121, 0
    v_mov_b32 v122, 0
    v_mov_b32 v123, 0
    v_mov_b32 v124, 0
    v_mov_b32 v125, 0
    v_mov_b32 v126, 0
    v_mov_b32 v127, 0
    v_mov_b32 v128, 0
    v_mov_b32 v129, 0
    v_mov_b32 v130, 0
    v_mov_b32 v131, 0
    v_mov_b32 v132, 0
    v_mov_b32 v133, 0
    v_mov_b32 v134, 0
    v_mov_b32 v135, 0
    v_mov_b32 v136, 0
    v_mov_b32 v137, 0
    v_mov_b32 v138, 0
    v_mov_b32 v139, 0
    v_mov_b32 v140, 0
    v_mov_b32 v141, 0
    v_mov_b32 v142, 0
    v_mov_b32 v143, 0
    v_mov_b32 v144, 0
    v_mov_b32 v145, 0
    v_mov_b32 v146, 0
    v_mov_b32 v147, 0
    v_mov_b32 v148, 0
    v_mov_b32 v149, 0
    v_mov_b32 v150, 0
    v_mov_b32 v151, 0
    v_mov_b32 v152, 0
    v_mov_b32 v153, 0
    v_mov_b32 v154, 0
    v_mov_b32 v155, 0
    v_mov_b32 v156, 0
    v_mov_b32 v157, 0
    v_mov_b32 v158, 0
    v_mov_b32 v159, 0
    v_mov_b32 v160, 0
    v_mov_b32 v161, 0
    v_mov_b32 v162, 0
    v_mov_b32 v163, 0
    v_mov_b32 v164, 0
    v_mov_b32 v165, 0
    v_mov_b32 v166, 0
    v_mov_b32 v167, 0
    v_mov_b32 v168, 0
    v_mov_b32 v169, 0
    v_mov_b32 v170, 0
    v_mov_b32 v171, 0
    v_mov_b32 v172, 0
    v_mov_b32 v173, 0
    v_mov_b32 v174, 0
    v_mov_b32 v175, 0
    v_mov_b32 v176, 0
    v_mov_b32 v177, 0
    v_mov_b32 v178, 0
    v_mov_b32 v179, 0
    v_mov_b32 v180, 0
    v_mov_b32 v181, 0
    v_mov_b32 v182, 0
    v_mov_b32 v183, 0
    v_mov_b32 v184, 0
    v_mov_b32 v185, 0
    v_mov_b32 v186, 0
    v_mov_b32 v187, 0
    v_mov_b32 v188, 0
    v_mov_b32 v189, 0
    v_mov_b32 v190, 0
    v_mov_b32 v191, 0
    v_mov_b32 v192, 0
    v_mov_b32 v193, 0
    v_mov_b32 v194, 0
    v_mov_b32 v195, 0
    v_mov_b32 v196, 0
    v_mov_b32 v197, 0
    v_mov_b32 v198, 0
    v_mov_b32 v199, 0
    v_mov_b32 v200, 0
    v_mov_b32 v201, 0
    v_mov_b32 v202, 0
    v_mov_b32 v203, 0
    v_mov_b32 v204, 0
    v_mov_b32 v205, 0
    v_mov_b32 v206, 0
    v_mov_b32 v207, 0
    v_mov_b32 v208, 0
    v_mov_b32 v209, 0
    v_mov_b32 v210, 0
    v_mov_b32 v211, 0
    v_mov_b32 v212, 0
    v_mov_b32 v213, 0
    v_mov_b32 v214, 0
    v_mov_b32 v215, 0
    v_mov_b32 v216, 0
    v_mov_b32 v217, 0
    v_mov_b32 v218, 0
    v_mov_b32 v219, 0
    v_mov_b32 v220, 0
    v_mov_b32 v221, 0
    v_mov_b32 v222, 0
    v_mov_b32 v223, 0
    v_mov_b32 v224, 0
    v_mov_b32 v225, 0
    v_mov_b32 v226, 0
    v_mov_b32 v227, 0
    v_mov_b32 v228, 0
    v_mov_b32 v229, 0
    v_mov_b32 v230, 0
    v_mov_b32 v231, 0
    v_mov_b32 v232, 0
    v_mov_b32 v233, 0
    v_mov_b32 v234, 0
    v_mov_b32 v235, 0
    v_mov_b32 v236, 0
    v_mov_b32 v237, 0
    v_mov_b32 v238, 0
    v_mov_b32 v239, 0
    s_waitcnt vmcnt(8)
    s_barrier
    ds_read_b128 v[32:35], v14 offset:0
    ds_read_b128 v[36:39], v14 offset:4096
    ds_read_b64_tr_b16 v[48:49], v22 offset:0
    ds_read_b64_tr_b16 v[50:51], v22 offset:1024
    ds_read_b64_tr_b16 v[52:53], v23 offset:0
    ds_read_b64_tr_b16 v[54:55], v23 offset:1024
    ds_read_b64_tr_b16 v[56:57], v22 offset:16384
    ds_read_b64_tr_b16 v[58:59], v22 offset:17408
    ds_read_b64_tr_b16 v[60:61], v23 offset:16384
    ds_read_b64_tr_b16 v[62:63], v23 offset:17408
    s_mov_b32 s41, 7
gateup_kernel_loop:
    s_waitcnt lgkmcnt(6)
    v_mfma_f32_32x32x16_bf16 v[112:127], v[48:51], v[32:35], v[112:127]
    ds_read_b128 v[40:43], v15 offset:0
    ds_read_b128 v[44:47], v15 offset:4096
    s_waitcnt lgkmcnt(6)
    v_mfma_f32_32x32x16_bf16 v[128:143], v[52:55], v[32:35], v[128:143]
    ds_read_b64_tr_b16 v[64:65], v22 offset:4096
    ds_read_b64_tr_b16 v[66:67], v22 offset:5120
    s_waitcnt lgkmcnt(6)
    v_mfma_f32_32x32x16_bf16 v[144:159], v[56:59], v[32:35], v[144:159]
    ds_read_b64_tr_b16 v[68:69], v23 offset:4096
    ds_read_b64_tr_b16 v[70:71], v23 offset:5120
    s_waitcnt lgkmcnt(6)
    v_mfma_f32_32x32x16_bf16 v[160:175], v[60:63], v[32:35], v[160:175]
    ds_read_b64_tr_b16 v[72:73], v22 offset:20480
    ds_read_b64_tr_b16 v[74:75], v22 offset:21504
    v_mfma_f32_32x32x16_bf16 v[176:191], v[48:51], v[36:39], v[176:191]
    ds_read_b64_tr_b16 v[76:77], v23 offset:20480
    ds_read_b64_tr_b16 v[78:79], v23 offset:21504
    v_mfma_f32_32x32x16_bf16 v[192:207], v[52:55], v[36:39], v[192:207]
    v_mfma_f32_32x32x16_bf16 v[208:223], v[56:59], v[36:39], v[208:223]
    v_mfma_f32_32x32x16_bf16 v[224:239], v[60:63], v[36:39], v[224:239]
    s_waitcnt lgkmcnt(6)
    v_mfma_f32_32x32x16_bf16 v[112:127], v[64:67], v[40:43], v[112:127]
    ds_read_b128 v[32:35], v16 offset:0
    ds_read_b128 v[36:39], v16 offset:4096
    s_waitcnt lgkmcnt(6)
    v_mfma_f32_32x32x16_bf16 v[128:143], v[68:71], v[40:43], v[128:143]
    ds_read_b64_tr_b16 v[48:49], v22 offset:8192
    ds_read_b64_tr_b16 v[50:51], v22 offset:9216
    s_waitcnt lgkmcnt(6)
    v_mfma_f32_32x32x16_bf16 v[144:159], v[72:75], v[40:43], v[144:159]
    ds_read_b64_tr_b16 v[52:53], v23 offset:8192
    ds_read_b64_tr_b16 v[54:55], v23 offset:9216
    s_waitcnt lgkmcnt(6)
    v_mfma_f32_32x32x16_bf16 v[160:175], v[76:79], v[40:43], v[160:175]
    ds_read_b64_tr_b16 v[56:57], v22 offset:24576
    ds_read_b64_tr_b16 v[58:59], v22 offset:25600
    v_mfma_f32_32x32x16_bf16 v[176:191], v[64:67], v[44:47], v[176:191]
    ds_read_b64_tr_b16 v[60:61], v23 offset:24576
    ds_read_b64_tr_b16 v[62:63], v23 offset:25600
    v_mfma_f32_32x32x16_bf16 v[192:207], v[68:71], v[44:47], v[192:207]
    v_mfma_f32_32x32x16_bf16 v[208:223], v[72:75], v[44:47], v[208:223]
    v_mfma_f32_32x32x16_bf16 v[224:239], v[76:79], v[44:47], v[224:239]
    s_waitcnt lgkmcnt(6)
    v_mfma_f32_32x32x16_bf16 v[112:127], v[48:51], v[32:35], v[112:127]
    ds_read_b128 v[40:43], v17 offset:0
    ds_read_b128 v[44:47], v17 offset:4096
    s_waitcnt lgkmcnt(6)
    v_mfma_f32_32x32x16_bf16 v[128:143], v[52:55], v[32:35], v[128:143]
    ds_read_b64_tr_b16 v[64:65], v22 offset:12288
    ds_read_b64_tr_b16 v[66:67], v22 offset:13312
    s_waitcnt lgkmcnt(6)
    v_mfma_f32_32x32x16_bf16 v[144:159], v[56:59], v[32:35], v[144:159]
    ds_read_b64_tr_b16 v[68:69], v23 offset:12288
    ds_read_b64_tr_b16 v[70:71], v23 offset:13312
    s_waitcnt lgkmcnt(6)
    v_mfma_f32_32x32x16_bf16 v[160:175], v[60:63], v[32:35], v[160:175]
    ds_read_b64_tr_b16 v[72:73], v22 offset:28672
    ds_read_b64_tr_b16 v[74:75], v22 offset:29696
    v_mfma_f32_32x32x16_bf16 v[176:191], v[48:51], v[36:39], v[176:191]
    ds_read_b64_tr_b16 v[76:77], v23 offset:28672
    ds_read_b64_tr_b16 v[78:79], v23 offset:29696
    v_mfma_f32_32x32x16_bf16 v[192:207], v[52:55], v[36:39], v[192:207]
    v_mfma_f32_32x32x16_bf16 v[208:223], v[56:59], v[36:39], v[208:223]
    v_mfma_f32_32x32x16_bf16 v[224:239], v[60:63], v[36:39], v[224:239]
    s_waitcnt vmcnt(0) lgkmcnt(0)
    s_barrier
    v_mfma_f32_32x32x16_bf16 v[112:127], v[64:67], v[40:43], v[112:127]
    ds_read_b128 v[32:35], v18 offset:0
    ds_read_b128 v[36:39], v18 offset:4096
    ds_read_b64_tr_b16 v[48:49], v24 offset:0
    v_mfma_f32_32x32x16_bf16 v[128:143], v[68:71], v[40:43], v[128:143]
    ds_read_b64_tr_b16 v[50:51], v24 offset:1024
    ds_read_b64_tr_b16 v[52:53], v25 offset:0
    ds_read_b64_tr_b16 v[54:55], v25 offset:1024
    v_mfma_f32_32x32x16_bf16 v[144:159], v[72:75], v[40:43], v[144:159]
    ds_read_b64_tr_b16 v[56:57], v24 offset:16384
    ds_read_b64_tr_b16 v[58:59], v24 offset:17408
    ds_read_b64_tr_b16 v[60:61], v25 offset:16384
    v_mfma_f32_32x32x16_bf16 v[160:175], v[76:79], v[40:43], v[160:175]
    ds_read_b64_tr_b16 v[62:63], v25 offset:17408
    s_add_u32 m0, s42, 0
    s_nop 0
    buffer_load_dwordx4 v8, s[12:15], s39 offen offset:0 lds
    v_mfma_f32_32x32x16_bf16 v[176:191], v[64:67], v[44:47], v[176:191]
    buffer_load_dwordx4 v9, s[12:15], s39 offen offset:1024 lds
    buffer_load_dwordx4 v10, s[12:15], s39 offen offset:2048 lds
    buffer_load_dwordx4 v11, s[12:15], s39 offen offset:3072 lds
    v_mfma_f32_32x32x16_bf16 v[192:207], v[68:71], v[44:47], v[192:207]
    s_add_u32 m0, s43, 0
    s_nop 0
    buffer_load_dwordx4 v12, s[16:19], s40 offen offset:0 lds
    buffer_load_dwordx4 v13, s[16:19], s40 offen offset:1024 lds
    v_mfma_f32_32x32x16_bf16 v[208:223], v[72:75], v[44:47], v[208:223]
    s_add_u32 m0, s44, 0
    s_nop 0
    buffer_load_dwordx4 v12, s[20:23], s40 offen offset:0 lds
    buffer_load_dwordx4 v13, s[20:23], s40 offen offset:1024 lds
    v_mfma_f32_32x32x16_bf16 v[224:239], v[76:79], v[44:47], v[224:239]
    s_add_u32 s39, s39, 128
    s_add_u32 s40, s40, 458752
    s_waitcnt lgkmcnt(6)
    v_mfma_f32_32x32x16_bf16 v[112:127], v[48:51], v[32:35], v[112:127]
    ds_read_b128 v[40:43], v19 offset:0
    ds_read_b128 v[44:47], v19 offset:4096
    s_waitcnt lgkmcnt(6)
    v_mfma_f32_32x32x16_bf16 v[128:143], v[52:55], v[32:35], v[128:143]
    ds_read_b64_tr_b16 v[64:65], v24 offset:4096
    ds_read_b64_tr_b16 v[66:67], v24 offset:5120
    s_waitcnt lgkmcnt(6)
    v_mfma_f32_32x32x16_bf16 v[144:159], v[56:59], v[32:35], v[144:159]
    ds_read_b64_tr_b16 v[68:69], v25 offset:4096
    ds_read_b64_tr_b16 v[70:71], v25 offset:5120
    s_waitcnt lgkmcnt(6)
    v_mfma_f32_32x32x16_bf16 v[160:175], v[60:63], v[32:35], v[160:175]
    ds_read_b64_tr_b16 v[72:73], v24 offset:20480
    ds_read_b64_tr_b16 v[74:75], v24 offset:21504
    v_mfma_f32_32x32x16_bf16 v[176:191], v[48:51], v[36:39], v[176:191]
    ds_read_b64_tr_b16 v[76:77], v25 offset:20480
    ds_read_b64_tr_b16 v[78:79], v25 offset:21504
    v_mfma_f32_32x32x16_bf16 v[192:207], v[52:55], v[36:39], v[192:207]
    v_mfma_f32_32x32x16_bf16 v[208:223], v[56:59], v[36:39], v[208:223]
    v_mfma_f32_32x32x16_bf16 v[224:239], v[60:63], v[36:39], v[224:239]
    s_waitcnt lgkmcnt(6)
    v_mfma_f32_32x32x16_bf16 v[112:127], v[64:67], v[40:43], v[112:127]
    ds_read_b128 v[32:35], v20 offset:0
    ds_read_b128 v[36:39], v20 offset:4096
    s_waitcnt lgkmcnt(6)
    v_mfma_f32_32x32x16_bf16 v[128:143], v[68:71], v[40:43], v[128:143]
    ds_read_b64_tr_b16 v[48:49], v24 offset:8192
    ds_read_b64_tr_b16 v[50:51], v24 offset:9216
    s_waitcnt lgkmcnt(6)
    v_mfma_f32_32x32x16_bf16 v[144:159], v[72:75], v[40:43], v[144:159]
    ds_read_b64_tr_b16 v[52:53], v25 offset:8192
    ds_read_b64_tr_b16 v[54:55], v25 offset:9216
    s_waitcnt lgkmcnt(6)
    v_mfma_f32_32x32x16_bf16 v[160:175], v[76:79], v[40:43], v[160:175]
    ds_read_b64_tr_b16 v[56:57], v24 offset:24576
    ds_read_b64_tr_b16 v[58:59], v24 offset:25600
    v_mfma_f32_32x32x16_bf16 v[176:191], v[64:67], v[44:47], v[176:191]
    ds_read_b64_tr_b16 v[60:61], v25 offset:24576
    ds_read_b64_tr_b16 v[62:63], v25 offset:25600
    v_mfma_f32_32x32x16_bf16 v[192:207], v[68:71], v[44:47], v[192:207]
    v_mfma_f32_32x32x16_bf16 v[208:223], v[72:75], v[44:47], v[208:223]
    v_mfma_f32_32x32x16_bf16 v[224:239], v[76:79], v[44:47], v[224:239]
    s_waitcnt lgkmcnt(6)
    v_mfma_f32_32x32x16_bf16 v[112:127], v[48:51], v[32:35], v[112:127]
    ds_read_b128 v[40:43], v21 offset:0
    ds_read_b128 v[44:47], v21 offset:4096
    s_waitcnt lgkmcnt(6)
    v_mfma_f32_32x32x16_bf16 v[128:143], v[52:55], v[32:35], v[128:143]
    ds_read_b64_tr_b16 v[64:65], v24 offset:12288
    ds_read_b64_tr_b16 v[66:67], v24 offset:13312
    s_waitcnt lgkmcnt(6)
    v_mfma_f32_32x32x16_bf16 v[144:159], v[56:59], v[32:35], v[144:159]
    ds_read_b64_tr_b16 v[68:69], v25 offset:12288
    ds_read_b64_tr_b16 v[70:71], v25 offset:13312
    s_waitcnt lgkmcnt(6)
    v_mfma_f32_32x32x16_bf16 v[160:175], v[60:63], v[32:35], v[160:175]
    ds_read_b64_tr_b16 v[72:73], v24 offset:28672
    ds_read_b64_tr_b16 v[74:75], v24 offset:29696
    v_mfma_f32_32x32x16_bf16 v[176:191], v[48:51], v[36:39], v[176:191]
    ds_read_b64_tr_b16 v[76:77], v25 offset:28672
    ds_read_b64_tr_b16 v[78:79], v25 offset:29696
    v_mfma_f32_32x32x16_bf16 v[192:207], v[52:55], v[36:39], v[192:207]
    v_mfma_f32_32x32x16_bf16 v[208:223], v[56:59], v[36:39], v[208:223]
    v_mfma_f32_32x32x16_bf16 v[224:239], v[60:63], v[36:39], v[224:239]
    s_waitcnt vmcnt(0) lgkmcnt(0)
    s_barrier
    v_mfma_f32_32x32x16_bf16 v[112:127], v[64:67], v[40:43], v[112:127]
    ds_read_b128 v[32:35], v14 offset:0
    ds_read_b128 v[36:39], v14 offset:4096
    ds_read_b64_tr_b16 v[48:49], v22 offset:0
    v_mfma_f32_32x32x16_bf16 v[128:143], v[68:71], v[40:43], v[128:143]
    ds_read_b64_tr_b16 v[50:51], v22 offset:1024
    ds_read_b64_tr_b16 v[52:53], v23 offset:0
    ds_read_b64_tr_b16 v[54:55], v23 offset:1024
    v_mfma_f32_32x32x16_bf16 v[144:159], v[72:75], v[40:43], v[144:159]
    ds_read_b64_tr_b16 v[56:57], v22 offset:16384
    ds_read_b64_tr_b16 v[58:59], v22 offset:17408
    ds_read_b64_tr_b16 v[60:61], v23 offset:16384
    v_mfma_f32_32x32x16_bf16 v[160:175], v[76:79], v[40:43], v[160:175]
    ds_read_b64_tr_b16 v[62:63], v23 offset:17408
    s_add_u32 m0, s42, 65536
    s_nop 0
    buffer_load_dwordx4 v8, s[12:15], s39 offen offset:0 lds
    v_mfma_f32_32x32x16_bf16 v[176:191], v[64:67], v[44:47], v[176:191]
    buffer_load_dwordx4 v9, s[12:15], s39 offen offset:1024 lds
    buffer_load_dwordx4 v10, s[12:15], s39 offen offset:2048 lds
    buffer_load_dwordx4 v11, s[12:15], s39 offen offset:3072 lds
    v_mfma_f32_32x32x16_bf16 v[192:207], v[68:71], v[44:47], v[192:207]
    s_add_u32 m0, s43, 65536
    s_nop 0
    buffer_load_dwordx4 v12, s[16:19], s40 offen offset:0 lds
    buffer_load_dwordx4 v13, s[16:19], s40 offen offset:1024 lds
    v_mfma_f32_32x32x16_bf16 v[208:223], v[72:75], v[44:47], v[208:223]
    s_add_u32 m0, s44, 65536
    s_nop 0
    buffer_load_dwordx4 v12, s[20:23], s40 offen offset:0 lds
    buffer_load_dwordx4 v13, s[20:23], s40 offen offset:1024 lds
    v_mfma_f32_32x32x16_bf16 v[224:239], v[76:79], v[44:47], v[224:239]
    s_add_u32 s39, s39, 128
    s_add_u32 s40, s40, 458752
    s_sub_u32 s41, s41, 1
    s_cmp_lg_u32 s41, 0
    s_cbranch_scc1 gateup_kernel_loop
    s_waitcnt lgkmcnt(6)
    v_mfma_f32_32x32x16_bf16 v[112:127], v[48:51], v[32:35], v[112:127]
    ds_read_b128 v[40:43], v15 offset:0
    ds_read_b128 v[44:47], v15 offset:4096
    s_waitcnt lgkmcnt(6)
    v_mfma_f32_32x32x16_bf16 v[128:143], v[52:55], v[32:35], v[128:143]
    ds_read_b64_tr_b16 v[64:65], v22 offset:4096
    ds_read_b64_tr_b16 v[66:67], v22 offset:5120
    s_waitcnt lgkmcnt(6)
    v_mfma_f32_32x32x16_bf16 v[144:159], v[56:59], v[32:35], v[144:159]
    ds_read_b64_tr_b16 v[68:69], v23 offset:4096
    ds_read_b64_tr_b16 v[70:71], v23 offset:5120
    s_waitcnt lgkmcnt(6)
    v_mfma_f32_32x32x16_bf16 v[160:175], v[60:63], v[32:35], v[160:175]
    ds_read_b64_tr_b16 v[72:73], v22 offset:20480
    ds_read_b64_tr_b16 v[74:75], v22 offset:21504
    v_mfma_f32_32x32x16_bf16 v[176:191], v[48:51], v[36:39], v[176:191]
    ds_read_b64_tr_b16 v[76:77], v23 offset:20480
    ds_read_b64_tr_b16 v[78:79], v23 offset:21504
    v_mfma_f32_32x32x16_bf16 v[192:207], v[52:55], v[36:39], v[192:207]
    v_mfma_f32_32x32x16_bf16 v[208:223], v[56:59], v[36:39], v[208:223]
    v_mfma_f32_32x32x16_bf16 v[224:239], v[60:63], v[36:39], v[224:239]
    s_waitcnt lgkmcnt(6)
    v_mfma_f32_32x32x16_bf16 v[112:127], v[64:67], v[40:43], v[112:127]
    ds_read_b128 v[32:35], v16 offset:0
    ds_read_b128 v[36:39], v16 offset:4096
    s_waitcnt lgkmcnt(6)
    v_mfma_f32_32x32x16_bf16 v[128:143], v[68:71], v[40:43], v[128:143]
    ds_read_b64_tr_b16 v[48:49], v22 offset:8192
    ds_read_b64_tr_b16 v[50:51], v22 offset:9216
    s_waitcnt lgkmcnt(6)
    v_mfma_f32_32x32x16_bf16 v[144:159], v[72:75], v[40:43], v[144:159]
    ds_read_b64_tr_b16 v[52:53], v23 offset:8192
    ds_read_b64_tr_b16 v[54:55], v23 offset:9216
    s_waitcnt lgkmcnt(6)
    v_mfma_f32_32x32x16_bf16 v[160:175], v[76:79], v[40:43], v[160:175]
    ds_read_b64_tr_b16 v[56:57], v22 offset:24576
    ds_read_b64_tr_b16 v[58:59], v22 offset:25600
    v_mfma_f32_32x32x16_bf16 v[176:191], v[64:67], v[44:47], v[176:191]
    ds_read_b64_tr_b16 v[60:61], v23 offset:24576
    ds_read_b64_tr_b16 v[62:63], v23 offset:25600
    v_mfma_f32_32x32x16_bf16 v[192:207], v[68:71], v[44:47], v[192:207]
    v_mfma_f32_32x32x16_bf16 v[208:223], v[72:75], v[44:47], v[208:223]
    v_mfma_f32_32x32x16_bf16 v[224:239], v[76:79], v[44:47], v[224:239]
    s_waitcnt lgkmcnt(6)
    v_mfma_f32_32x32x16_bf16 v[112:127], v[48:51], v[32:35], v[112:127]
    ds_read_b128 v[40:43], v17 offset:0
    ds_read_b128 v[44:47], v17 offset:4096
    s_waitcnt lgkmcnt(6)
    v_mfma_f32_32x32x16_bf16 v[128:143], v[52:55], v[32:35], v[128:143]
    ds_read_b64_tr_b16 v[64:65], v22 offset:12288
    ds_read_b64_tr_b16 v[66:67], v22 offset:13312
    s_waitcnt lgkmcnt(6)
    v_mfma_f32_32x32x16_bf16 v[144:159], v[56:59], v[32:35], v[144:159]
    ds_read_b64_tr_b16 v[68:69], v23 offset:12288
    ds_read_b64_tr_b16 v[70:71], v23 offset:13312
    s_waitcnt lgkmcnt(6)
    v_mfma_f32_32x32x16_bf16 v[160:175], v[60:63], v[32:35], v[160:175]
    ds_read_b64_tr_b16 v[72:73], v22 offset:28672
    ds_read_b64_tr_b16 v[74:75], v22 offset:29696
    v_mfma_f32_32x32x16_bf16 v[176:191], v[48:51], v[36:39], v[176:191]
    ds_read_b64_tr_b16 v[76:77], v23 offset:28672
    ds_read_b64_tr_b16 v[78:79], v23 offset:29696
    v_mfma_f32_32x32x16_bf16 v[192:207], v[52:55], v[36:39], v[192:207]
    v_mfma_f32_32x32x16_bf16 v[208:223], v[56:59], v[36:39], v[208:223]
    v_mfma_f32_32x32x16_bf16 v[224:239], v[60:63], v[36:39], v[224:239]
    s_waitcnt vmcnt(0) lgkmcnt(0)
    s_barrier
    v_mfma_f32_32x32x16_bf16 v[112:127], v[64:67], v[40:43], v[112:127]
    ds_read_b128 v[32:35], v18 offset:0
    ds_read_b128 v[36:39], v18 offset:4096
    v_mfma_f32_32x32x16_bf16 v[128:143], v[68:71], v[40:43], v[128:143]
    ds_read_b64_tr_b16 v[48:49], v24 offset:0
    ds_read_b64_tr_b16 v[50:51], v24 offset:1024
    v_mfma_f32_32x32x16_bf16 v[144:159], v[72:75], v[40:43], v[144:159]
    ds_read_b64_tr_b16 v[52:53], v25 offset:0
    ds_read_b64_tr_b16 v[54:55], v25 offset:1024
    v_mfma_f32_32x32x16_bf16 v[160:175], v[76:79], v[40:43], v[160:175]
    ds_read_b64_tr_b16 v[56:57], v24 offset:16384
    ds_read_b64_tr_b16 v[58:59], v24 offset:17408
    v_mfma_f32_32x32x16_bf16 v[176:191], v[64:67], v[44:47], v[176:191]
    ds_read_b64_tr_b16 v[60:61], v25 offset:16384
    ds_read_b64_tr_b16 v[62:63], v25 offset:17408
    v_mfma_f32_32x32x16_bf16 v[192:207], v[68:71], v[44:47], v[192:207]
    v_mfma_f32_32x32x16_bf16 v[208:223], v[72:75], v[44:47], v[208:223]
    v_mfma_f32_32x32x16_bf16 v[224:239], v[76:79], v[44:47], v[224:239]
    s_waitcnt lgkmcnt(6)
    v_mfma_f32_32x32x16_bf16 v[112:127], v[48:51], v[32:35], v[112:127]
    ds_read_b128 v[40:43], v19 offset:0
    ds_read_b128 v[44:47], v19 offset:4096
    s_waitcnt lgkmcnt(6)
    v_mfma_f32_32x32x16_bf16 v[128:143], v[52:55], v[32:35], v[128:143]
    ds_read_b64_tr_b16 v[64:65], v24 offset:4096
    ds_read_b64_tr_b16 v[66:67], v24 offset:5120
    s_waitcnt lgkmcnt(6)
    v_mfma_f32_32x32x16_bf16 v[144:159], v[56:59], v[32:35], v[144:159]
    ds_read_b64_tr_b16 v[68:69], v25 offset:4096
    ds_read_b64_tr_b16 v[70:71], v25 offset:5120
    s_waitcnt lgkmcnt(6)
    v_mfma_f32_32x32x16_bf16 v[160:175], v[60:63], v[32:35], v[160:175]
    ds_read_b64_tr_b16 v[72:73], v24 offset:20480
    ds_read_b64_tr_b16 v[74:75], v24 offset:21504
    v_mfma_f32_32x32x16_bf16 v[176:191], v[48:51], v[36:39], v[176:191]
    ds_read_b64_tr_b16 v[76:77], v25 offset:20480
    ds_read_b64_tr_b16 v[78:79], v25 offset:21504
    v_mfma_f32_32x32x16_bf16 v[192:207], v[52:55], v[36:39], v[192:207]
    v_mfma_f32_32x32x16_bf16 v[208:223], v[56:59], v[36:39], v[208:223]
    v_mfma_f32_32x32x16_bf16 v[224:239], v[60:63], v[36:39], v[224:239]
    s_waitcnt lgkmcnt(6)
    v_mfma_f32_32x32x16_bf16 v[112:127], v[64:67], v[40:43], v[112:127]
    ds_read_b128 v[32:35], v20 offset:0
    ds_read_b128 v[36:39], v20 offset:4096
    s_waitcnt lgkmcnt(6)
    v_mfma_f32_32x32x16_bf16 v[128:143], v[68:71], v[40:43], v[128:143]
    ds_read_b64_tr_b16 v[48:49], v24 offset:8192
    ds_read_b64_tr_b16 v[50:51], v24 offset:9216
    s_waitcnt lgkmcnt(6)
    v_mfma_f32_32x32x16_bf16 v[144:159], v[72:75], v[40:43], v[144:159]
    ds_read_b64_tr_b16 v[52:53], v25 offset:8192
    ds_read_b64_tr_b16 v[54:55], v25 offset:9216
    s_waitcnt lgkmcnt(6)
    v_mfma_f32_32x32x16_bf16 v[160:175], v[76:79], v[40:43], v[160:175]
    ds_read_b64_tr_b16 v[56:57], v24 offset:24576
    ds_read_b64_tr_b16 v[58:59], v24 offset:25600
    v_mfma_f32_32x32x16_bf16 v[176:191], v[64:67], v[44:47], v[176:191]
    ds_read_b64_tr_b16 v[60:61], v25 offset:24576
    ds_read_b64_tr_b16 v[62:63], v25 offset:25600
    v_mfma_f32_32x32x16_bf16 v[192:207], v[68:71], v[44:47], v[192:207]
    v_mfma_f32_32x32x16_bf16 v[208:223], v[72:75], v[44:47], v[208:223]
    v_mfma_f32_32x32x16_bf16 v[224:239], v[76:79], v[44:47], v[224:239]
    s_waitcnt lgkmcnt(6)
    v_mfma_f32_32x32x16_bf16 v[112:127], v[48:51], v[32:35], v[112:127]
    ds_read_b128 v[40:43], v21 offset:0
    ds_read_b128 v[44:47], v21 offset:4096
    s_waitcnt lgkmcnt(6)
    v_mfma_f32_32x32x16_bf16 v[128:143], v[52:55], v[32:35], v[128:143]
    ds_read_b64_tr_b16 v[64:65], v24 offset:12288
    ds_read_b64_tr_b16 v[66:67], v24 offset:13312
    s_waitcnt lgkmcnt(6)
    v_mfma_f32_32x32x16_bf16 v[144:159], v[56:59], v[32:35], v[144:159]
    ds_read_b64_tr_b16 v[68:69], v25 offset:12288
    ds_read_b64_tr_b16 v[70:71], v25 offset:13312
    s_waitcnt lgkmcnt(6)
    v_mfma_f32_32x32x16_bf16 v[160:175], v[60:63], v[32:35], v[160:175]
    ds_read_b64_tr_b16 v[72:73], v24 offset:28672
    ds_read_b64_tr_b16 v[74:75], v24 offset:29696
    v_mfma_f32_32x32x16_bf16 v[176:191], v[48:51], v[36:39], v[176:191]
    ds_read_b64_tr_b16 v[76:77], v25 offset:28672
    ds_read_b64_tr_b16 v[78:79], v25 offset:29696
    v_mfma_f32_32x32x16_bf16 v[192:207], v[52:55], v[36:39], v[192:207]
    v_mfma_f32_32x32x16_bf16 v[208:223], v[56:59], v[36:39], v[208:223]
    v_mfma_f32_32x32x16_bf16 v[224:239], v[60:63], v[36:39], v[224:239]
    s_waitcnt lgkmcnt(6)
    v_mfma_f32_32x32x16_bf16 v[112:127], v[64:67], v[40:43], v[112:127]
    s_waitcnt lgkmcnt(4)
    v_mfma_f32_32x32x16_bf16 v[128:143], v[68:71], v[40:43], v[128:143]
    s_waitcnt lgkmcnt(2)
    v_mfma_f32_32x32x16_bf16 v[144:159], v[72:75], v[40:43], v[144:159]
    s_waitcnt lgkmcnt(0)
    v_mfma_f32_32x32x16_bf16 v[160:175], v[76:79], v[40:43], v[160:175]
    v_mfma_f32_32x32x16_bf16 v[176:191], v[64:67], v[44:47], v[176:191]
    v_mfma_f32_32x32x16_bf16 v[192:207], v[68:71], v[44:47], v[192:207]
    v_mfma_f32_32x32x16_bf16 v[208:223], v[72:75], v[44:47], v[208:223]
    v_mfma_f32_32x32x16_bf16 v[224:239], v[76:79], v[44:47], v[224:239]
    s_mov_b32 s46, 0
    s_mov_b32 s45, 229376
    s_mov_b32 s47, 65536
    v_cvt_pk_bf16_f32 v2, v112, v113
    v_lshlrev_b32 v112, 16, v2
    v_and_b32 v113, 0xffff0000, v2
    v_mul_f32 v3, 0xbfb8aa3b, v112
    v_mul_f32 v4, 0xbfb8aa3b, v113
    v_exp_f32 v3, v3
    v_exp_f32 v4, v4
    v_cvt_pk_bf16_f32 v2, v144, v145
    v_lshlrev_b32 v144, 16, v2
    v_and_b32 v145, 0xffff0000, v2
    v_add_f32 v3, 1.0, v3
    v_add_f32 v4, 1.0, v4
    v_rcp_f32 v3, v3
    v_rcp_f32 v4, v4
    v_mul_f32 v112, v112, v3
    v_mul_f32 v113, v113, v4
    v_cvt_pk_bf16_f32 v2, v112, v113
    v_lshlrev_b32 v112, 16, v2
    v_and_b32 v113, 0xffff0000, v2
    v_mul_f32 v112, v112, v144
    v_mul_f32 v113, v113, v145
    v_cvt_pk_bf16_f32 v80, v112, v113
    v_cvt_pk_bf16_f32 v2, v114, v115
    v_lshlrev_b32 v114, 16, v2
    v_and_b32 v115, 0xffff0000, v2
    v_mul_f32 v3, 0xbfb8aa3b, v114
    v_mul_f32 v4, 0xbfb8aa3b, v115
    v_exp_f32 v3, v3
    v_exp_f32 v4, v4
    v_cvt_pk_bf16_f32 v2, v146, v147
    v_lshlrev_b32 v146, 16, v2
    v_and_b32 v147, 0xffff0000, v2
    v_add_f32 v3, 1.0, v3
    v_add_f32 v4, 1.0, v4
    v_rcp_f32 v3, v3
    v_rcp_f32 v4, v4
    v_mul_f32 v114, v114, v3
    v_mul_f32 v115, v115, v4
    v_cvt_pk_bf16_f32 v2, v114, v115
    v_lshlrev_b32 v114, 16, v2
    v_and_b32 v115, 0xffff0000, v2
    v_mul_f32 v114, v114, v146
    v_mul_f32 v115, v115, v147
    v_cvt_pk_bf16_f32 v81, v114, v115
    v_cvt_pk_bf16_f32 v2, v116, v117
    v_lshlrev_b32 v116, 16, v2
    v_and_b32 v117, 0xffff0000, v2
    v_mul_f32 v3, 0xbfb8aa3b, v116
    v_mul_f32 v4, 0xbfb8aa3b, v117
    v_exp_f32 v3, v3
    v_exp_f32 v4, v4
    v_cvt_pk_bf16_f32 v2, v148, v149
    v_lshlrev_b32 v148, 16, v2
    v_and_b32 v149, 0xffff0000, v2
    v_add_f32 v3, 1.0, v3
    v_add_f32 v4, 1.0, v4
    v_rcp_f32 v3, v3
    v_rcp_f32 v4, v4
    v_mul_f32 v116, v116, v3
    v_mul_f32 v117, v117, v4
    v_cvt_pk_bf16_f32 v2, v116, v117
    v_lshlrev_b32 v116, 16, v2
    v_and_b32 v117, 0xffff0000, v2
    v_mul_f32 v116, v116, v148
    v_mul_f32 v117, v117, v149
    v_cvt_pk_bf16_f32 v82, v116, v117
    v_cvt_pk_bf16_f32 v2, v118, v119
    v_lshlrev_b32 v118, 16, v2
    v_and_b32 v119, 0xffff0000, v2
    v_mul_f32 v3, 0xbfb8aa3b, v118
    v_mul_f32 v4, 0xbfb8aa3b, v119
    v_exp_f32 v3, v3
    v_exp_f32 v4, v4
    v_cvt_pk_bf16_f32 v2, v150, v151
    v_lshlrev_b32 v150, 16, v2
    v_and_b32 v151, 0xffff0000, v2
    v_add_f32 v3, 1.0, v3
    v_add_f32 v4, 1.0, v4
    v_rcp_f32 v3, v3
    v_rcp_f32 v4, v4
    v_mul_f32 v118, v118, v3
    v_mul_f32 v119, v119, v4
    v_cvt_pk_bf16_f32 v2, v118, v119
    v_lshlrev_b32 v118, 16, v2
    v_and_b32 v119, 0xffff0000, v2
    v_mul_f32 v118, v118, v150
    v_mul_f32 v119, v119, v151
    v_cvt_pk_bf16_f32 v83, v118, v119
    v_cvt_pk_bf16_f32 v2, v120, v121
    v_lshlrev_b32 v120, 16, v2
    v_and_b32 v121, 0xffff0000, v2
    v_mul_f32 v3, 0xbfb8aa3b, v120
    v_mul_f32 v4, 0xbfb8aa3b, v121
    v_exp_f32 v3, v3
    v_exp_f32 v4, v4
    v_cvt_pk_bf16_f32 v2, v152, v153
    v_lshlrev_b32 v152, 16, v2
    v_and_b32 v153, 0xffff0000, v2
    v_add_f32 v3, 1.0, v3
    v_add_f32 v4, 1.0, v4
    v_rcp_f32 v3, v3
    v_rcp_f32 v4, v4
    v_mul_f32 v120, v120, v3
    v_mul_f32 v121, v121, v4
    v_cvt_pk_bf16_f32 v2, v120, v121
    v_lshlrev_b32 v120, 16, v2
    v_and_b32 v121, 0xffff0000, v2
    v_mul_f32 v120, v120, v152
    v_mul_f32 v121, v121, v153
    v_cvt_pk_bf16_f32 v84, v120, v121
    v_cvt_pk_bf16_f32 v2, v122, v123
    v_lshlrev_b32 v122, 16, v2
    v_and_b32 v123, 0xffff0000, v2
    v_mul_f32 v3, 0xbfb8aa3b, v122
    v_mul_f32 v4, 0xbfb8aa3b, v123
    v_exp_f32 v3, v3
    v_exp_f32 v4, v4
    v_cvt_pk_bf16_f32 v2, v154, v155
    v_lshlrev_b32 v154, 16, v2
    v_and_b32 v155, 0xffff0000, v2
    v_add_f32 v3, 1.0, v3
    v_add_f32 v4, 1.0, v4
    v_rcp_f32 v3, v3
    v_rcp_f32 v4, v4
    v_mul_f32 v122, v122, v3
    v_mul_f32 v123, v123, v4
    v_cvt_pk_bf16_f32 v2, v122, v123
    v_lshlrev_b32 v122, 16, v2
    v_and_b32 v123, 0xffff0000, v2
    v_mul_f32 v122, v122, v154
    v_mul_f32 v123, v123, v155
    v_cvt_pk_bf16_f32 v85, v122, v123
    v_cvt_pk_bf16_f32 v2, v124, v125
    v_lshlrev_b32 v124, 16, v2
    v_and_b32 v125, 0xffff0000, v2
    v_mul_f32 v3, 0xbfb8aa3b, v124
    v_mul_f32 v4, 0xbfb8aa3b, v125
    v_exp_f32 v3, v3
    v_exp_f32 v4, v4
    v_cvt_pk_bf16_f32 v2, v156, v157
    v_lshlrev_b32 v156, 16, v2
    v_and_b32 v157, 0xffff0000, v2
    v_add_f32 v3, 1.0, v3
    v_add_f32 v4, 1.0, v4
    v_rcp_f32 v3, v3
    v_rcp_f32 v4, v4
    v_mul_f32 v124, v124, v3
    v_mul_f32 v125, v125, v4
    v_cvt_pk_bf16_f32 v2, v124, v125
    v_lshlrev_b32 v124, 16, v2
    v_and_b32 v125, 0xffff0000, v2
    v_mul_f32 v124, v124, v156
    v_mul_f32 v125, v125, v157
    v_cvt_pk_bf16_f32 v86, v124, v125
    v_cvt_pk_bf16_f32 v2, v126, v127
    v_lshlrev_b32 v126, 16, v2
    v_and_b32 v127, 0xffff0000, v2
    v_mul_f32 v3, 0xbfb8aa3b, v126
    v_mul_f32 v4, 0xbfb8aa3b, v127
    v_exp_f32 v3, v3
    v_exp_f32 v4, v4
    v_cvt_pk_bf16_f32 v2, v158, v159
    v_lshlrev_b32 v158, 16, v2
    v_and_b32 v159, 0xffff0000, v2
    v_add_f32 v3, 1.0, v3
    v_add_f32 v4, 1.0, v4
    v_rcp_f32 v3, v3
    v_rcp_f32 v4, v4
    v_mul_f32 v126, v126, v3
    v_mul_f32 v127, v127, v4
    v_cvt_pk_bf16_f32 v2, v126, v127
    v_lshlrev_b32 v126, 16, v2
    v_and_b32 v127, 0xffff0000, v2
    v_mul_f32 v126, v126, v158
    v_mul_f32 v127, v127, v159
    v_cvt_pk_bf16_f32 v87, v126, v127
    v_permlane32_swap_b32 v80, v82
    v_permlane32_swap_b32 v81, v83
    buffer_store_dwordx4 v[80:83], v26, s[24:27], s46 offen offset:0
    v_permlane32_swap_b32 v84, v86
    v_permlane32_swap_b32 v85, v87
    buffer_store_dwordx4 v[84:87], v26, s[24:27], s46 offen offset:32
    v_cvt_pk_bf16_f32 v2, v128, v129
    v_lshlrev_b32 v128, 16, v2
    v_and_b32 v129, 0xffff0000, v2
    v_mul_f32 v3, 0xbfb8aa3b, v128
    v_mul_f32 v4, 0xbfb8aa3b, v129
    v_exp_f32 v3, v3
    v_exp_f32 v4, v4
    v_cvt_pk_bf16_f32 v2, v160, v161
    v_lshlrev_b32 v160, 16, v2
    v_and_b32 v161, 0xffff0000, v2
    v_add_f32 v3, 1.0, v3
    v_add_f32 v4, 1.0, v4
    v_rcp_f32 v3, v3
    v_rcp_f32 v4, v4
    v_mul_f32 v128, v128, v3
    v_mul_f32 v129, v129, v4
    v_cvt_pk_bf16_f32 v2, v128, v129
    v_lshlrev_b32 v128, 16, v2
    v_and_b32 v129, 0xffff0000, v2
    v_mul_f32 v128, v128, v160
    v_mul_f32 v129, v129, v161
    v_cvt_pk_bf16_f32 v88, v128, v129
    v_cvt_pk_bf16_f32 v2, v130, v131
    v_lshlrev_b32 v130, 16, v2
    v_and_b32 v131, 0xffff0000, v2
    v_mul_f32 v3, 0xbfb8aa3b, v130
    v_mul_f32 v4, 0xbfb8aa3b, v131
    v_exp_f32 v3, v3
    v_exp_f32 v4, v4
    v_cvt_pk_bf16_f32 v2, v162, v163
    v_lshlrev_b32 v162, 16, v2
    v_and_b32 v163, 0xffff0000, v2
    v_add_f32 v3, 1.0, v3
    v_add_f32 v4, 1.0, v4
    v_rcp_f32 v3, v3
    v_rcp_f32 v4, v4
    v_mul_f32 v130, v130, v3
    v_mul_f32 v131, v131, v4
    v_cvt_pk_bf16_f32 v2, v130, v131
    v_lshlrev_b32 v130, 16, v2
    v_and_b32 v131, 0xffff0000, v2
    v_mul_f32 v130, v130, v162
    v_mul_f32 v131, v131, v163
    v_cvt_pk_bf16_f32 v89, v130, v131
    v_cvt_pk_bf16_f32 v2, v132, v133
    v_lshlrev_b32 v132, 16, v2
    v_and_b32 v133, 0xffff0000, v2
    v_mul_f32 v3, 0xbfb8aa3b, v132
    v_mul_f32 v4, 0xbfb8aa3b, v133
    v_exp_f32 v3, v3
    v_exp_f32 v4, v4
    v_cvt_pk_bf16_f32 v2, v164, v165
    v_lshlrev_b32 v164, 16, v2
    v_and_b32 v165, 0xffff0000, v2
    v_add_f32 v3, 1.0, v3
    v_add_f32 v4, 1.0, v4
    v_rcp_f32 v3, v3
    v_rcp_f32 v4, v4
    v_mul_f32 v132, v132, v3
    v_mul_f32 v133, v133, v4
    v_cvt_pk_bf16_f32 v2, v132, v133
    v_lshlrev_b32 v132, 16, v2
    v_and_b32 v133, 0xffff0000, v2
    v_mul_f32 v132, v132, v164
    v_mul_f32 v133, v133, v165
    v_cvt_pk_bf16_f32 v90, v132, v133
    v_cvt_pk_bf16_f32 v2, v134, v135
    v_lshlrev_b32 v134, 16, v2
    v_and_b32 v135, 0xffff0000, v2
    v_mul_f32 v3, 0xbfb8aa3b, v134
    v_mul_f32 v4, 0xbfb8aa3b, v135
    v_exp_f32 v3, v3
    v_exp_f32 v4, v4
    v_cvt_pk_bf16_f32 v2, v166, v167
    v_lshlrev_b32 v166, 16, v2
    v_and_b32 v167, 0xffff0000, v2
    v_add_f32 v3, 1.0, v3
    v_add_f32 v4, 1.0, v4
    v_rcp_f32 v3, v3
    v_rcp_f32 v4, v4
    v_mul_f32 v134, v134, v3
    v_mul_f32 v135, v135, v4
    v_cvt_pk_bf16_f32 v2, v134, v135
    v_lshlrev_b32 v134, 16, v2
    v_and_b32 v135, 0xffff0000, v2
    v_mul_f32 v134, v134, v166
    v_mul_f32 v135, v135, v167
    v_cvt_pk_bf16_f32 v91, v134, v135
    v_cvt_pk_bf16_f32 v2, v136, v137
    v_lshlrev_b32 v136, 16, v2
    v_and_b32 v137, 0xffff0000, v2
    v_mul_f32 v3, 0xbfb8aa3b, v136
    v_mul_f32 v4, 0xbfb8aa3b, v137
    v_exp_f32 v3, v3
    v_exp_f32 v4, v4
    v_cvt_pk_bf16_f32 v2, v168, v169
    v_lshlrev_b32 v168, 16, v2
    v_and_b32 v169, 0xffff0000, v2
    v_add_f32 v3, 1.0, v3
    v_add_f32 v4, 1.0, v4
    v_rcp_f32 v3, v3
    v_rcp_f32 v4, v4
    v_mul_f32 v136, v136, v3
    v_mul_f32 v137, v137, v4
    v_cvt_pk_bf16_f32 v2, v136, v137
    v_lshlrev_b32 v136, 16, v2
    v_and_b32 v137, 0xffff0000, v2
    v_mul_f32 v136, v136, v168
    v_mul_f32 v137, v137, v169
    v_cvt_pk_bf16_f32 v92, v136, v137
    v_cvt_pk_bf16_f32 v2, v138, v139
    v_lshlrev_b32 v138, 16, v2
    v_and_b32 v139, 0xffff0000, v2
    v_mul_f32 v3, 0xbfb8aa3b, v138
    v_mul_f32 v4, 0xbfb8aa3b, v139
    v_exp_f32 v3, v3
    v_exp_f32 v4, v4
    v_cvt_pk_bf16_f32 v2, v170, v171
    v_lshlrev_b32 v170, 16, v2
    v_and_b32 v171, 0xffff0000, v2
    v_add_f32 v3, 1.0, v3
    v_add_f32 v4, 1.0, v4
    v_rcp_f32 v3, v3
    v_rcp_f32 v4, v4
    v_mul_f32 v138, v138, v3
    v_mul_f32 v139, v139, v4
    v_cvt_pk_bf16_f32 v2, v138, v139
    v_lshlrev_b32 v138, 16, v2
    v_and_b32 v139, 0xffff0000, v2
    v_mul_f32 v138, v138, v170
    v_mul_f32 v139, v139, v171
    v_cvt_pk_bf16_f32 v93, v138, v139
    v_cvt_pk_bf16_f32 v2, v140, v141
    v_lshlrev_b32 v140, 16, v2
    v_and_b32 v141, 0xffff0000, v2
    v_mul_f32 v3, 0xbfb8aa3b, v140
    v_mul_f32 v4, 0xbfb8aa3b, v141
    v_exp_f32 v3, v3
    v_exp_f32 v4, v4
    v_cvt_pk_bf16_f32 v2, v172, v173
    v_lshlrev_b32 v172, 16, v2
    v_and_b32 v173, 0xffff0000, v2
    v_add_f32 v3, 1.0, v3
    v_add_f32 v4, 1.0, v4
    v_rcp_f32 v3, v3
    v_rcp_f32 v4, v4
    v_mul_f32 v140, v140, v3
    v_mul_f32 v141, v141, v4
    v_cvt_pk_bf16_f32 v2, v140, v141
    v_lshlrev_b32 v140, 16, v2
    v_and_b32 v141, 0xffff0000, v2
    v_mul_f32 v140, v140, v172
    v_mul_f32 v141, v141, v173
    v_cvt_pk_bf16_f32 v94, v140, v141
    v_cvt_pk_bf16_f32 v2, v142, v143
    v_lshlrev_b32 v142, 16, v2
    v_and_b32 v143, 0xffff0000, v2
    v_mul_f32 v3, 0xbfb8aa3b, v142
    v_mul_f32 v4, 0xbfb8aa3b, v143
    v_exp_f32 v3, v3
    v_exp_f32 v4, v4
    v_cvt_pk_bf16_f32 v2, v174, v175
    v_lshlrev_b32 v174, 16, v2
    v_and_b32 v175, 0xffff0000, v2
    v_add_f32 v3, 1.0, v3
    v_add_f32 v4, 1.0, v4
    v_rcp_f32 v3, v3
    v_rcp_f32 v4, v4
    v_mul_f32 v142, v142, v3
    v_mul_f32 v143, v143, v4
    v_cvt_pk_bf16_f32 v2, v142, v143
    v_lshlrev_b32 v142, 16, v2
    v_and_b32 v143, 0xffff0000, v2
    v_mul_f32 v142, v142, v174
    v_mul_f32 v143, v143, v175
    v_cvt_pk_bf16_f32 v95, v142, v143
    v_permlane32_swap_b32 v88, v90
    v_permlane32_swap_b32 v89, v91
    buffer_store_dwordx4 v[88:91], v26, s[24:27], s46 offen offset:64
    v_permlane32_swap_b32 v92, v94
    v_permlane32_swap_b32 v93, v95
    buffer_store_dwordx4 v[92:95], v26, s[24:27], s46 offen offset:96
    v_cvt_pk_bf16_f32 v2, v176, v177
    v_lshlrev_b32 v176, 16, v2
    v_and_b32 v177, 0xffff0000, v2
    v_mul_f32 v3, 0xbfb8aa3b, v176
    v_mul_f32 v4, 0xbfb8aa3b, v177
    v_exp_f32 v3, v3
    v_exp_f32 v4, v4
    v_cvt_pk_bf16_f32 v2, v208, v209
    v_lshlrev_b32 v208, 16, v2
    v_and_b32 v209, 0xffff0000, v2
    v_add_f32 v3, 1.0, v3
    v_add_f32 v4, 1.0, v4
    v_rcp_f32 v3, v3
    v_rcp_f32 v4, v4
    v_mul_f32 v176, v176, v3
    v_mul_f32 v177, v177, v4
    v_cvt_pk_bf16_f32 v2, v176, v177
    v_lshlrev_b32 v176, 16, v2
    v_and_b32 v177, 0xffff0000, v2
    v_mul_f32 v176, v176, v208
    v_mul_f32 v177, v177, v209
    v_cvt_pk_bf16_f32 v96, v176, v177
    v_cvt_pk_bf16_f32 v2, v178, v179
    v_lshlrev_b32 v178, 16, v2
    v_and_b32 v179, 0xffff0000, v2
    v_mul_f32 v3, 0xbfb8aa3b, v178
    v_mul_f32 v4, 0xbfb8aa3b, v179
    v_exp_f32 v3, v3
    v_exp_f32 v4, v4
    v_cvt_pk_bf16_f32 v2, v210, v211
    v_lshlrev_b32 v210, 16, v2
    v_and_b32 v211, 0xffff0000, v2
    v_add_f32 v3, 1.0, v3
    v_add_f32 v4, 1.0, v4
    v_rcp_f32 v3, v3
    v_rcp_f32 v4, v4
    v_mul_f32 v178, v178, v3
    v_mul_f32 v179, v179, v4
    v_cvt_pk_bf16_f32 v2, v178, v179
    v_lshlrev_b32 v178, 16, v2
    v_and_b32 v179, 0xffff0000, v2
    v_mul_f32 v178, v178, v210
    v_mul_f32 v179, v179, v211
    v_cvt_pk_bf16_f32 v97, v178, v179
    v_cvt_pk_bf16_f32 v2, v180, v181
    v_lshlrev_b32 v180, 16, v2
    v_and_b32 v181, 0xffff0000, v2
    v_mul_f32 v3, 0xbfb8aa3b, v180
    v_mul_f32 v4, 0xbfb8aa3b, v181
    v_exp_f32 v3, v3
    v_exp_f32 v4, v4
    v_cvt_pk_bf16_f32 v2, v212, v213
    v_lshlrev_b32 v212, 16, v2
    v_and_b32 v213, 0xffff0000, v2
    v_add_f32 v3, 1.0, v3
    v_add_f32 v4, 1.0, v4
    v_rcp_f32 v3, v3
    v_rcp_f32 v4, v4
    v_mul_f32 v180, v180, v3
    v_mul_f32 v181, v181, v4
    v_cvt_pk_bf16_f32 v2, v180, v181
    v_lshlrev_b32 v180, 16, v2
    v_and_b32 v181, 0xffff0000, v2
    v_mul_f32 v180, v180, v212
    v_mul_f32 v181, v181, v213
    v_cvt_pk_bf16_f32 v98, v180, v181
    v_cvt_pk_bf16_f32 v2, v182, v183
    v_lshlrev_b32 v182, 16, v2
    v_and_b32 v183, 0xffff0000, v2
    v_mul_f32 v3, 0xbfb8aa3b, v182
    v_mul_f32 v4, 0xbfb8aa3b, v183
    v_exp_f32 v3, v3
    v_exp_f32 v4, v4
    v_cvt_pk_bf16_f32 v2, v214, v215
    v_lshlrev_b32 v214, 16, v2
    v_and_b32 v215, 0xffff0000, v2
    v_add_f32 v3, 1.0, v3
    v_add_f32 v4, 1.0, v4
    v_rcp_f32 v3, v3
    v_rcp_f32 v4, v4
    v_mul_f32 v182, v182, v3
    v_mul_f32 v183, v183, v4
    v_cvt_pk_bf16_f32 v2, v182, v183
    v_lshlrev_b32 v182, 16, v2
    v_and_b32 v183, 0xffff0000, v2
    v_mul_f32 v182, v182, v214
    v_mul_f32 v183, v183, v215
    v_cvt_pk_bf16_f32 v99, v182, v183
    v_cvt_pk_bf16_f32 v2, v184, v185
    v_lshlrev_b32 v184, 16, v2
    v_and_b32 v185, 0xffff0000, v2
    v_mul_f32 v3, 0xbfb8aa3b, v184
    v_mul_f32 v4, 0xbfb8aa3b, v185
    v_exp_f32 v3, v3
    v_exp_f32 v4, v4
    v_cvt_pk_bf16_f32 v2, v216, v217
    v_lshlrev_b32 v216, 16, v2
    v_and_b32 v217, 0xffff0000, v2
    v_add_f32 v3, 1.0, v3
    v_add_f32 v4, 1.0, v4
    v_rcp_f32 v3, v3
    v_rcp_f32 v4, v4
    v_mul_f32 v184, v184, v3
    v_mul_f32 v185, v185, v4
    v_cvt_pk_bf16_f32 v2, v184, v185
    v_lshlrev_b32 v184, 16, v2
    v_and_b32 v185, 0xffff0000, v2
    v_mul_f32 v184, v184, v216
    v_mul_f32 v185, v185, v217
    v_cvt_pk_bf16_f32 v100, v184, v185
    v_cvt_pk_bf16_f32 v2, v186, v187
    v_lshlrev_b32 v186, 16, v2
    v_and_b32 v187, 0xffff0000, v2
    v_mul_f32 v3, 0xbfb8aa3b, v186
    v_mul_f32 v4, 0xbfb8aa3b, v187
    v_exp_f32 v3, v3
    v_exp_f32 v4, v4
    v_cvt_pk_bf16_f32 v2, v218, v219
    v_lshlrev_b32 v218, 16, v2
    v_and_b32 v219, 0xffff0000, v2
    v_add_f32 v3, 1.0, v3
    v_add_f32 v4, 1.0, v4
    v_rcp_f32 v3, v3
    v_rcp_f32 v4, v4
    v_mul_f32 v186, v186, v3
    v_mul_f32 v187, v187, v4
    v_cvt_pk_bf16_f32 v2, v186, v187
    v_lshlrev_b32 v186, 16, v2
    v_and_b32 v187, 0xffff0000, v2
    v_mul_f32 v186, v186, v218
    v_mul_f32 v187, v187, v219
    v_cvt_pk_bf16_f32 v101, v186, v187
    v_cvt_pk_bf16_f32 v2, v188, v189
    v_lshlrev_b32 v188, 16, v2
    v_and_b32 v189, 0xffff0000, v2
    v_mul_f32 v3, 0xbfb8aa3b, v188
    v_mul_f32 v4, 0xbfb8aa3b, v189
    v_exp_f32 v3, v3
    v_exp_f32 v4, v4
    v_cvt_pk_bf16_f32 v2, v220, v221
    v_lshlrev_b32 v220, 16, v2
    v_and_b32 v221, 0xffff0000, v2
    v_add_f32 v3, 1.0, v3
    v_add_f32 v4, 1.0, v4
    v_rcp_f32 v3, v3
    v_rcp_f32 v4, v4
    v_mul_f32 v188, v188, v3
    v_mul_f32 v189, v189, v4
    v_cvt_pk_bf16_f32 v2, v188, v189
    v_lshlrev_b32 v188, 16, v2
    v_and_b32 v189, 0xffff0000, v2
    v_mul_f32 v188, v188, v220
    v_mul_f32 v189, v189, v221
    v_cvt_pk_bf16_f32 v102, v188, v189
    v_cvt_pk_bf16_f32 v2, v190, v191
    v_lshlrev_b32 v190, 16, v2
    v_and_b32 v191, 0xffff0000, v2
    v_mul_f32 v3, 0xbfb8aa3b, v190
    v_mul_f32 v4, 0xbfb8aa3b, v191
    v_exp_f32 v3, v3
    v_exp_f32 v4, v4
    v_cvt_pk_bf16_f32 v2, v222, v223
    v_lshlrev_b32 v222, 16, v2
    v_and_b32 v223, 0xffff0000, v2
    v_add_f32 v3, 1.0, v3
    v_add_f32 v4, 1.0, v4
    v_rcp_f32 v3, v3
    v_rcp_f32 v4, v4
    v_mul_f32 v190, v190, v3
    v_mul_f32 v191, v191, v4
    v_cvt_pk_bf16_f32 v2, v190, v191
    v_lshlrev_b32 v190, 16, v2
    v_and_b32 v191, 0xffff0000, v2
    v_mul_f32 v190, v190, v222
    v_mul_f32 v191, v191, v223
    v_cvt_pk_bf16_f32 v103, v190, v191
    v_permlane32_swap_b32 v96, v98
    v_permlane32_swap_b32 v97, v99
    buffer_store_dwordx4 v[96:99], v26, s[24:27], s45 offen offset:0
    v_permlane32_swap_b32 v100, v102
    v_permlane32_swap_b32 v101, v103
    buffer_store_dwordx4 v[100:103], v26, s[24:27], s45 offen offset:32
    v_cvt_pk_bf16_f32 v2, v192, v193
    v_lshlrev_b32 v192, 16, v2
    v_and_b32 v193, 0xffff0000, v2
    v_mul_f32 v3, 0xbfb8aa3b, v192
    v_mul_f32 v4, 0xbfb8aa3b, v193
    v_exp_f32 v3, v3
    v_exp_f32 v4, v4
    v_cvt_pk_bf16_f32 v2, v224, v225
    v_lshlrev_b32 v224, 16, v2
    v_and_b32 v225, 0xffff0000, v2
    v_add_f32 v3, 1.0, v3
    v_add_f32 v4, 1.0, v4
    v_rcp_f32 v3, v3
    v_rcp_f32 v4, v4
    v_mul_f32 v192, v192, v3
    v_mul_f32 v193, v193, v4
    v_cvt_pk_bf16_f32 v2, v192, v193
    v_lshlrev_b32 v192, 16, v2
    v_and_b32 v193, 0xffff0000, v2
    v_mul_f32 v192, v192, v224
    v_mul_f32 v193, v193, v225
    v_cvt_pk_bf16_f32 v104, v192, v193
    v_cvt_pk_bf16_f32 v2, v194, v195
    v_lshlrev_b32 v194, 16, v2
    v_and_b32 v195, 0xffff0000, v2
    v_mul_f32 v3, 0xbfb8aa3b, v194
    v_mul_f32 v4, 0xbfb8aa3b, v195
    v_exp_f32 v3, v3
    v_exp_f32 v4, v4
    v_cvt_pk_bf16_f32 v2, v226, v227
    v_lshlrev_b32 v226, 16, v2
    v_and_b32 v227, 0xffff0000, v2
    v_add_f32 v3, 1.0, v3
    v_add_f32 v4, 1.0, v4
    v_rcp_f32 v3, v3
    v_rcp_f32 v4, v4
    v_mul_f32 v194, v194, v3
    v_mul_f32 v195, v195, v4
    v_cvt_pk_bf16_f32 v2, v194, v195
    v_lshlrev_b32 v194, 16, v2
    v_and_b32 v195, 0xffff0000, v2
    v_mul_f32 v194, v194, v226
    v_mul_f32 v195, v195, v227
    v_cvt_pk_bf16_f32 v105, v194, v195
    v_cvt_pk_bf16_f32 v2, v196, v197
    v_lshlrev_b32 v196, 16, v2
    v_and_b32 v197, 0xffff0000, v2
    v_mul_f32 v3, 0xbfb8aa3b, v196
    v_mul_f32 v4, 0xbfb8aa3b, v197
    v_exp_f32 v3, v3
    v_exp_f32 v4, v4
    v_cvt_pk_bf16_f32 v2, v228, v229
    v_lshlrev_b32 v228, 16, v2
    v_and_b32 v229, 0xffff0000, v2
    v_add_f32 v3, 1.0, v3
    v_add_f32 v4, 1.0, v4
    v_rcp_f32 v3, v3
    v_rcp_f32 v4, v4
    v_mul_f32 v196, v196, v3
    v_mul_f32 v197, v197, v4
    v_cvt_pk_bf16_f32 v2, v196, v197
    v_lshlrev_b32 v196, 16, v2
    v_and_b32 v197, 0xffff0000, v2
    v_mul_f32 v196, v196, v228
    v_mul_f32 v197, v197, v229
    v_cvt_pk_bf16_f32 v106, v196, v197
    v_cvt_pk_bf16_f32 v2, v198, v199
    v_lshlrev_b32 v198, 16, v2
    v_and_b32 v199, 0xffff0000, v2
    v_mul_f32 v3, 0xbfb8aa3b, v198
    v_mul_f32 v4, 0xbfb8aa3b, v199
    v_exp_f32 v3, v3
    v_exp_f32 v4, v4
    v_cvt_pk_bf16_f32 v2, v230, v231
    v_lshlrev_b32 v230, 16, v2
    v_and_b32 v231, 0xffff0000, v2
    v_add_f32 v3, 1.0, v3
    v_add_f32 v4, 1.0, v4
    v_rcp_f32 v3, v3
    v_rcp_f32 v4, v4
    v_mul_f32 v198, v198, v3
    v_mul_f32 v199, v199, v4
    v_cvt_pk_bf16_f32 v2, v198, v199
    v_lshlrev_b32 v198, 16, v2
    v_and_b32 v199, 0xffff0000, v2
    v_mul_f32 v198, v198, v230
    v_mul_f32 v199, v199, v231
    v_cvt_pk_bf16_f32 v107, v198, v199
    v_cvt_pk_bf16_f32 v2, v200, v201
    v_lshlrev_b32 v200, 16, v2
    v_and_b32 v201, 0xffff0000, v2
    v_mul_f32 v3, 0xbfb8aa3b, v200
    v_mul_f32 v4, 0xbfb8aa3b, v201
    v_exp_f32 v3, v3
    v_exp_f32 v4, v4
    v_cvt_pk_bf16_f32 v2, v232, v233
    v_lshlrev_b32 v232, 16, v2
    v_and_b32 v233, 0xffff0000, v2
    v_add_f32 v3, 1.0, v3
    v_add_f32 v4, 1.0, v4
    v_rcp_f32 v3, v3
    v_rcp_f32 v4, v4
    v_mul_f32 v200, v200, v3
    v_mul_f32 v201, v201, v4
    v_cvt_pk_bf16_f32 v2, v200, v201
    v_lshlrev_b32 v200, 16, v2
    v_and_b32 v201, 0xffff0000, v2
    v_mul_f32 v200, v200, v232
    v_mul_f32 v201, v201, v233
    v_cvt_pk_bf16_f32 v108, v200, v201
    v_cvt_pk_bf16_f32 v2, v202, v203
    v_lshlrev_b32 v202, 16, v2
    v_and_b32 v203, 0xffff0000, v2
    v_mul_f32 v3, 0xbfb8aa3b, v202
    v_mul_f32 v4, 0xbfb8aa3b, v203
    v_exp_f32 v3, v3
    v_exp_f32 v4, v4
    v_cvt_pk_bf16_f32 v2, v234, v235
    v_lshlrev_b32 v234, 16, v2
    v_and_b32 v235, 0xffff0000, v2
    v_add_f32 v3, 1.0, v3
    v_add_f32 v4, 1.0, v4
    v_rcp_f32 v3, v3
    v_rcp_f32 v4, v4
    v_mul_f32 v202, v202, v3
    v_mul_f32 v203, v203, v4
    v_cvt_pk_bf16_f32 v2, v202, v203
    v_lshlrev_b32 v202, 16, v2
    v_and_b32 v203, 0xffff0000, v2
    v_mul_f32 v202, v202, v234
    v_mul_f32 v203, v203, v235
    v_cvt_pk_bf16_f32 v109, v202, v203
    v_cvt_pk_bf16_f32 v2, v204, v205
    v_lshlrev_b32 v204, 16, v2
    v_and_b32 v205, 0xffff0000, v2
    v_mul_f32 v3, 0xbfb8aa3b, v204
    v_mul_f32 v4, 0xbfb8aa3b, v205
    v_exp_f32 v3, v3
    v_exp_f32 v4, v4
    v_cvt_pk_bf16_f32 v2, v236, v237
    v_lshlrev_b32 v236, 16, v2
    v_and_b32 v237, 0xffff0000, v2
    v_add_f32 v3, 1.0, v3
    v_add_f32 v4, 1.0, v4
    v_rcp_f32 v3, v3
    v_rcp_f32 v4, v4
    v_mul_f32 v204, v204, v3
    v_mul_f32 v205, v205, v4
    v_cvt_pk_bf16_f32 v2, v204, v205
    v_lshlrev_b32 v204, 16, v2
    v_and_b32 v205, 0xffff0000, v2
    v_mul_f32 v204, v204, v236
    v_mul_f32 v205, v205, v237
    v_cvt_pk_bf16_f32 v110, v204, v205
    v_cvt_pk_bf16_f32 v2, v206, v207
    v_lshlrev_b32 v206, 16, v2
    v_and_b32 v207, 0xffff0000, v2
    v_mul_f32 v3, 0xbfb8aa3b, v206
    v_mul_f32 v4, 0xbfb8aa3b, v207
    v_exp_f32 v3, v3
    v_exp_f32 v4, v4
    v_cvt_pk_bf16_f32 v2, v238, v239
    v_lshlrev_b32 v238, 16, v2
    v_and_b32 v239, 0xffff0000, v2
    v_add_f32 v3, 1.0, v3
    v_add_f32 v4, 1.0, v4
    v_rcp_f32 v3, v3
    v_rcp_f32 v4, v4
    v_mul_f32 v206, v206, v3
    v_mul_f32 v207, v207, v4
    v_cvt_pk_bf16_f32 v2, v206, v207
    v_lshlrev_b32 v206, 16, v2
    v_and_b32 v207, 0xffff0000, v2
    v_mul_f32 v206, v206, v238
    v_mul_f32 v207, v207, v239
    v_cvt_pk_bf16_f32 v111, v206, v207
    v_permlane32_swap_b32 v104, v106
    v_permlane32_swap_b32 v105, v107
    buffer_store_dwordx4 v[104:107], v26, s[24:27], s45 offen offset:64
    v_permlane32_swap_b32 v108, v110
    v_permlane32_swap_b32 v109, v111
    buffer_store_dwordx4 v[108:111], v26, s[24:27], s45 offen offset:96
gateup_kernel_end:
    s_endpgm
.section .rodata,"a"
.p2align 6
.amdhsa_kernel gateup_kernel
  .amdhsa_next_free_vgpr 240
  .amdhsa_next_free_sgpr 64
  .amdhsa_accum_offset 240
  .amdhsa_group_segment_fixed_size 0
  .amdhsa_kernarg_size 112
  .amdhsa_user_sgpr_count 2
  .amdhsa_user_sgpr_kernarg_segment_ptr 1
  .amdhsa_system_sgpr_workgroup_id_x 1
.end_amdhsa_kernel

.text
.globl down_kernel
.p2align 8
.type down_kernel,@function
down_kernel:
    s_cmp_ge_u32 s2, 256
    s_cbranch_scc1 down_kernel_end
    s_load_dwordx2 s[4:5], s[0:1], 104
    s_load_dwordx2 s[6:7], s[0:1], 64
    s_load_dwordx2 s[10:11], s[0:1], 0
    s_load_dwordx2 s[52:53], s[0:1], 88
    v_and_b32 v1, 63, v0
    v_lshrrev_b32 v2, 6, v0
    s_nop 0
    v_readfirstlane_b32 s38, v2
    s_and_b32 s45, s2, 7
    s_lshr_b32 s46, s2, 3
    s_and_b32 s47, s45, 1
    s_lshr_b32 s48, s45, 1
    s_and_b32 s49, s46, 7
    s_lshr_b32 s50, s46, 3
    s_mul_i32 s47, s47, 8
    s_add_u32 s36, s47, s49
    s_mul_i32 s48, s48, 4
    s_add_u32 s37, s48, s50
    s_mul_i32 s36, s36, 128
    s_mul_i32 s37, s37, 64
    s_waitcnt lgkmcnt(0)
    s_add_u32 s12, s4, 0x2d00000
    s_addc_u32 s13, s5, 0
    s_mov_b32 s14, 0xe00000
    s_mov_b32 s15, 0x00020000
    s_mov_b32 s16, s6
    s_mov_b32 s17, s7
    s_mov_b32 s18, 0x700000
    s_mov_b32 s19, 0x00020000
    s_mov_b32 s24, s52
    s_mov_b32 s25, s53
    s_mov_b32 s26, 0x400000
    s_mov_b32 s27, 0x00020000
    s_add_u32 s28, s4, 0x2500000
    s_addc_u32 s29, s5, 0
    s_mov_b32 s30, 0x400000
    s_mov_b32 s31, 0x00020000
    s_mov_b32 s32, s4
    s_mov_b32 s33, s5
    s_mov_b32 s34, 0x6000
    s_mov_b32 s35, 0x00020000
    s_mul_i32 s45, s38, 16
    s_mov_b32 s46, 7168
    v_lshrrev_b32 v2, 3, v1
    v_add_u32 v2, s45, v2
    v_and_b32 v3, 7, v1
    v_add_u32 v4, 0, v2
    v_bfe_u32 v5, v4, 1, 3
    v_xor_b32 v5, v5, v3
    v_add_u32 v4, s36, v4
    v_mul_lo_u32 v4, v4, s46
    v_lshl_add_u32 v8, v5, 4, v4
    v_add_u32 v4, 8, v2
    v_bfe_u32 v5, v4, 1, 3
    v_xor_b32 v5, v5, v3
    v_add_u32 v4, s36, v4
    v_mul_lo_u32 v4, v4, s46
    v_lshl_add_u32 v9, v5, 4, v4
    v_subrev_u32 v9, 1024, v9
    s_mul_i32 s45, s38, 8
    s_mov_b32 s46, 2048
    s_lshl_b32 s47, s37, 1
    v_lshrrev_b32 v2, 3, v1
    v_add_u32 v2, s45, v2
    v_and_b32 v3, 7, v1
    v_add_u32 v4, 0, v2
    v_lshrrev_b32 v5, 1, v4
    v_and_b32 v5, 1, v5
    v_lshlrev_b32 v5, 2, v5
    v_xor_b32 v5, v5, v3
    v_mul_lo_u32 v4, v4, s46
    v_lshl_add_u32 v10, v5, 4, v4
    v_add_u32 v10, s47, v10
    s_mul_i32 s42, s38, 2048
    s_mul_i32 s43, s38, 1024
    s_add_u32 s43, s43, 16384
    s_mov_b32 s39, 0
    s_mov_b32 s40, 0
    s_add_u32 m0, s42, 0
    s_nop 0
    buffer_load_dwordx4 v8, s[12:15], s39 offen offset:0 lds
    buffer_load_dwordx4 v9, s[12:15], s39 offen offset:1024 lds
    s_add_u32 m0, s43, 0
    s_nop 0
    buffer_load_dwordx4 v10, s[16:19], s40 offen offset:0 lds
    s_add_u32 s39, s39, 128
    s_add_u32 s40, s40, 131072
    s_add_u32 m0, s42, 24576
    s_nop 0
    buffer_load_dwordx4 v8, s[12:15], s39 offen offset:0 lds
    buffer_load_dwordx4 v9, s[12:15], s39 offen offset:1024 lds
    s_add_u32 m0, s43, 24576
    s_nop 0
    buffer_load_dwordx4 v10, s[16:19], s40 offen offset:0 lds
    s_add_u32 s39, s39, 128
    s_add_u32 s40, s40, 131072
    s_add_u32 m0, s42, 49152
    s_nop 0
    buffer_load_dwordx4 v8, s[12:15], s39 offen offset:0 lds
    buffer_load_dwordx4 v9, s[12:15], s39 offen offset:1024 lds
    s_add_u32 m0, s43, 49152
    s_nop 0
    buffer_load_dwordx4 v10, s[16:19], s40 offen offset:0 lds
    s_add_u32 s39, s39, 128
    s_add_u32 s40, s40, 131072
    s_add_u32 m0, s42, 73728
    s_nop 0
    buffer_load_dwordx4 v8, s[12:15], s39 offen offset:0 lds
    buffer_load_dwordx4 v9, s[12:15], s39 offen offset:1024 lds
    s_add_u32 m0, s43, 73728
    s_nop 0
    buffer_load_dwordx4 v10, s[16:19], s40 offen offset:0 lds
    s_add_u32 s39, s39, 128
    s_add_u32 s40, s40, 131072
    s_lshr_b32 s45, s38, 1
    s_and_b32 s46, s38, 1
    s_mul_i32 s47, s45, 32
    s_mul_i32 s48, s46, 32
    v_and_b32 v2, 31, v1
    v_add_u32 v2, s47, v2
    v_lshrrev_b32 v3, 5, v1
    v_bfe_u32 v4, v2, 1, 3
    v_xor_b32 v4, v4, v3
    v_lshlrev_b32 v4, 4, v4
    v_lshl_add_u32 v4, v2, 7, v4
    v_xor_b32 v11, 0, v4
    v_add_u32 v15, 24576, v11
    v_add_u32 v19, 49152, v11
    v_add_u32 v23, 73728, v11
    v_xor_b32 v12, 32, v4
    v_add_u32 v16, 24576, v12
    v_add_u32 v20, 49152, v12
    v_add_u32 v24, 73728, v12
    v_xor_b32 v13, 64, v4
    v_add_u32 v17, 24576, v13
    v_add_u32 v21, 49152, v13
    v_add_u32 v25, 73728, v13
    v_xor_b32 v14, 96, v4
    v_add_u32 v18, 24576, v14
    v_add_u32 v22, 49152, v14
    v_add_u32 v26, 73728, v14
    v_add_u32 v2, s36, v2
    s_add_u32 s48, s48, s37
    s_lshl_b32 s49, s48, 1
    s_mov_b32 s50, 2048
    v_mul_lo_u32 v31, v2, s50
    v_add_u32 v31, s49, v31
    v_lshl_add_u32 v31, v3, 4, v31
    v_lshlrev_b32 v32, 11, v2
    v_add_u32 v32, s49, v32
    v_lshl_add_u32 v32, v3, 3, v32
    s_lshl_b32 s49, s48, 2
    s_add_u32 s49, s49, 20480
    v_lshlrev_b32 v33, 4, v3
    v_add_u32 v33, s49, v33
    s_mov_b32 s50, 0
    s_mov_b32 s58, 65536
    buffer_load_dwordx4 v[84:87], v33, s[32:35], 0 offen offset:0
    buffer_load_dwordx4 v[88:91], v33, s[32:35], 0 offen offset:32
    buffer_load_dwordx4 v[92:95], v33, s[32:35], 0 offen offset:64
    buffer_load_dwordx4 v[96:99], v33, s[32:35], 0 offen offset:96
    buffer_load_dwordx2 v[100:101], v32, s[28:31], s50 offen offset:0
    buffer_load_dwordx2 v[102:103], v32, s[28:31], s50 offen offset:16
    buffer_load_dwordx2 v[104:105], v32, s[28:31], s50 offen offset:32
    buffer_load_dwordx2 v[106:107], v32, s[28:31], s50 offen offset:48
    s_mul_i32 s48, s46, 4
    v_bfe_u32 v2, v1, 2, 2
    v_and_b32 v3, 3, v1
    v_bfe_u32 v4, v1, 4, 1
    v_lshrrev_b32 v5, 5, v1
    v_lshl_add_u32 v5, v5, 3, v2
    v_lshlrev_b32 v5, 7, v5
    v_and_b32 v6, 1, v3
    v_lshl_add_u32 v5, v6, 3, v5
    v_add_u32 v5, 16384, v5
    v_lshrrev_b32 v3, 1, v3
    v_lshl_add_u32 v3, v4, 1, v3
    v_add_u32 v3, s48, v3
    v_lshrrev_b32 v2, 1, v2
    v_and_b32 v2, 1, v2
    v_lshlrev_b32 v2, 2, v2
    v_add_u32 v4, 0, v3
    v_xor_b32 v4, v4, v2
    v_lshl_add_u32 v27, v4, 4, v5
    v_add_u32 v28, 24576, v27
    v_add_u32 v29, 49152, v27
    v_add_u32 v30, 73728, v27
    v_mov_b32 v108, 0
    v_mov_b32 v109, 0
    v_mov_b32 v110, 0
    v_mov_b32 v111, 0
    v_mov_b32 v112, 0
    v_mov_b32 v113, 0
    v_mov_b32 v114, 0
    v_mov_b32 v115, 0
    v_mov_b32 v116, 0
    v_mov_b32 v117, 0
    v_mov_b32 v118, 0
    v_mov_b32 v119, 0
    v_mov_b32 v120, 0
    v_mov_b32 v121, 0
    v_mov_b32 v122, 0
    v_mov_b32 v123, 0
    s_waitcnt vmcnt(17)
    s_barrier
    ds_read_b128 v[36:39], v11 offset:0
    ds_read_b64_tr_b16 v[44:45], v27 offset:0
    ds_read_b64_tr_b16 v[46:47], v27 offset:512
    s_mov_b32 s41, 13
down_kernel_loop:
    s_waitcnt lgkmcnt(0)
    v_mfma_f32_32x32x16_bf16 v[108:123], v[44:47], v[36:39], v[108:123]
    ds_read_b128 v[40:43], v12 offset:0
    ds_read_b64_tr_b16 v[48:49], v27 offset:2048
    ds_read_b64_tr_b16 v[50:51], v27 offset:2560
    s_waitcnt lgkmcnt(0)
    v_mfma_f32_32x32x16_bf16 v[108:123], v[48:51], v[40:43], v[108:123]
    ds_read_b128 v[36:39], v13 offset:0
    ds_read_b64_tr_b16 v[44:45], v27 offset:4096
    ds_read_b64_tr_b16 v[46:47], v27 offset:4608
    s_waitcnt lgkmcnt(0)
    v_mfma_f32_32x32x16_bf16 v[108:123], v[44:47], v[36:39], v[108:123]
    ds_read_b128 v[40:43], v14 offset:0
    ds_read_b64_tr_b16 v[48:49], v27 offset:6144
    ds_read_b64_tr_b16 v[50:51], v27 offset:6656
    s_waitcnt vmcnt(6) lgkmcnt(0)
    s_barrier
    v_mfma_f32_32x32x16_bf16 v[108:123], v[48:51], v[40:43], v[108:123]
    ds_read_b128 v[36:39], v15 offset:0
    ds_read_b64_tr_b16 v[44:45], v28 offset:0
    ds_read_b64_tr_b16 v[46:47], v28 offset:512
    s_add_u32 m0, s42, 0
    s_nop 0
    buffer_load_dwordx4 v8, s[12:15], s39 offen offset:0 lds
    buffer_load_dwordx4 v9, s[12:15], s39 offen offset:1024 lds
    s_add_u32 m0, s43, 0
    s_nop 0
    buffer_load_dwordx4 v10, s[16:19], s40 offen offset:0 lds
    s_add_u32 s39, s39, 128
    s_add_u32 s40, s40, 131072
    s_waitcnt lgkmcnt(0)
    v_mfma_f32_32x32x16_bf16 v[108:123], v[44:47], v[36:39], v[108:123]
    ds_read_b128 v[40:43], v16 offset:0
    ds_read_b64_tr_b16 v[48:49], v28 offset:2048
    ds_read_b64_tr_b16 v[50:51], v28 offset:2560
    s_waitcnt lgkmcnt(0)
    v_mfma_f32_32x32x16_bf16 v[108:123], v[48:51], v[40:43], v[108:123]
    ds_read_b128 v[36:39], v17 offset:0
    ds_read_b64_tr_b16 v[44:45], v28 offset:4096
    ds_read_b64_tr_b16 v[46:47], v28 offset:4608
    s_waitcnt lgkmcnt(0)
    v_mfma_f32_32x32x16_bf16 v[108:123], v[44:47], v[36:39], v[108:123]
    ds_read_b128 v[40:43], v18 offset:0
    ds_read_b64_tr_b16 v[48:49], v28 offset:6144
    ds_read_b64_tr_b16 v[50:51], v28 offset:6656
    s_waitcnt vmcnt(6) lgkmcnt(0)
    s_barrier
    v_mfma_f32_32x32x16_bf16 v[108:123], v[48:51], v[40:43], v[108:123]
    ds_read_b128 v[36:39], v19 offset:0
    ds_read_b64_tr_b16 v[44:45], v29 offset:0
    ds_read_b64_tr_b16 v[46:47], v29 offset:512
    s_add_u32 m0, s42, 24576
    s_nop 0
    buffer_load_dwordx4 v8, s[12:15], s39 offen offset:0 lds
    buffer_load_dwordx4 v9, s[12:15], s39 offen offset:1024 lds
    s_add_u32 m0, s43, 24576
    s_nop 0
    buffer_load_dwordx4 v10, s[16:19], s40 offen offset:0 lds
    s_add_u32 s39, s39, 128
    s_add_u32 s40, s40, 131072
    s_waitcnt lgkmcnt(0)
    v_mfma_f32_32x32x16_bf16 v[108:123], v[44:47], v[36:39], v[108:123]
    ds_read_b128 v[40:43], v20 offset:0
    ds_read_b64_tr_b16 v[48:49], v29 offset:2048
    ds_read_b64_tr_b16 v[50:51], v29 offset:2560
    s_waitcnt lgkmcnt(0)
    v_mfma_f32_32x32x16_bf16 v[108:123], v[48:51], v[40:43], v[108:123]
    ds_read_b128 v[36:39], v21 offset:0
    ds_read_b64_tr_b16 v[44:45], v29 offset:4096
    ds_read_b64_tr_b16 v[46:47], v29 offset:4608
    s_waitcnt lgkmcnt(0)
    v_mfma_f32_32x32x16_bf16 v[108:123], v[44:47], v[36:39], v[108:123]
    ds_read_b128 v[40:43], v22 offset:0
    ds_read_b64_tr_b16 v[48:49], v29 offset:6144
    ds_read_b64_tr_b16 v[50:51], v29 offset:6656
    s_waitcnt vmcnt(6) lgkmcnt(0)
    s_barrier
    v_mfma_f32_32x32x16_bf16 v[108:123], v[48:51], v[40:43], v[108:123]
    ds_read_b128 v[36:39], v23 offset:0
    ds_read_b64_tr_b16 v[44:45], v30 offset:0
    ds_read_b64_tr_b16 v[46:47], v30 offset:512
    s_add_u32 m0, s42, 49152
    s_nop 0
    buffer_load_dwordx4 v8, s[12:15], s39 offen offset:0 lds
    buffer_load_dwordx4 v9, s[12:15], s39 offen offset:1024 lds
    s_add_u32 m0, s43, 49152
    s_nop 0
    buffer_load_dwordx4 v10, s[16:19], s40 offen offset:0 lds
    s_add_u32 s39, s39, 128
    s_add_u32 s40, s40, 131072
    s_waitcnt lgkmcnt(0)
    v_mfma_f32_32x32x16_bf16 v[108:123], v[44:47], v[36:39], v[108:123]
    ds_read_b128 v[40:43], v24 offset:0
    ds_read_b64_tr_b16 v[48:49], v30 offset:2048
    ds_read_b64_tr_b16 v[50:51], v30 offset:2560
    s_waitcnt lgkmcnt(0)
    v_mfma_f32_32x32x16_bf16 v[108:123], v[48:51], v[40:43], v[108:123]
    ds_read_b128 v[36:39], v25 offset:0
    ds_read_b64_tr_b16 v[44:45], v30 offset:4096
    ds_read_b64_tr_b16 v[46:47], v30 offset:4608
    s_waitcnt lgkmcnt(0)
    v_mfma_f32_32x32x16_bf16 v[108:123], v[44:47], v[36:39], v[108:123]
    ds_read_b128 v[40:43], v26 offset:0
    ds_read_b64_tr_b16 v[48:49], v30 offset:6144
    ds_read_b64_tr_b16 v[50:51], v30 offset:6656
    s_waitcnt vmcnt(6) lgkmcnt(0)
    s_barrier
    v_mfma_f32_32x32x16_bf16 v[108:123], v[48:51], v[40:43], v[108:123]
    ds_read_b128 v[36:39], v11 offset:0
    ds_read_b64_tr_b16 v[44:45], v27 offset:0
    ds_read_b64_tr_b16 v[46:47], v27 offset:512
    s_add_u32 m0, s42, 73728
    s_nop 0
    buffer_load_dwordx4 v8, s[12:15], s39 offen offset:0 lds
    buffer_load_dwordx4 v9, s[12:15], s39 offen offset:1024 lds
    s_add_u32 m0, s43, 73728
    s_nop 0
    buffer_load_dwordx4 v10, s[16:19], s40 offen offset:0 lds
    s_add_u32 s39, s39, 128
    s_add_u32 s40, s40, 131072
    s_sub_u32 s41, s41, 1
    s_cmp_lg_u32 s41, 0
    s_cbranch_scc1 down_kernel_loop
    s_waitcnt lgkmcnt(0)
    v_mfma_f32_32x32x16_bf16 v[108:123], v[44:47], v[36:39], v[108:123]
    ds_read_b128 v[40:43], v12 offset:0
    ds_read_b64_tr_b16 v[48:49], v27 offset:2048
    ds_read_b64_tr_b16 v[50:51], v27 offset:2560
    s_waitcnt lgkmcnt(0)
    v_mfma_f32_32x32x16_bf16 v[108:123], v[48:51], v[40:43], v[108:123]
    ds_read_b128 v[36:39], v13 offset:0
    ds_read_b64_tr_b16 v[44:45], v27 offset:4096
    ds_read_b64_tr_b16 v[46:47], v27 offset:4608
    s_waitcnt lgkmcnt(0)
    v_mfma_f32_32x32x16_bf16 v[108:123], v[44:47], v[36:39], v[108:123]
    ds_read_b128 v[40:43], v14 offset:0
    ds_read_b64_tr_b16 v[48:49], v27 offset:6144
    ds_read_b64_tr_b16 v[50:51], v27 offset:6656
    s_waitcnt vmcnt(6) lgkmcnt(0)
    s_barrier
    v_mfma_f32_32x32x16_bf16 v[108:123], v[48:51], v[40:43], v[108:123]
    ds_read_b128 v[36:39], v15 offset:0
    ds_read_b64_tr_b16 v[44:45], v28 offset:0
    ds_read_b64_tr_b16 v[46:47], v28 offset:512
    s_waitcnt lgkmcnt(0)
    v_mfma_f32_32x32x16_bf16 v[108:123], v[44:47], v[36:39], v[108:123]
    ds_read_b128 v[40:43], v16 offset:0
    ds_read_b64_tr_b16 v[48:49], v28 offset:2048
    ds_read_b64_tr_b16 v[50:51], v28 offset:2560
    s_waitcnt lgkmcnt(0)
    v_mfma_f32_32x32x16_bf16 v[108:123], v[48:51], v[40:43], v[108:123]
    ds_read_b128 v[36:39], v17 offset:0
    ds_read_b64_tr_b16 v[44:45], v28 offset:4096
    ds_read_b64_tr_b16 v[46:47], v28 offset:4608
    s_waitcnt lgkmcnt(0)
    v_mfma_f32_32x32x16_bf16 v[108:123], v[44:47], v[36:39], v[108:123]
    ds_read_b128 v[40:43], v18 offset:0
    ds_read_b64_tr_b16 v[48:49], v28 offset:6144
    ds_read_b64_tr_b16 v[50:51], v28 offset:6656
    s_waitcnt vmcnt(3) lgkmcnt(0)
    s_barrier
    v_mfma_f32_32x32x16_bf16 v[108:123], v[48:51], v[40:43], v[108:123]
    ds_read_b128 v[36:39], v19 offset:0
    ds_read_b64_tr_b16 v[44:45], v29 offset:0
    ds_read_b64_tr_b16 v[46:47], v29 offset:512
    s_waitcnt lgkmcnt(0)
    v_mfma_f32_32x32x16_bf16 v[108:123], v[44:47], v[36:39], v[108:123]
    ds_read_b128 v[40:43], v20 offset:0
    ds_read_b64_tr_b16 v[48:49], v29 offset:2048
    ds_read_b64_tr_b16 v[50:51], v29 offset:2560
    s_waitcnt lgkmcnt(0)
    v_mfma_f32_32x32x16_bf16 v[108:123], v[48:51], v[40:43], v[108:123]
    ds_read_b128 v[36:39], v21 offset:0
    ds_read_b64_tr_b16 v[44:45], v29 offset:4096
    ds_read_b64_tr_b16 v[46:47], v29 offset:4608
    s_waitcnt lgkmcnt(0)
    v_mfma_f32_32x32x16_bf16 v[108:123], v[44:47], v[36:39], v[108:123]
    ds_read_b128 v[40:43], v22 offset:0
    ds_read_b64_tr_b16 v[48:49], v29 offset:6144
    ds_read_b64_tr_b16 v[50:51], v29 offset:6656
    s_waitcnt vmcnt(0) lgkmcnt(0)
    s_barrier
    v_mfma_f32_32x32x16_bf16 v[108:123], v[48:51], v[40:43], v[108:123]
    ds_read_b128 v[36:39], v23 offset:0
    ds_read_b64_tr_b16 v[44:45], v30 offset:0
    ds_read_b64_tr_b16 v[46:47], v30 offset:512
    s_waitcnt lgkmcnt(0)
    v_mfma_f32_32x32x16_bf16 v[108:123], v[44:47], v[36:39], v[108:123]
    ds_read_b128 v[40:43], v24 offset:0
    ds_read_b64_tr_b16 v[48:49], v30 offset:2048
    ds_read_b64_tr_b16 v[50:51], v30 offset:2560
    s_waitcnt lgkmcnt(0)
    v_mfma_f32_32x32x16_bf16 v[108:123], v[48:51], v[40:43], v[108:123]
    ds_read_b128 v[36:39], v25 offset:0
    ds_read_b64_tr_b16 v[44:45], v30 offset:4096
    ds_read_b64_tr_b16 v[46:47], v30 offset:4608
    s_waitcnt lgkmcnt(0)
    v_mfma_f32_32x32x16_bf16 v[108:123], v[44:47], v[36:39], v[108:123]
    ds_read_b128 v[40:43], v26 offset:0
    ds_read_b64_tr_b16 v[48:49], v30 offset:6144
    ds_read_b64_tr_b16 v[50:51], v30 offset:6656
    s_waitcnt lgkmcnt(0)
    v_mfma_f32_32x32x16_bf16 v[108:123], v[48:51], v[40:43], v[108:123]
    s_mov_b32 s46, 0
    s_mov_b32 s45, 65536
    s_mov_b32 s47, 65536
    s_nop 8
    v_cvt_pk_bf16_f32 v2, v108, v109
    v_lshlrev_b32 v108, 16, v2
    v_and_b32 v109, 0xffff0000, v2
    v_mul_f32 v108, v108, v84
    v_mul_f32 v109, v109, v85
    v_cvt_pk_bf16_f32 v2, v108, v109
    v_lshlrev_b32 v108, 16, v2
    v_and_b32 v109, 0xffff0000, v2
    v_lshlrev_b32 v3, 16, v100
    v_and_b32 v4, 0xffff0000, v100
    v_add_f32 v108, v108, v3
    v_add_f32 v109, v109, v4
    v_cvt_pk_bf16_f32 v52, v108, v109
    v_cvt_pk_bf16_f32 v2, v110, v111
    v_lshlrev_b32 v110, 16, v2
    v_and_b32 v111, 0xffff0000, v2
    v_mul_f32 v110, v110, v86
    v_mul_f32 v111, v111, v87
    v_cvt_pk_bf16_f32 v2, v110, v111
    v_lshlrev_b32 v110, 16, v2
    v_and_b32 v111, 0xffff0000, v2
    v_lshlrev_b32 v3, 16, v101
    v_and_b32 v4, 0xffff0000, v101
    v_add_f32 v110, v110, v3
    v_add_f32 v111, v111, v4
    v_cvt_pk_bf16_f32 v53, v110, v111
    v_cvt_pk_bf16_f32 v2, v112, v113
    v_lshlrev_b32 v112, 16, v2
    v_and_b32 v113, 0xffff0000, v2
    v_mul_f32 v112, v112, v88
    v_mul_f32 v113, v113, v89
    v_cvt_pk_bf16_f32 v2, v112, v113
    v_lshlrev_b32 v112, 16, v2
    v_and_b32 v113, 0xffff0000, v2
    v_lshlrev_b32 v3, 16, v102
    v_and_b32 v4, 0xffff0000, v102
    v_add_f32 v112, v112, v3
    v_add_f32 v113, v113, v4
    v_cvt_pk_bf16_f32 v54, v112, v113
    v_cvt_pk_bf16_f32 v2, v114, v115
    v_lshlrev_b32 v114, 16, v2
    v_and_b32 v115, 0xffff0000, v2
    v_mul_f32 v114, v114, v90
    v_mul_f32 v115, v115, v91
    v_cvt_pk_bf16_f32 v2, v114, v115
    v_lshlrev_b32 v114, 16, v2
    v_and_b32 v115, 0xffff0000, v2
    v_lshlrev_b32 v3, 16, v103
    v_and_b32 v4, 0xffff0000, v103
    v_add_f32 v114, v114, v3
    v_add_f32 v115, v115, v4
    v_cvt_pk_bf16_f32 v55, v114, v115
    v_cvt_pk_bf16_f32 v2, v116, v117
    v_lshlrev_b32 v116, 16, v2
    v_and_b32 v117, 0xffff0000, v2
    v_mul_f32 v116, v116, v92
    v_mul_f32 v117, v117, v93
    v_cvt_pk_bf16_f32 v2, v116, v117
    v_lshlrev_b32 v116, 16, v2
    v_and_b32 v117, 0xffff0000, v2
    v_lshlrev_b32 v3, 16, v104
    v_and_b32 v4, 0xffff0000, v104
    v_add_f32 v116, v116, v3
    v_add_f32 v117, v117, v4
    v_cvt_pk_bf16_f32 v56, v116, v117
    v_cvt_pk_bf16_f32 v2, v118, v119
    v_lshlrev_b32 v118, 16, v2
    v_and_b32 v119, 0xffff0000, v2
    v_mul_f32 v118, v118, v94
    v_mul_f32 v119, v119, v95
    v_cvt_pk_bf16_f32 v2, v118, v119
    v_lshlrev_b32 v118, 16, v2
    v_and_b32 v119, 0xffff0000, v2
    v_lshlrev_b32 v3, 16, v105
    v_and_b32 v4, 0xffff0000, v105
    v_add_f32 v118, v118, v3
    v_add_f32 v119, v119, v4
    v_cvt_pk_bf16_f32 v57, v118, v119
    v_cvt_pk_bf16_f32 v2, v120, v121
    v_lshlrev_b32 v120, 16, v2
    v_and_b32 v121, 0xffff0000, v2
    v_mul_f32 v120, v120, v96
    v_mul_f32 v121, v121, v97
    v_cvt_pk_bf16_f32 v2, v120, v121
    v_lshlrev_b32 v120, 16, v2
    v_and_b32 v121, 0xffff0000, v2
    v_lshlrev_b32 v3, 16, v106
    v_and_b32 v4, 0xffff0000, v106
    v_add_f32 v120, v120, v3
    v_add_f32 v121, v121, v4
    v_cvt_pk_bf16_f32 v58, v120, v121
    v_cvt_pk_bf16_f32 v2, v122, v123
    v_lshlrev_b32 v122, 16, v2
    v_and_b32 v123, 0xffff0000, v2
    v_mul_f32 v122, v122, v98
    v_mul_f32 v123, v123, v99
    v_cvt_pk_bf16_f32 v2, v122, v123
    v_lshlrev_b32 v122, 16, v2
    v_and_b32 v123, 0xffff0000, v2
    v_lshlrev_b32 v3, 16, v107
    v_and_b32 v4, 0xffff0000, v107
    v_add_f32 v122, v122, v3
    v_add_f32 v123, v123, v4
    v_cvt_pk_bf16_f32 v59, v122, v123
    v_permlane32_swap_b32 v52, v54
    v_permlane32_swap_b32 v53, v55
    buffer_store_dwordx4 v[52:55], v31, s[24:27], s46 offen offset:0
    v_permlane32_swap_b32 v56, v58
    v_permlane32_swap_b32 v57, v59
    buffer_store_dwordx4 v[56:59], v31, s[24:27], s46 offen offset:32
down_kernel_end:
    s_endpgm
.section .rodata,"a"
.p2align 6
.amdhsa_kernel down_kernel
  .amdhsa_next_free_vgpr 124
  .amdhsa_next_free_sgpr 64
  .amdhsa_accum_offset 124
  .amdhsa_group_segment_fixed_size 0
  .amdhsa_kernarg_size 112
  .amdhsa_user_sgpr_count 2
  .amdhsa_user_sgpr_kernarg_segment_ptr 1
  .amdhsa_system_sgpr_workgroup_id_x 1
.end_amdhsa_kernel
```
